```python
import torch

def _softmax(x, axis=-1):
    return torch.softmax(x, dim=axis)
def _gelu(x):
    return torch.nn.functional.gelu(x, approximate="tanh")
def _silu(x):
    return torch.nn.functional.silu(x)
def _sigmoid(x):
    return torch.sigmoid(x)
def _layernorm(x, axis=-1, eps=1e-5):
    m = x.mean(dim=axis, keepdim=True)
    v = x.var(dim=axis, keepdim=True, unbiased=False)
    return (x - m) / torch.sqrt(v + eps)
def _scatter_add(tgt, idx, src, axis=0):
    return tgt.clone().index_add_(axis, idx, src)
def _segment_sum(src, seg, n):
    out = torch.zeros((n,) + src.shape[1:], dtype=src.dtype)
    return out.index_add_(0, seg, src)
def _pad(x, pw):
    flat = tuple(v for pair in reversed(pw) for v in pair)
    return torch.nn.functional.pad(x, flat)

kernel_name = 'standalone__mixer_s_mlp__prompt'

def setup_inputs():

    _w = (lambda a: (lambda t: t.to(torch.bfloat16) if t.is_floating_point() else t)(torch.as_tensor(a)))
    B, S, D, F = 1, 2048, 1024, 3584
    return {
        "x":  _w((lambda *s: torch.randn(*s, dtype=torch.bfloat16) * 0.4)(B, S, D)),
        "w1": _w((lambda *s: torch.randn(*s, dtype=torch.bfloat16) * 3.2)(D, D) * (D ** -0.5)),
        "w2": _w((lambda *s: torch.randn(*s, dtype=torch.bfloat16) * 3.2)(D, D) * (D ** -0.5)),
        "w3": _w((lambda *s: torch.randn(*s, dtype=torch.bfloat16) * 3.2)(D, F) * (D ** -0.5)),
        "w4": _w((lambda *s: torch.randn(*s, dtype=torch.bfloat16) * 0.8)(F, D) * (F ** -0.5)),
    }

def reference(x, w1, w2, w3, w4):
    B, S, D = x.shape
    h = _gelu(_layernorm(x, axis=-1) @ w1)
    c = D // 4
    g0 = _pad(h[:, :, 0*c:1*c], ((0, 0), (1, 0), (0, 0)))[:, :S, :]
    g1 = _pad(h[:, :, 1*c:2*c], ((0, 0), (0, 1), (0, 0)))[:, 1:, :]
    g2 = _pad(h[:, :, 2*c:3*c], ((0, 0), (2, 0), (0, 0)))[:, :S, :]
    g3 = _pad(h[:, :, 3*c:   ], ((0, 0), (0, 2), (0, 0)))[:, 2:, :]
    hs = torch.concatenate([g0, g1, g2, g3], axis=-1) @ w2
    x1 = x + hs
    h2 = _gelu(_layernorm(x1, axis=-1) @ w3) @ w4
    return x1 + h2
```

```asm
; @launch grid=(256,1,1) block=(256,1,1) lds=163840
.amdgcn_target "amdgcn-amd-amdhsa--gfx950"
.text
.p2align 8
.globl standalone__mixer_s_mlp__prompt_kernel
.type standalone__mixer_s_mlp__prompt_kernel,@function
standalone__mixer_s_mlp__prompt_kernel:
    s_cmp_ge_u32 s2, 256
    s_cbranch_scc1 L_end
    s_load_dwordx16 s[4:19], s[0:1], 0
    s_memrealtime s[28:29]
    v_lshrrev_b32 v4, 6, v0
    v_and_b32 v1, 63, v0
    v_lshlrev_b32 v2, 4, v1
    s_and_b32 s48, s2, 7
    s_lshr_b32 s49, s2, 3
    v_readfirstlane_b32 s20, v4
    s_lshr_b32 s50, s48, 1
    s_lshl_b32 s50, s50, 2
    s_lshr_b32 s21, s49, 3
    s_add_u32 s21, s21, s50
    s_and_b32 s50, s48, 1
    s_lshl_b32 s50, s50, 3
    s_and_b32 s22, s49, 7
    s_add_u32 s22, s22, s50
    s_lshr_b32 s50, s48, 2
    s_lshl_b32 s50, s50, 3
    s_lshr_b32 s23, s49, 2
    s_add_u32 s23, s23, s50
    s_and_b32 s50, s48, 3
    s_lshl_b32 s50, s50, 2
    s_and_b32 s24, s49, 3
    s_add_u32 s24, s24, s50
    s_lshl_b32 s25, s21, 2
    s_add_u32 s25, s25, s20
    s_lshl_b32 s26, s23, 2
    s_add_u32 s26, s26, s20
    v_mov_b32 v3, 0x7ffffff0
    v_cmp_eq_u32 vcc, 0, v0
    s_nop 1
    v_cndmask_b32 v3, v3, 0, vcc
    v_lshlrev_b32 v5, 2, v0
    v_mov_b32 v234, 0x7ffffff0
    v_cmp_gt_u32 vcc, 32, v0
    s_nop 1
    v_cndmask_b32 v234, v234, v5, vcc
    s_and_b32 s48, s22, 7
    s_lshl_b32 s48, s48, 1
    s_lshr_b32 s49, s22, 3
    s_add_u32 s48, s48, s49
    s_and_b32 s49, s21, 3
    s_lshl_b32 s49, s49, 2
    s_add_u32 s48, s48, s49
    s_lshr_b32 s49, s21, 2
    s_add_u32 s48, s48, s49
    s_and_b32 s48, s48, 15
    s_lshl_b32 s49, s48, 7
    s_lshl_b32 s50, s48, 17
    s_lshl_b32 s51, s20, 15
    s_lshl_b32 s91, s2, 2
    s_add_u32 s91, s91, s20
    v_lshlrev_b32 v235, 7, v1
    v_lshrrev_b32 v20, 3, v1
    v_lshlrev_b32 v20, 11, v20
    v_lshrrev_b32 v21, 4, v1
    v_and_b32 v21, 1, v21
    v_lshlrev_b32 v21, 2, v21
    v_and_b32 v4, 7, v1
    v_xor_b32 v4, v4, v21
    v_lshlrev_b32 v4, 4, v4
    v_add_u32 v4, v4, v20
    v_lshrrev_b32 v20, 3, v1
    v_lshlrev_b32 v20, 11, v20
    v_lshrrev_b32 v21, 4, v1
    v_and_b32 v7, 7, v1
    v_xor_b32 v7, v7, v21
    v_xor_b32 v8, 4, v7
    v_lshlrev_b32 v7, 4, v7
    v_lshlrev_b32 v8, 4, v8
    v_add_u32 v7, v7, v20
    v_add_u32 v8, v8, v20
    s_lshl_b32 s52, s20, 12
    s_lshl_b32 s53, s20, 11
    s_waitcnt lgkmcnt(0)
    s_mov_b32 s57, s28
    s_lshl_b32 s30, s25, 16
    s_add_u32 s36, s4, s30
    s_addc_u32 s37, s5, 0
    s_and_b32 s37, s37, 0xffff
    s_mov_b32 s38, 65536
    s_mov_b32 s39, 0x20000
    s_lshl_b32 s30, s22, 7
    s_sub_u32 s31, 2097152, s30
    s_add_u32 s40, s6, s30
    s_addc_u32 s41, s7, 0
    s_and_b32 s41, s41, 0xffff
    s_mov_b32 s42, s31
    s_mov_b32 s43, 0x20000
    s_add_u32 m0, s53, 114688
    s_add_u32 s30, s50, s51
    buffer_load_dwordx4 v4, s[40:43], s30 offen lds
    s_add_u32 m0, s53, 115712
    s_add_u32 s30, s50, s51
    s_add_u32 s30, s30, 16384
    s_add_u32 s50, s50, 131072
    s_and_b32 s50, s50, 2097151
    buffer_load_dwordx4 v4, s[40:43], s30 offen lds
    s_add_u32 m0, s52, 32768
    s_add_u32 s30, s49, 0
    buffer_load_dwordx4 v7, s[36:39], s30 offen lds
    s_add_u32 m0, s52, 33792
    s_add_u32 s30, s49, 16384
    buffer_load_dwordx4 v8, s[36:39], s30 offen lds
    s_add_u32 m0, s52, 34816
    s_add_u32 s30, s49, 32768
    buffer_load_dwordx4 v7, s[36:39], s30 offen lds
    s_add_u32 m0, s52, 35840
    s_add_u32 s30, s49, 49152
    s_add_u32 s49, s49, 128
    s_and_b32 s49, s49, 2047
    buffer_load_dwordx4 v8, s[36:39], s30 offen lds
    s_add_u32 m0, s53, 122880
    s_add_u32 s30, s50, s51
    buffer_load_dwordx4 v4, s[40:43], s30 offen lds
    s_add_u32 m0, s53, 123904
    s_add_u32 s30, s50, s51
    s_add_u32 s30, s30, 16384
    s_add_u32 s50, s50, 131072
    s_and_b32 s50, s50, 2097151
    buffer_load_dwordx4 v4, s[40:43], s30 offen lds
    s_add_u32 m0, s52, 49152
    s_add_u32 s30, s49, 0
    buffer_load_dwordx4 v7, s[36:39], s30 offen lds
    s_add_u32 m0, s52, 50176
    s_add_u32 s30, s49, 16384
    buffer_load_dwordx4 v8, s[36:39], s30 offen lds
    s_add_u32 m0, s52, 51200
    s_add_u32 s30, s49, 32768
    buffer_load_dwordx4 v7, s[36:39], s30 offen lds
    s_add_u32 m0, s52, 52224
    s_add_u32 s30, s49, 49152
    s_add_u32 s49, s49, 128
    s_and_b32 s49, s49, 2047
    buffer_load_dwordx4 v8, s[36:39], s30 offen lds
    s_getpc_b64 s[28:29]
L_pc0:
    s_lshr_b32 s30, s2, 3
    s_mul_i32 s30, s30, 3072
    v_min_u32 v24, 23, v1
    v_lshlrev_b32 v24, 7, v24
    v_add_u32 v24, s30, v24
    v_min_u32 v24, (L_end - L_pc0), v24
    v_mov_b32 v25, s29
    v_add_co_u32 v24, vcc, s28, v24
    s_nop 1
    v_addc_co_u32 v25, vcc, 0, v25, vcc
    global_load_dword v236, v[24:25], off
    s_mov_b32 s44, s16
    s_and_b32 s45, s17, 0xffff
    s_mov_b32 s46, 256
    s_mov_b32 s47, 0x20000
    s_or_b32 s57, s57, 1
    v_mov_b32 v27, s57
    s_cmp_eq_u32 s2, 0
    s_cselect_b32 s30, 0, 0x7ff00000
    buffer_store_dword v27, v3, s[44:47], s30 offen sc1
    s_mul_i32 s30, s91, 2048
    s_add_u32 s30, s30, 0
    s_mov_b32 s92, s8
    s_and_b32 s93, s9, 0xffff
    s_add_u32 s94, s30, 2048
    s_mov_b32 s95, 0x20000
    buffer_load_dword v236, v235, s[92:95], s30 offen
    s_mov_b32 s32, s18
    s_and_b32 s33, s19, 0xffff
    s_mov_b32 s34, 268435456
    s_mov_b32 s35, 0x20000
    v_lshrrev_b32 v20, 5, v1
    v_mul_u32_u24 v20, 8, v20
    v_bfe_u32 v21, v1, 2, 2
    v_add_u32 v20, v20, v21
    v_lshlrev_b32 v20, 7, v20
    v_bfe_u32 v21, v1, 4, 1
    v_lshlrev_b32 v21, 1, v21
    v_bfe_u32 v22, v1, 1, 1
    v_add_u32 v21, v21, v22
    v_bfe_u32 v22, v1, 3, 1
    v_lshlrev_b32 v22, 2, v22
    v_add_u32 v21, v21, v22
    v_lshlrev_b32 v21, 4, v21
    v_add_u32 v20, v20, v21
    v_and_b32 v21, 1, v1
    v_lshlrev_b32 v21, 3, v21
    v_add_u32 v5, v20, v21
    v_add_u32 v5, 98304, v5
    v_xor_b32 v6, 64, v5
    v_and_b32 v20, 31, v1
    v_lshlrev_b32 v21, 7, v20
    v_lshrrev_b32 v20, 1, v20
    v_and_b32 v20, 7, v20
    v_lshrrev_b32 v22, 5, v1
    v_xor_b32 v20, v20, v22
    v_lshlrev_b32 v20, 4, v20
    v_add_u32 v21, v21, v20
    v_add_u32 v12, s52, v21
    v_xor_b32 v13, 32, v12
    v_xor_b32 v14, 64, v12
    v_xor_b32 v15, 96, v12
    v_add_u32 v16, 0x10000, v12
    v_add_u32 v17, 0x10000, v13
    v_add_u32 v18, 0x10000, v14
    v_add_u32 v19, 0x10000, v15
    v_mov_b32 v32, 0
    v_mov_b32 v33, 0
    v_mov_b32 v34, 0
    v_mov_b32 v35, 0
    v_mov_b32 v36, 0
    v_mov_b32 v37, 0
    v_mov_b32 v38, 0
    v_mov_b32 v39, 0
    v_mov_b32 v40, 0
    v_mov_b32 v41, 0
    v_mov_b32 v42, 0
    v_mov_b32 v43, 0
    v_mov_b32 v44, 0
    v_mov_b32 v45, 0
    v_mov_b32 v46, 0
    v_mov_b32 v47, 0
    v_mov_b32 v48, 0
    v_mov_b32 v49, 0
    v_mov_b32 v50, 0
    v_mov_b32 v51, 0
    v_mov_b32 v52, 0
    v_mov_b32 v53, 0
    v_mov_b32 v54, 0
    v_mov_b32 v55, 0
    v_mov_b32 v56, 0
    v_mov_b32 v57, 0
    v_mov_b32 v58, 0
    v_mov_b32 v59, 0
    v_mov_b32 v60, 0
    v_mov_b32 v61, 0
    v_mov_b32 v62, 0
    v_mov_b32 v63, 0
    v_mov_b32 v88, 0
    v_mov_b32 v89, 0
    v_mov_b32 v90, 0
    v_mov_b32 v91, 0
    v_mov_b32 v92, 0
    v_mov_b32 v93, 0
    v_mov_b32 v94, 0
    v_mov_b32 v95, 0
    v_mov_b32 v96, 0
    v_mov_b32 v97, 0
    v_mov_b32 v98, 0
    v_mov_b32 v99, 0
    v_mov_b32 v100, 0
    v_mov_b32 v101, 0
    v_mov_b32 v102, 0
    v_mov_b32 v103, 0
    v_mov_b32 v104, 0
    v_mov_b32 v105, 0
    v_mov_b32 v106, 0
    v_mov_b32 v107, 0
    v_mov_b32 v108, 0
    v_mov_b32 v109, 0
    v_mov_b32 v110, 0
    v_mov_b32 v111, 0
    v_mov_b32 v112, 0
    v_mov_b32 v113, 0
    v_mov_b32 v114, 0
    v_mov_b32 v115, 0
    v_mov_b32 v116, 0
    v_mov_b32 v117, 0
    v_mov_b32 v118, 0
    v_mov_b32 v119, 0
    v_mov_b32 v120, 0x3f803f80
    v_mov_b32 v121, 0x3f803f80
    s_add_u32 m0, s53, 131072
    s_add_u32 s30, s50, s51
    buffer_load_dwordx4 v4, s[40:43], s30 offen lds
    s_add_u32 m0, s53, 132096
    s_add_u32 s30, s50, s51
    s_add_u32 s30, s30, 16384
    s_add_u32 s50, s50, 131072
    s_and_b32 s50, s50, 2097151
    buffer_load_dwordx4 v4, s[40:43], s30 offen lds
    s_add_u32 m0, s52, 65536
    s_add_u32 s30, s49, 0
    buffer_load_dwordx4 v7, s[36:39], s30 offen lds
    s_add_u32 m0, s52, 66560
    s_add_u32 s30, s49, 16384
    buffer_load_dwordx4 v8, s[36:39], s30 offen lds
    s_add_u32 m0, s52, 67584
    s_add_u32 s30, s49, 32768
    buffer_load_dwordx4 v7, s[36:39], s30 offen lds
    s_add_u32 m0, s52, 68608
    s_add_u32 s30, s49, 49152
    s_add_u32 s49, s49, 128
    s_and_b32 s49, s49, 2047
    buffer_load_dwordx4 v8, s[36:39], s30 offen lds
    s_waitcnt vmcnt(15)
    s_barrier
    ds_read_b64_tr_b16 v[72:73], v5 offset:16384
    ds_read_b64_tr_b16 v[74:75], v5 offset:16896
    ds_read_b128 v[64:67], v12 offset:32768
    ds_read_b64_tr_b16 v[76:77], v6 offset:16384
    ds_read_b64_tr_b16 v[78:79], v6 offset:16896
    ds_read_b64_tr_b16 v[80:81], v5 offset:18432
    ds_read_b64_tr_b16 v[82:83], v5 offset:18944
    ds_read_b128 v[68:71], v13 offset:32768
    ds_read_b64_tr_b16 v[84:85], v6 offset:18432
    ds_read_b64_tr_b16 v[86:87], v6 offset:18944
    s_waitcnt vmcnt(9)
    s_barrier
    s_waitcnt lgkmcnt(5)
    v_mfma_f32_32x32x16_bf16 v[32:47], v[72:75], v[64:67], v[32:47]
    s_add_u32 m0, s53, 139264
    s_add_u32 s30, s50, s51
    v_mfma_f32_32x32x16_bf16 v[48:63], v[76:79], v[64:67], v[48:63]
    buffer_load_dwordx4 v4, s[40:43], s30 offen lds
    v_mfma_f32_4x4x4_16b_bf16 v[88:91], v[120:121], v[64:65], v[88:91]
    v_mfma_f32_4x4x4_16b_bf16 v[96:99], v[64:65], v[64:65], v[96:99]
    v_mfma_f32_4x4x4_16b_bf16 v[92:95], v[120:121], v[66:67], v[92:95]
    v_mfma_f32_4x4x4_16b_bf16 v[100:103], v[66:67], v[66:67], v[100:103]
    s_cmp_lg_u32 s20, 0
    s_cbranch_scc1 L_cs_1
    v_mfma_f32_4x4x4_16b_bf16 v[104:107], v[120:121], v[72:73], v[104:107]
    v_mfma_f32_4x4x4_16b_bf16 v[108:111], v[120:121], v[74:75], v[108:111]
    v_mfma_f32_4x4x4_16b_bf16 v[112:115], v[120:121], v[76:77], v[112:115]
    v_mfma_f32_4x4x4_16b_bf16 v[116:119], v[120:121], v[78:79], v[116:119]
L_cs_1:
    ds_read_b64_tr_b16 v[72:73], v5 offset:20480
    ds_read_b64_tr_b16 v[74:75], v5 offset:20992
    ds_read_b128 v[64:67], v14 offset:32768
    ds_read_b64_tr_b16 v[76:77], v6 offset:20480
    ds_read_b64_tr_b16 v[78:79], v6 offset:20992
    s_add_u32 m0, s53, 140288
    s_add_u32 s30, s50, s51
    s_add_u32 s30, s30, 16384
    s_add_u32 s50, s50, 131072
    s_and_b32 s50, s50, 2097151
    s_waitcnt lgkmcnt(5)
    v_mfma_f32_32x32x16_bf16 v[32:47], v[80:83], v[68:71], v[32:47]
    buffer_load_dwordx4 v4, s[40:43], s30 offen lds
    s_add_u32 m0, s52, 81920
    s_add_u32 s30, s49, 0
    v_mfma_f32_32x32x16_bf16 v[48:63], v[84:87], v[68:71], v[48:63]
    buffer_load_dwordx4 v7, s[36:39], s30 offen lds
    v_mfma_f32_4x4x4_16b_bf16 v[88:91], v[120:121], v[68:69], v[88:91]
    v_mfma_f32_4x4x4_16b_bf16 v[96:99], v[68:69], v[68:69], v[96:99]
    v_mfma_f32_4x4x4_16b_bf16 v[92:95], v[120:121], v[70:71], v[92:95]
    v_mfma_f32_4x4x4_16b_bf16 v[100:103], v[70:71], v[70:71], v[100:103]
    s_cmp_lg_u32 s20, 1
    s_cbranch_scc1 L_cs_2
    v_mfma_f32_4x4x4_16b_bf16 v[104:107], v[120:121], v[80:81], v[104:107]
    v_mfma_f32_4x4x4_16b_bf16 v[108:111], v[120:121], v[82:83], v[108:111]
    v_mfma_f32_4x4x4_16b_bf16 v[112:115], v[120:121], v[84:85], v[112:115]
    v_mfma_f32_4x4x4_16b_bf16 v[116:119], v[120:121], v[86:87], v[116:119]
L_cs_2:
    ds_read_b64_tr_b16 v[80:81], v5 offset:22528
    ds_read_b64_tr_b16 v[82:83], v5 offset:23040
    ds_read_b128 v[68:71], v15 offset:32768
    ds_read_b64_tr_b16 v[84:85], v6 offset:22528
    ds_read_b64_tr_b16 v[86:87], v6 offset:23040
    s_add_u32 m0, s52, 82944
    s_add_u32 s30, s49, 16384
    s_waitcnt lgkmcnt(5)
    v_mfma_f32_32x32x16_bf16 v[32:47], v[72:75], v[64:67], v[32:47]
    buffer_load_dwordx4 v8, s[36:39], s30 offen lds
    s_add_u32 m0, s52, 83968
    s_add_u32 s30, s49, 32768
    v_mfma_f32_32x32x16_bf16 v[48:63], v[76:79], v[64:67], v[48:63]
    buffer_load_dwordx4 v7, s[36:39], s30 offen lds
    v_mfma_f32_4x4x4_16b_bf16 v[88:91], v[120:121], v[64:65], v[88:91]
    v_mfma_f32_4x4x4_16b_bf16 v[96:99], v[64:65], v[64:65], v[96:99]
    v_mfma_f32_4x4x4_16b_bf16 v[92:95], v[120:121], v[66:67], v[92:95]
    v_mfma_f32_4x4x4_16b_bf16 v[100:103], v[66:67], v[66:67], v[100:103]
    s_cmp_lg_u32 s20, 2
    s_cbranch_scc1 L_cs_3
    v_mfma_f32_4x4x4_16b_bf16 v[104:107], v[120:121], v[72:73], v[104:107]
    v_mfma_f32_4x4x4_16b_bf16 v[108:111], v[120:121], v[74:75], v[108:111]
    v_mfma_f32_4x4x4_16b_bf16 v[112:115], v[120:121], v[76:77], v[112:115]
    v_mfma_f32_4x4x4_16b_bf16 v[116:119], v[120:121], v[78:79], v[116:119]
L_cs_3:
    ds_read_b64_tr_b16 v[72:73], v5 offset:24576
    ds_read_b64_tr_b16 v[74:75], v5 offset:25088
    ds_read_b128 v[64:67], v12 offset:49152
    ds_read_b64_tr_b16 v[76:77], v6 offset:24576
    ds_read_b64_tr_b16 v[78:79], v6 offset:25088
    s_add_u32 m0, s52, 84992
    s_add_u32 s30, s49, 49152
    s_add_u32 s49, s49, 128
    s_and_b32 s49, s49, 2047
    s_waitcnt lgkmcnt(5)
    v_mfma_f32_32x32x16_bf16 v[32:47], v[80:83], v[68:71], v[32:47]
    buffer_load_dwordx4 v8, s[36:39], s30 offen lds
    s_add_u32 m0, s53, 98304
    s_add_u32 s30, s50, s51
    v_mfma_f32_32x32x16_bf16 v[48:63], v[84:87], v[68:71], v[48:63]
    buffer_load_dwordx4 v4, s[40:43], s30 offen lds
    v_mfma_f32_4x4x4_16b_bf16 v[88:91], v[120:121], v[68:69], v[88:91]
    v_mfma_f32_4x4x4_16b_bf16 v[96:99], v[68:69], v[68:69], v[96:99]
    v_mfma_f32_4x4x4_16b_bf16 v[92:95], v[120:121], v[70:71], v[92:95]
    v_mfma_f32_4x4x4_16b_bf16 v[100:103], v[70:71], v[70:71], v[100:103]
    s_cmp_lg_u32 s20, 3
    s_cbranch_scc1 L_cs_4
    v_mfma_f32_4x4x4_16b_bf16 v[104:107], v[120:121], v[80:81], v[104:107]
    v_mfma_f32_4x4x4_16b_bf16 v[108:111], v[120:121], v[82:83], v[108:111]
    v_mfma_f32_4x4x4_16b_bf16 v[112:115], v[120:121], v[84:85], v[112:115]
    v_mfma_f32_4x4x4_16b_bf16 v[116:119], v[120:121], v[86:87], v[116:119]
L_cs_4:
    ds_read_b64_tr_b16 v[80:81], v5 offset:26624
    ds_read_b64_tr_b16 v[82:83], v5 offset:27136
    ds_read_b128 v[68:71], v13 offset:49152
    ds_read_b64_tr_b16 v[84:85], v6 offset:26624
    ds_read_b64_tr_b16 v[86:87], v6 offset:27136
    s_add_u32 m0, s53, 99328
    s_add_u32 s30, s50, s51
    s_add_u32 s30, s30, 16384
    s_add_u32 s50, s50, 131072
    s_and_b32 s50, s50, 2097151
    buffer_load_dwordx4 v4, s[40:43], s30 offen lds
    s_waitcnt vmcnt(8)
    s_barrier
    s_waitcnt lgkmcnt(5)
    v_mfma_f32_32x32x16_bf16 v[32:47], v[72:75], v[64:67], v[32:47]
    ds_read_b64_tr_b16 v[72:73], v5 offset:28672
    ds_read_b64_tr_b16 v[74:75], v5 offset:29184
    s_add_u32 m0, s52, 0
    s_add_u32 s30, s49, 0
    v_add_f32 v88, v88, v92
    v_add_f32 v96, v96, v100
    v_add_f32 v97, v97, v101
    v_add_f32 v98, v98, v102
    v_mfma_f32_32x32x16_bf16 v[48:63], v[76:79], v[64:67], v[48:63]
    buffer_load_dwordx4 v7, s[36:39], s30 offen lds
    ds_read_b128 v[64:67], v14 offset:49152
    ds_read_b64_tr_b16 v[76:77], v6 offset:28672
    ds_read_b64_tr_b16 v[78:79], v6 offset:29184
    s_add_u32 m0, s52, 1024
    s_add_u32 s30, s49, 16384
    v_add_f32 v99, v99, v103
    v_and_b32 v20, 3, v1
    v_cmp_eq_u32 vcc, 1, v20
    s_nop 1
    v_cndmask_b32 v96, v96, v97, vcc
    s_waitcnt lgkmcnt(5)
    v_mfma_f32_32x32x16_bf16 v[32:47], v[80:83], v[68:71], v[32:47]
    buffer_load_dwordx4 v8, s[36:39], s30 offen lds
    ds_read_b64_tr_b16 v[80:81], v5 offset:30720
    ds_read_b64_tr_b16 v[82:83], v5 offset:31232
    s_add_u32 m0, s52, 2048
    s_add_u32 s30, s49, 32768
    v_cmp_eq_u32 vcc, 2, v20
    s_nop 1
    v_cndmask_b32 v96, v96, v98, vcc
    v_cmp_eq_u32 vcc, 3, v20
    s_nop 1
    v_cndmask_b32 v96, v96, v99, vcc
    v_mfma_f32_32x32x16_bf16 v[48:63], v[84:87], v[68:71], v[48:63]
    buffer_load_dwordx4 v7, s[36:39], s30 offen lds
    ds_read_b128 v[68:71], v15 offset:49152
    ds_read_b64_tr_b16 v[84:85], v6 offset:30720
    ds_read_b64_tr_b16 v[86:87], v6 offset:31232
    s_add_u32 m0, s52, 3072
    s_add_u32 s30, s49, 49152
    s_add_u32 s49, s49, 128
    s_and_b32 s49, s49, 2047
    v_add_f32 v104, v104, v108
    v_add_f32 v112, v112, v116
    v_mov_b32 v20, v88
    s_nop 1
    v_permlane32_swap_b32 v88, v20
    s_waitcnt lgkmcnt(5)
    v_mfma_f32_32x32x16_bf16 v[32:47], v[72:75], v[64:67], v[32:47]
    buffer_load_dwordx4 v8, s[36:39], s30 offen lds
    ds_read_b64_tr_b16 v[72:73], v5 offset:32768
    ds_read_b64_tr_b16 v[74:75], v5 offset:33280
    s_add_u32 m0, s53, 106496
    s_add_u32 s30, s50, s51
    v_add_f32 v88, v88, v20
    v_mov_b32 v21, v96
    s_nop 1
    v_permlane32_swap_b32 v96, v21
    v_add_f32 v96, v96, v21
    v_mfma_f32_32x32x16_bf16 v[48:63], v[76:79], v[64:67], v[48:63]
    buffer_load_dwordx4 v4, s[40:43], s30 offen lds
    ds_read_b128 v[64:67], v16 offset:0
    ds_read_b64_tr_b16 v[76:77], v6 offset:32768
    ds_read_b64_tr_b16 v[78:79], v6 offset:33280
    s_add_u32 m0, s53, 107520
    s_add_u32 s30, s50, s51
    s_add_u32 s30, s30, 16384
    s_add_u32 s50, s50, 131072
    s_and_b32 s50, s50, 2097151
    v_mov_b32 v22, v104
    s_nop 1
    v_permlane32_swap_b32 v104, v22
    v_add_f32 v104, v104, v22
    v_mov_b32 v23, v112
    s_waitcnt lgkmcnt(5)
    v_mfma_f32_32x32x16_bf16 v[32:47], v[80:83], v[68:71], v[32:47]
    buffer_load_dwordx4 v4, s[40:43], s30 offen lds
    ds_read_b64_tr_b16 v[80:81], v5 offset:34816
    ds_read_b64_tr_b16 v[82:83], v5 offset:35328
    s_add_u32 m0, s52, 16384
    s_add_u32 s30, s49, 0
    v_permlane32_swap_b32 v112, v23
    v_add_f32 v112, v112, v23
    v_mov_b32 v89, v96
    v_cmp_gt_u32 vcc, 32, v1
    v_mfma_f32_32x32x16_bf16 v[48:63], v[84:87], v[68:71], v[48:63]
    buffer_load_dwordx4 v7, s[36:39], s30 offen lds
    ds_read_b128 v[68:71], v17 offset:0
    ds_read_b64_tr_b16 v[84:85], v6 offset:34816
    ds_read_b64_tr_b16 v[86:87], v6 offset:35328
    s_add_u32 m0, s52, 17408
    s_add_u32 s30, s49, 16384
    v_cndmask_b32 v104, v112, v104, vcc
    v_lshlrev_b32 v20, 2, v0
    v_add_u32 v20, 147712, v20
    ds_write_b32 v20, v104
    buffer_load_dwordx4 v8, s[36:39], s30 offen lds
    s_waitcnt vmcnt(10)
    s_waitcnt lgkmcnt(0)
    s_barrier
    v_lshlrev_b32 v20, 2, v1
    v_add_u32 v20, 147712, v20
    ds_read_b32 v21, v20 offset:0
    ds_read_b32 v22, v20 offset:256
    ds_read_b32 v23, v20 offset:512
    ds_read_b32 v24, v20 offset:768
    s_waitcnt lgkmcnt(10)
    v_mfma_f32_32x32x16_bf16 v[32:47], v[72:75], v[64:67], v[32:47]
    ds_read_b64_tr_b16 v[72:73], v5 offset:36864
    ds_read_b64_tr_b16 v[74:75], v5 offset:37376
    s_add_u32 m0, s52, 18432
    s_add_u32 s30, s49, 32768
    v_lshlrev_b32 v26, 3, v1
    v_mov_b32 v27, 0x7ffffff0
    v_cndmask_b32 v26, v27, v26, vcc
    s_lshl_b32 s87, s22, 14
    v_mfma_f32_32x32x16_bf16 v[48:63], v[76:79], v[64:67], v[48:63]
    buffer_load_dwordx4 v7, s[36:39], s30 offen lds
    ds_read_b128 v[64:67], v18 offset:0
    ds_read_b64_tr_b16 v[76:77], v6 offset:36864
    ds_read_b64_tr_b16 v[78:79], v6 offset:37376
    s_add_u32 m0, s52, 19456
    s_add_u32 s30, s49, 49152
    s_add_u32 s49, s49, 128
    s_and_b32 s49, s49, 2047
    s_lshl_b32 s88, s25, 8
    s_add_u32 s87, s87, s88
    s_add_u32 s87, s87, 25165824
    buffer_store_dwordx2 v[88:89], v26, s[32:35], s87 offen sc1
    s_waitcnt lgkmcnt(10)
    v_mfma_f32_32x32x16_bf16 v[32:47], v[80:83], v[68:71], v[32:47]
    buffer_load_dwordx4 v8, s[36:39], s30 offen lds
    ds_read_b64_tr_b16 v[80:81], v5 offset:38912
    ds_read_b64_tr_b16 v[82:83], v5 offset:39424
    s_add_u32 m0, s53, 114688
    s_add_u32 s30, s50, s51
    v_lshlrev_b32 v25, 2, v0
    v_mov_b32 v29, 0x7ffffff0
    v_cmp_gt_u32 vcc, 64, v0
    s_nop 1
    v_cndmask_b32 v25, v29, v25, vcc
    v_mfma_f32_32x32x16_bf16 v[48:63], v[84:87], v[68:71], v[48:63]
    buffer_load_dwordx4 v4, s[40:43], s30 offen lds
    ds_read_b128 v[68:71], v19 offset:0
    ds_read_b64_tr_b16 v[84:85], v6 offset:38912
    ds_read_b64_tr_b16 v[86:87], v6 offset:39424
    s_add_u32 m0, s53, 115712
    s_add_u32 s30, s50, s51
    s_add_u32 s30, s30, 16384
    s_add_u32 s50, s50, 131072
    s_and_b32 s50, s50, 2097151
    s_lshl_b32 s89, s21, 12
    s_lshl_b32 s90, s22, 8
    s_add_u32 s89, s89, s90
    s_add_u32 s89, s89, 25690112
    s_waitcnt lgkmcnt(5)
    v_mfma_f32_32x32x16_bf16 v[32:47], v[72:75], v[64:67], v[32:47]
    buffer_load_dwordx4 v4, s[40:43], s30 offen lds
    ds_read_b64_tr_b16 v[72:73], v5 offset:40960
    ds_read_b64_tr_b16 v[74:75], v5 offset:41472
    s_add_u32 m0, s52, 32768
    s_add_u32 s30, s49, 0
    s_waitcnt lgkmcnt(12)
    v_add_f32 v21, v21, v22
    v_add_f32 v23, v23, v24
    v_add_f32 v21, v21, v23
    v_mfma_f32_32x32x16_bf16 v[48:63], v[76:79], v[64:67], v[48:63]
    buffer_load_dwordx4 v7, s[36:39], s30 offen lds
    ds_read_b128 v[64:67], v16 offset:16384
    ds_read_b64_tr_b16 v[76:77], v6 offset:40960
    ds_read_b64_tr_b16 v[78:79], v6 offset:41472
    s_add_u32 m0, s52, 33792
    s_add_u32 s30, s49, 16384
    buffer_store_dword v21, v25, s[32:35], s89 offen sc1
    s_mov_b32 s44, s16
    s_and_b32 s45, s17, 0xffff
    s_mov_b32 s46, 256
    s_mov_b32 s47, 0x20000
    buffer_load_dword v28, v3, s[44:47], 0 offen sc1
    s_waitcnt lgkmcnt(5)
    v_mfma_f32_32x32x16_bf16 v[32:47], v[80:83], v[68:71], v[32:47]
    buffer_load_dwordx4 v8, s[36:39], s30 offen lds
    ds_read_b64_tr_b16 v[80:81], v5 offset:43008
    ds_read_b64_tr_b16 v[82:83], v5 offset:43520
    s_add_u32 m0, s52, 34816
    s_add_u32 s30, s49, 32768
    v_mfma_f32_32x32x16_bf16 v[48:63], v[84:87], v[68:71], v[48:63]
    buffer_load_dwordx4 v7, s[36:39], s30 offen lds
    ds_read_b128 v[68:71], v17 offset:16384
    ds_read_b64_tr_b16 v[84:85], v6 offset:43008
    ds_read_b64_tr_b16 v[86:87], v6 offset:43520
    s_add_u32 m0, s52, 35840
    s_add_u32 s30, s49, 49152
    s_add_u32 s49, s49, 128
    s_and_b32 s49, s49, 2047
    buffer_load_dwordx4 v8, s[36:39], s30 offen lds
    s_waitcnt vmcnt(15)
    s_barrier
    s_waitcnt lgkmcnt(5)
    v_mfma_f32_32x32x16_bf16 v[32:47], v[72:75], v[64:67], v[32:47]
    ds_read_b64_tr_b16 v[72:73], v5 offset:45056
    ds_read_b64_tr_b16 v[74:75], v5 offset:45568
    s_add_u32 m0, s53, 122880
    s_add_u32 s30, s50, s51
    v_mfma_f32_32x32x16_bf16 v[48:63], v[76:79], v[64:67], v[48:63]
    buffer_load_dwordx4 v4, s[40:43], s30 offen lds
    ds_read_b128 v[64:67], v18 offset:16384
    ds_read_b64_tr_b16 v[76:77], v6 offset:45056
    ds_read_b64_tr_b16 v[78:79], v6 offset:45568
    s_add_u32 m0, s53, 123904
    s_add_u32 s30, s50, s51
    s_add_u32 s30, s30, 16384
    s_add_u32 s50, s50, 131072
    s_and_b32 s50, s50, 2097151
    s_waitcnt lgkmcnt(5)
    v_mfma_f32_32x32x16_bf16 v[32:47], v[80:83], v[68:71], v[32:47]
    buffer_load_dwordx4 v4, s[40:43], s30 offen lds
    ds_read_b64_tr_b16 v[80:81], v5 offset:47104
    ds_read_b64_tr_b16 v[82:83], v5 offset:47616
    s_add_u32 m0, s52, 49152
    s_add_u32 s30, s49, 0
    v_mfma_f32_32x32x16_bf16 v[48:63], v[84:87], v[68:71], v[48:63]
    buffer_load_dwordx4 v7, s[36:39], s30 offen lds
    ds_read_b128 v[68:71], v19 offset:16384
    ds_read_b64_tr_b16 v[84:85], v6 offset:47104
    ds_read_b64_tr_b16 v[86:87], v6 offset:47616
    s_add_u32 m0, s52, 50176
    s_add_u32 s30, s49, 16384
    s_waitcnt lgkmcnt(5)
    v_mfma_f32_32x32x16_bf16 v[32:47], v[72:75], v[64:67], v[32:47]
    buffer_load_dwordx4 v8, s[36:39], s30 offen lds
    ds_read_b64_tr_b16 v[72:73], v5 offset:0
    ds_read_b64_tr_b16 v[74:75], v5 offset:512
    s_add_u32 m0, s52, 51200
    s_add_u32 s30, s49, 32768
    v_mfma_f32_32x32x16_bf16 v[48:63], v[76:79], v[64:67], v[48:63]
    buffer_load_dwordx4 v7, s[36:39], s30 offen lds
    ds_read_b128 v[64:67], v12 offset:0
    ds_read_b64_tr_b16 v[76:77], v6 offset:0
    ds_read_b64_tr_b16 v[78:79], v6 offset:512
    s_add_u32 m0, s52, 52224
    s_add_u32 s30, s49, 49152
    s_add_u32 s49, s49, 128
    s_and_b32 s49, s49, 2047
    s_waitcnt lgkmcnt(5)
    v_mfma_f32_32x32x16_bf16 v[32:47], v[80:83], v[68:71], v[32:47]
    buffer_load_dwordx4 v8, s[36:39], s30 offen lds
    ds_read_b64_tr_b16 v[80:81], v5 offset:2048
    ds_read_b64_tr_b16 v[82:83], v5 offset:2560
    s_add_u32 m0, s53, 131072
    s_add_u32 s30, s50, s51
    v_mfma_f32_32x32x16_bf16 v[48:63], v[84:87], v[68:71], v[48:63]
    buffer_load_dwordx4 v4, s[40:43], s30 offen lds
    ds_read_b128 v[68:71], v13 offset:0
    ds_read_b64_tr_b16 v[84:85], v6 offset:2048
    ds_read_b64_tr_b16 v[86:87], v6 offset:2560
    s_add_u32 m0, s53, 132096
    s_add_u32 s30, s50, s51
    s_add_u32 s30, s30, 16384
    s_add_u32 s50, s50, 131072
    s_and_b32 s50, s50, 2097151
    buffer_load_dwordx4 v4, s[40:43], s30 offen lds
    s_waitcnt vmcnt(16)
    s_barrier
    s_waitcnt lgkmcnt(5)
    v_mfma_f32_32x32x16_bf16 v[32:47], v[72:75], v[64:67], v[32:47]
    ds_read_b64_tr_b16 v[72:73], v5 offset:4096
    ds_read_b64_tr_b16 v[74:75], v5 offset:4608
    s_add_u32 m0, s52, 65536
    s_add_u32 s30, s49, 0
    v_mfma_f32_32x32x16_bf16 v[48:63], v[76:79], v[64:67], v[48:63]
    buffer_load_dwordx4 v7, s[36:39], s30 offen lds
    ds_read_b128 v[64:67], v14 offset:0
    ds_read_b64_tr_b16 v[76:77], v6 offset:4096
    ds_read_b64_tr_b16 v[78:79], v6 offset:4608
    s_add_u32 m0, s52, 66560
    s_add_u32 s30, s49, 16384
    s_waitcnt lgkmcnt(5)
    v_mfma_f32_32x32x16_bf16 v[32:47], v[80:83], v[68:71], v[32:47]
    buffer_load_dwordx4 v8, s[36:39], s30 offen lds
    ds_read_b64_tr_b16 v[80:81], v5 offset:6144
    ds_read_b64_tr_b16 v[82:83], v5 offset:6656
    s_add_u32 m0, s52, 67584
    s_add_u32 s30, s49, 32768
    v_mfma_f32_32x32x16_bf16 v[48:63], v[84:87], v[68:71], v[48:63]
    buffer_load_dwordx4 v7, s[36:39], s30 offen lds
    ds_read_b128 v[68:71], v15 offset:0
    ds_read_b64_tr_b16 v[84:85], v6 offset:6144
    ds_read_b64_tr_b16 v[86:87], v6 offset:6656
    s_add_u32 m0, s52, 68608
    s_add_u32 s30, s49, 49152
    s_add_u32 s49, s49, 128
    s_and_b32 s49, s49, 2047
    s_waitcnt lgkmcnt(5)
    v_mfma_f32_32x32x16_bf16 v[32:47], v[72:75], v[64:67], v[32:47]
    buffer_load_dwordx4 v8, s[36:39], s30 offen lds
    ds_read_b64_tr_b16 v[72:73], v5 offset:8192
    ds_read_b64_tr_b16 v[74:75], v5 offset:8704
    s_add_u32 m0, s53, 139264
    s_add_u32 s30, s50, s51
    v_mfma_f32_32x32x16_bf16 v[48:63], v[76:79], v[64:67], v[48:63]
    buffer_load_dwordx4 v4, s[40:43], s30 offen lds
    ds_read_b128 v[64:67], v12 offset:16384
    ds_read_b64_tr_b16 v[76:77], v6 offset:8192
    ds_read_b64_tr_b16 v[78:79], v6 offset:8704
    s_add_u32 m0, s53, 140288
    s_add_u32 s30, s50, s51
    s_add_u32 s30, s30, 16384
    s_add_u32 s50, s50, 131072
    s_and_b32 s50, s50, 2097151
    s_waitcnt lgkmcnt(5)
    v_mfma_f32_32x32x16_bf16 v[32:47], v[80:83], v[68:71], v[32:47]
    buffer_load_dwordx4 v4, s[40:43], s30 offen lds
    ds_read_b64_tr_b16 v[80:81], v5 offset:10240
    ds_read_b64_tr_b16 v[82:83], v5 offset:10752
    s_add_u32 m0, s52, 81920
    s_add_u32 s30, s49, 0
    v_mfma_f32_32x32x16_bf16 v[48:63], v[84:87], v[68:71], v[48:63]
    buffer_load_dwordx4 v7, s[36:39], s30 offen lds
    ds_read_b128 v[68:71], v13 offset:16384
    ds_read_b64_tr_b16 v[84:85], v6 offset:10240
    ds_read_b64_tr_b16 v[86:87], v6 offset:10752
    s_add_u32 m0, s52, 82944
    s_add_u32 s30, s49, 16384
    buffer_load_dwordx4 v8, s[36:39], s30 offen lds
    s_waitcnt vmcnt(16)
    s_barrier
    s_waitcnt lgkmcnt(5)
    v_mfma_f32_32x32x16_bf16 v[32:47], v[72:75], v[64:67], v[32:47]
    ds_read_b64_tr_b16 v[72:73], v5 offset:12288
    ds_read_b64_tr_b16 v[74:75], v5 offset:12800
    s_add_u32 m0, s52, 83968
    s_add_u32 s30, s49, 32768
    v_mfma_f32_32x32x16_bf16 v[48:63], v[76:79], v[64:67], v[48:63]
    buffer_load_dwordx4 v7, s[36:39], s30 offen lds
    ds_read_b128 v[64:67], v14 offset:16384
    ds_read_b64_tr_b16 v[76:77], v6 offset:12288
    ds_read_b64_tr_b16 v[78:79], v6 offset:12800
    s_add_u32 m0, s52, 84992
    s_add_u32 s30, s49, 49152
    s_add_u32 s49, s49, 128
    s_and_b32 s49, s49, 2047
    s_waitcnt lgkmcnt(5)
    v_mfma_f32_32x32x16_bf16 v[32:47], v[80:83], v[68:71], v[32:47]
    buffer_load_dwordx4 v8, s[36:39], s30 offen lds
    ds_read_b64_tr_b16 v[80:81], v5 offset:14336
    ds_read_b64_tr_b16 v[82:83], v5 offset:14848
    s_add_u32 m0, s53, 98304
    s_add_u32 s30, s50, s51
    v_mfma_f32_32x32x16_bf16 v[48:63], v[84:87], v[68:71], v[48:63]
    buffer_load_dwordx4 v4, s[40:43], s30 offen lds
    ds_read_b128 v[68:71], v15 offset:16384
    ds_read_b64_tr_b16 v[84:85], v6 offset:14336
    ds_read_b64_tr_b16 v[86:87], v6 offset:14848
    s_add_u32 m0, s53, 99328
    s_add_u32 s30, s50, s51
    s_add_u32 s30, s30, 16384
    s_add_u32 s50, s50, 131072
    s_and_b32 s50, s50, 2097151
    s_waitcnt lgkmcnt(5)
    v_mfma_f32_32x32x16_bf16 v[32:47], v[72:75], v[64:67], v[32:47]
    buffer_load_dwordx4 v4, s[40:43], s30 offen lds
    ds_read_b64_tr_b16 v[72:73], v5 offset:16384
    ds_read_b64_tr_b16 v[74:75], v5 offset:16896
    s_add_u32 m0, s52, 0
    s_add_u32 s30, s49, 0
    v_mfma_f32_32x32x16_bf16 v[48:63], v[76:79], v[64:67], v[48:63]
    buffer_load_dwordx4 v7, s[36:39], s30 offen lds
    ds_read_b128 v[64:67], v12 offset:32768
    ds_read_b64_tr_b16 v[76:77], v6 offset:16384
    ds_read_b64_tr_b16 v[78:79], v6 offset:16896
    s_add_u32 m0, s52, 1024
    s_add_u32 s30, s49, 16384
    s_waitcnt lgkmcnt(5)
    v_mfma_f32_32x32x16_bf16 v[32:47], v[80:83], v[68:71], v[32:47]
    buffer_load_dwordx4 v8, s[36:39], s30 offen lds
    ds_read_b64_tr_b16 v[80:81], v5 offset:18432
    ds_read_b64_tr_b16 v[82:83], v5 offset:18944
    s_add_u32 m0, s52, 2048
    s_add_u32 s30, s49, 32768
    v_mfma_f32_32x32x16_bf16 v[48:63], v[84:87], v[68:71], v[48:63]
    buffer_load_dwordx4 v7, s[36:39], s30 offen lds
    ds_read_b128 v[68:71], v13 offset:32768
    ds_read_b64_tr_b16 v[84:85], v6 offset:18432
    ds_read_b64_tr_b16 v[86:87], v6 offset:18944
    s_add_u32 m0, s52, 3072
    s_add_u32 s30, s49, 49152
    s_add_u32 s49, s49, 128
    s_and_b32 s49, s49, 2047
    buffer_load_dwordx4 v8, s[36:39], s30 offen lds
    s_waitcnt vmcnt(18)
    s_waitcnt vmcnt(27)
    s_cmp_lg_u32 s20, 0
    s_cbranch_scc1 L_n_5
    s_mov_b32 s30, 200000
L_np_6:
    v_readfirstlane_b32 s27, v28
    s_nop 0
    s_cmp_lg_u32 s27, 0
    s_cbranch_scc1 L_n_5
    buffer_load_dword v28, v3, s[44:47], 0 offen sc1
    s_waitcnt vmcnt(0)
    s_sub_u32 s30, s30, 1
    s_cmp_lg_u32 s30, 0
    s_cbranch_scc1 L_np_6
L_n_5:
    s_barrier
    s_add_u32 s28, s21, 0
    s_lshl_b32 s28, s28, 4
    s_add_u32 s28, s28, s22
    s_lshl_b32 s28, s28, 7
    s_add_u32 s28, s28, 26214400
    v_mov_b32 v20, s27
    buffer_store_dword v20, v234, s[32:35], s28 offen sc1
    s_add_u32 s28, s22, 16
    s_lshl_b32 s28, s28, 4
    s_add_u32 s28, s28, s21
    s_lshl_b32 s28, s28, 7
    s_add_u32 s28, s28, 26214400
    v_mov_b32 v20, s27
    buffer_store_dword v20, v234, s[32:35], s28 offen sc1
    s_waitcnt lgkmcnt(5)
    v_mfma_f32_32x32x16_bf16 v[32:47], v[72:75], v[64:67], v[32:47]
    ds_read_b64_tr_b16 v[72:73], v5 offset:20480
    ds_read_b64_tr_b16 v[74:75], v5 offset:20992
    s_add_u32 m0, s53, 106496
    s_add_u32 s30, s50, s51
    v_mfma_f32_32x32x16_bf16 v[48:63], v[76:79], v[64:67], v[48:63]
    buffer_load_dwordx4 v4, s[40:43], s30 offen lds
    ds_read_b128 v[64:67], v14 offset:32768
    ds_read_b64_tr_b16 v[76:77], v6 offset:20480
    ds_read_b64_tr_b16 v[78:79], v6 offset:20992
    s_add_u32 m0, s53, 107520
    s_add_u32 s30, s50, s51
    s_add_u32 s30, s30, 16384
    s_add_u32 s50, s50, 131072
    s_and_b32 s50, s50, 2097151
    s_waitcnt lgkmcnt(5)
    v_mfma_f32_32x32x16_bf16 v[32:47], v[80:83], v[68:71], v[32:47]
    buffer_load_dwordx4 v4, s[40:43], s30 offen lds
    ds_read_b64_tr_b16 v[80:81], v5 offset:22528
    ds_read_b64_tr_b16 v[82:83], v5 offset:23040
    s_add_u32 m0, s52, 16384
    s_add_u32 s30, s49, 0
    v_mfma_f32_32x32x16_bf16 v[48:63], v[84:87], v[68:71], v[48:63]
    buffer_load_dwordx4 v7, s[36:39], s30 offen lds
    ds_read_b128 v[68:71], v15 offset:32768
    ds_read_b64_tr_b16 v[84:85], v6 offset:22528
    ds_read_b64_tr_b16 v[86:87], v6 offset:23040
    s_add_u32 m0, s52, 17408
    s_add_u32 s30, s49, 16384
    s_waitcnt lgkmcnt(5)
    v_mfma_f32_32x32x16_bf16 v[32:47], v[72:75], v[64:67], v[32:47]
    buffer_load_dwordx4 v8, s[36:39], s30 offen lds
    ds_read_b64_tr_b16 v[72:73], v5 offset:24576
    ds_read_b64_tr_b16 v[74:75], v5 offset:25088
    s_add_u32 m0, s52, 18432
    s_add_u32 s30, s49, 32768
    v_mfma_f32_32x32x16_bf16 v[48:63], v[76:79], v[64:67], v[48:63]
    buffer_load_dwordx4 v7, s[36:39], s30 offen lds
    ds_read_b128 v[64:67], v12 offset:49152
    ds_read_b64_tr_b16 v[76:77], v6 offset:24576
    ds_read_b64_tr_b16 v[78:79], v6 offset:25088
    s_add_u32 m0, s52, 19456
    s_add_u32 s30, s49, 49152
    s_add_u32 s49, s49, 128
    s_and_b32 s49, s49, 2047
    s_waitcnt lgkmcnt(5)
    v_mfma_f32_32x32x16_bf16 v[32:47], v[80:83], v[68:71], v[32:47]
    buffer_load_dwordx4 v8, s[36:39], s30 offen lds
    ds_read_b64_tr_b16 v[80:81], v5 offset:26624
    ds_read_b64_tr_b16 v[82:83], v5 offset:27136
    v_mfma_f32_32x32x16_bf16 v[48:63], v[84:87], v[68:71], v[48:63]
    ds_read_b128 v[68:71], v13 offset:49152
    ds_read_b64_tr_b16 v[84:85], v6 offset:26624
    ds_read_b64_tr_b16 v[86:87], v6 offset:27136
    s_waitcnt vmcnt(20)
    s_barrier
    s_waitcnt lgkmcnt(5)
    v_mfma_f32_32x32x16_bf16 v[32:47], v[72:75], v[64:67], v[32:47]
    ds_read_b64_tr_b16 v[72:73], v5 offset:28672
    ds_read_b64_tr_b16 v[74:75], v5 offset:29184
    s_add_u32 m0, s53, 114688
    s_add_u32 s30, s50, s51
    v_mfma_f32_32x32x16_bf16 v[48:63], v[76:79], v[64:67], v[48:63]
    buffer_load_dwordx4 v4, s[40:43], s30 offen lds
    ds_read_b128 v[64:67], v14 offset:49152
    ds_read_b64_tr_b16 v[76:77], v6 offset:28672
    ds_read_b64_tr_b16 v[78:79], v6 offset:29184
    s_add_u32 m0, s53, 115712
    s_add_u32 s30, s50, s51
    s_add_u32 s30, s30, 16384
    s_add_u32 s50, s50, 131072
    s_and_b32 s50, s50, 2097151
    s_waitcnt lgkmcnt(5)
    v_mfma_f32_32x32x16_bf16 v[32:47], v[80:83], v[68:71], v[32:47]
    buffer_load_dwordx4 v4, s[40:43], s30 offen lds
    ds_read_b64_tr_b16 v[80:81], v5 offset:30720
    ds_read_b64_tr_b16 v[82:83], v5 offset:31232
    s_add_u32 m0, s52, 32768
    s_add_u32 s30, s49, 0
    v_mfma_f32_32x32x16_bf16 v[48:63], v[84:87], v[68:71], v[48:63]
    buffer_load_dwordx4 v7, s[36:39], s30 offen lds
    ds_read_b128 v[68:71], v15 offset:49152
    ds_read_b64_tr_b16 v[84:85], v6 offset:30720
    ds_read_b64_tr_b16 v[86:87], v6 offset:31232
    s_add_u32 m0, s52, 33792
    s_add_u32 s30, s49, 16384
    s_waitcnt lgkmcnt(5)
    v_mfma_f32_32x32x16_bf16 v[32:47], v[72:75], v[64:67], v[32:47]
    buffer_load_dwordx4 v8, s[36:39], s30 offen lds
    ds_read_b64_tr_b16 v[72:73], v5 offset:32768
    ds_read_b64_tr_b16 v[74:75], v5 offset:33280
    s_add_u32 m0, s52, 34816
    s_add_u32 s30, s49, 32768
    v_mfma_f32_32x32x16_bf16 v[48:63], v[76:79], v[64:67], v[48:63]
    buffer_load_dwordx4 v7, s[36:39], s30 offen lds
    ds_read_b128 v[64:67], v16 offset:0
    ds_read_b64_tr_b16 v[76:77], v6 offset:32768
    ds_read_b64_tr_b16 v[78:79], v6 offset:33280
    s_add_u32 m0, s52, 35840
    s_add_u32 s30, s49, 49152
    s_add_u32 s49, s49, 128
    s_and_b32 s49, s49, 2047
    s_waitcnt lgkmcnt(5)
    v_mfma_f32_32x32x16_bf16 v[32:47], v[80:83], v[68:71], v[32:47]
    buffer_load_dwordx4 v8, s[36:39], s30 offen lds
    ds_read_b64_tr_b16 v[80:81], v5 offset:34816
    ds_read_b64_tr_b16 v[82:83], v5 offset:35328
    v_mfma_f32_32x32x16_bf16 v[48:63], v[84:87], v[68:71], v[48:63]
    ds_read_b128 v[68:71], v17 offset:0
    ds_read_b64_tr_b16 v[84:85], v6 offset:34816
    ds_read_b64_tr_b16 v[86:87], v6 offset:35328
    s_waitcnt vmcnt(20)
    s_barrier
    s_waitcnt lgkmcnt(5)
    v_mfma_f32_32x32x16_bf16 v[32:47], v[72:75], v[64:67], v[32:47]
    ds_read_b64_tr_b16 v[72:73], v5 offset:36864
    ds_read_b64_tr_b16 v[74:75], v5 offset:37376
    s_add_u32 m0, s53, 122880
    s_add_u32 s30, s50, s51
    s_lshl_b32 s87, s22, 7
    s_sub_u32 s88, 2097152, s87
    s_add_u32 s44, s8, s87
    s_addc_u32 s45, s9, 0
    s_and_b32 s45, s45, 0xffff
    s_mov_b32 s46, s88
    s_mov_b32 s47, 0x20000
    v_mfma_f32_32x32x16_bf16 v[48:63], v[76:79], v[64:67], v[48:63]
    buffer_load_dwordx4 v4, s[40:43], s30 offen lds
    ds_read_b128 v[64:67], v18 offset:0
    ds_read_b64_tr_b16 v[76:77], v6 offset:36864
    ds_read_b64_tr_b16 v[78:79], v6 offset:37376
    s_add_u32 m0, s53, 123904
    s_add_u32 s30, s50, s51
    s_add_u32 s30, s30, 16384
    s_add_u32 s50, s50, 131072
    s_and_b32 s50, s50, 2097151
    s_waitcnt lgkmcnt(5)
    v_mfma_f32_32x32x16_bf16 v[32:47], v[80:83], v[68:71], v[32:47]
    buffer_load_dwordx4 v4, s[40:43], s30 offen lds
    ds_read_b64_tr_b16 v[80:81], v5 offset:38912
    ds_read_b64_tr_b16 v[82:83], v5 offset:39424
    s_add_u32 m0, s52, 49152
    s_add_u32 s30, s49, 0
    v_mfma_f32_32x32x16_bf16 v[48:63], v[84:87], v[68:71], v[48:63]
    buffer_load_dwordx4 v7, s[36:39], s30 offen lds
    ds_read_b128 v[68:71], v19 offset:0
    ds_read_b64_tr_b16 v[84:85], v6 offset:38912
    ds_read_b64_tr_b16 v[86:87], v6 offset:39424
    s_add_u32 m0, s52, 50176
    s_add_u32 s30, s49, 16384
    s_waitcnt lgkmcnt(5)
    v_mfma_f32_32x32x16_bf16 v[32:47], v[72:75], v[64:67], v[32:47]
    buffer_load_dwordx4 v8, s[36:39], s30 offen lds
    ds_read_b64_tr_b16 v[72:73], v5 offset:40960
    ds_read_b64_tr_b16 v[74:75], v5 offset:41472
    s_add_u32 m0, s52, 51200
    s_add_u32 s30, s49, 32768
    v_mfma_f32_32x32x16_bf16 v[48:63], v[76:79], v[64:67], v[48:63]
    buffer_load_dwordx4 v7, s[36:39], s30 offen lds
    ds_read_b128 v[64:67], v16 offset:16384
    ds_read_b64_tr_b16 v[76:77], v6 offset:40960
    ds_read_b64_tr_b16 v[78:79], v6 offset:41472
    s_add_u32 m0, s52, 52224
    s_add_u32 s30, s49, 49152
    s_add_u32 s49, s49, 128
    s_and_b32 s49, s49, 2047
    s_waitcnt lgkmcnt(5)
    v_mfma_f32_32x32x16_bf16 v[32:47], v[80:83], v[68:71], v[32:47]
    buffer_load_dwordx4 v8, s[36:39], s30 offen lds
    ds_read_b64_tr_b16 v[80:81], v5 offset:43008
    ds_read_b64_tr_b16 v[82:83], v5 offset:43520
    v_mfma_f32_32x32x16_bf16 v[48:63], v[84:87], v[68:71], v[48:63]
    ds_read_b128 v[68:71], v17 offset:16384
    ds_read_b64_tr_b16 v[84:85], v6 offset:43008
    ds_read_b64_tr_b16 v[86:87], v6 offset:43520
    s_waitcnt vmcnt(20)
    s_barrier
    v_and_b32 v9, 15, v1
    v_lshlrev_b32 v9, 7, v9
    s_add_u32 s28, s21, 0
    s_lshl_b32 s28, s28, 11
    s_add_u32 s29, s22, 16
    s_lshl_b32 s29, s29, 11
    v_mov_b32 v20, s28
    v_mov_b32 v21, s29
    v_and_b32 v22, 16, v1
    v_cmp_eq_u32 vcc, 0, v22
    s_nop 1
    v_cndmask_b32 v20, v21, v20, vcc
    v_add_u32 v9, v9, v20
    v_lshrrev_b32 v20, 5, v1
    v_lshlrev_b32 v20, 2, v20
    v_add_u32 v9, v9, v20
    v_mov_b32 v20, 0x7ffffff0
    v_cmp_gt_u32 vcc, 64, v0
    s_nop 1
    v_cndmask_b32 v9, v20, v9, vcc
    s_mov_b32 s31, 26214400
    buffer_load_dword v10, v9, s[32:35], s31 offen sc1
    s_waitcnt lgkmcnt(5)
    v_mfma_f32_32x32x16_bf16 v[32:47], v[72:75], v[64:67], v[32:47]
    ds_read_b64_tr_b16 v[72:73], v5 offset:45056
    ds_read_b64_tr_b16 v[74:75], v5 offset:45568
    s_add_u32 m0, s53, 131072
    s_add_u32 s30, s50, s51
    v_mfma_f32_32x32x16_bf16 v[48:63], v[76:79], v[64:67], v[48:63]
    buffer_load_dwordx4 v4, s[40:43], s30 offen lds
    ds_read_b128 v[64:67], v18 offset:16384
    ds_read_b64_tr_b16 v[76:77], v6 offset:45056
    ds_read_b64_tr_b16 v[78:79], v6 offset:45568
    s_add_u32 m0, s53, 132096
    s_add_u32 s30, s50, s51
    s_add_u32 s30, s30, 16384
    s_add_u32 s50, s50, 131072
    s_and_b32 s50, s50, 2097151
    s_waitcnt lgkmcnt(5)
    v_mfma_f32_32x32x16_bf16 v[32:47], v[80:83], v[68:71], v[32:47]
    buffer_load_dwordx4 v4, s[40:43], s30 offen lds
    ds_read_b64_tr_b16 v[80:81], v5 offset:47104
    ds_read_b64_tr_b16 v[82:83], v5 offset:47616
    s_add_u32 m0, s52, 65536
    s_add_u32 s30, s49, 0
    v_mfma_f32_32x32x16_bf16 v[48:63], v[84:87], v[68:71], v[48:63]
    buffer_load_dwordx4 v7, s[36:39], s30 offen lds
    ds_read_b128 v[68:71], v19 offset:16384
    ds_read_b64_tr_b16 v[84:85], v6 offset:47104
    ds_read_b64_tr_b16 v[86:87], v6 offset:47616
    s_add_u32 m0, s52, 66560
    s_add_u32 s30, s49, 16384
    s_waitcnt lgkmcnt(5)
    v_mfma_f32_32x32x16_bf16 v[32:47], v[72:75], v[64:67], v[32:47]
    buffer_load_dwordx4 v8, s[36:39], s30 offen lds
    ds_read_b64_tr_b16 v[72:73], v5 offset:0
    ds_read_b64_tr_b16 v[74:75], v5 offset:512
    s_add_u32 m0, s52, 67584
    s_add_u32 s30, s49, 32768
    v_mfma_f32_32x32x16_bf16 v[48:63], v[76:79], v[64:67], v[48:63]
    buffer_load_dwordx4 v7, s[36:39], s30 offen lds
    ds_read_b128 v[64:67], v12 offset:0
    ds_read_b64_tr_b16 v[76:77], v6 offset:0
    ds_read_b64_tr_b16 v[78:79], v6 offset:512
    s_add_u32 m0, s52, 68608
    s_add_u32 s30, s49, 49152
    s_add_u32 s49, s49, 128
    s_and_b32 s49, s49, 2047
    s_waitcnt lgkmcnt(5)
    v_mfma_f32_32x32x16_bf16 v[32:47], v[80:83], v[68:71], v[32:47]
    buffer_load_dwordx4 v8, s[36:39], s30 offen lds
    ds_read_b64_tr_b16 v[80:81], v5 offset:2048
    ds_read_b64_tr_b16 v[82:83], v5 offset:2560
    v_mfma_f32_32x32x16_bf16 v[48:63], v[84:87], v[68:71], v[48:63]
    ds_read_b128 v[68:71], v13 offset:0
    ds_read_b64_tr_b16 v[84:85], v6 offset:2048
    ds_read_b64_tr_b16 v[86:87], v6 offset:2560
    s_waitcnt vmcnt(19)
    s_barrier
    s_waitcnt lgkmcnt(5)
    v_mfma_f32_32x32x16_bf16 v[32:47], v[72:75], v[64:67], v[32:47]
    ds_read_b64_tr_b16 v[72:73], v5 offset:4096
    ds_read_b64_tr_b16 v[74:75], v5 offset:4608
    s_add_u32 m0, s53, 139264
    s_add_u32 s30, s50, s51
    v_mfma_f32_32x32x16_bf16 v[48:63], v[76:79], v[64:67], v[48:63]
    buffer_load_dwordx4 v4, s[40:43], s30 offen lds
    ds_read_b128 v[64:67], v14 offset:0
    ds_read_b64_tr_b16 v[76:77], v6 offset:4096
    ds_read_b64_tr_b16 v[78:79], v6 offset:4608
    s_add_u32 m0, s53, 140288
    s_add_u32 s30, s50, s51
    s_add_u32 s30, s30, 16384
    s_add_u32 s50, s50, 131072
    s_and_b32 s50, s50, 2097151
    s_waitcnt lgkmcnt(5)
    v_mfma_f32_32x32x16_bf16 v[32:47], v[80:83], v[68:71], v[32:47]
    buffer_load_dwordx4 v4, s[40:43], s30 offen lds
    ds_read_b64_tr_b16 v[80:81], v5 offset:6144
    ds_read_b64_tr_b16 v[82:83], v5 offset:6656
    s_add_u32 m0, s52, 81920
    s_add_u32 s30, s49, 0
    v_mfma_f32_32x32x16_bf16 v[48:63], v[84:87], v[68:71], v[48:63]
    buffer_load_dwordx4 v7, s[36:39], s30 offen lds
    ds_read_b128 v[68:71], v15 offset:0
    ds_read_b64_tr_b16 v[84:85], v6 offset:6144
    ds_read_b64_tr_b16 v[86:87], v6 offset:6656
    s_add_u32 m0, s52, 82944
    s_add_u32 s30, s49, 16384
    s_waitcnt lgkmcnt(5)
    v_mfma_f32_32x32x16_bf16 v[32:47], v[72:75], v[64:67], v[32:47]
    buffer_load_dwordx4 v8, s[36:39], s30 offen lds
    ds_read_b64_tr_b16 v[72:73], v5 offset:8192
    ds_read_b64_tr_b16 v[74:75], v5 offset:8704
    s_add_u32 m0, s52, 83968
    s_add_u32 s30, s49, 32768
    v_mfma_f32_32x32x16_bf16 v[48:63], v[76:79], v[64:67], v[48:63]
    buffer_load_dwordx4 v7, s[36:39], s30 offen lds
    ds_read_b128 v[64:67], v12 offset:16384
    ds_read_b64_tr_b16 v[76:77], v6 offset:8192
    ds_read_b64_tr_b16 v[78:79], v6 offset:8704
    s_add_u32 m0, s52, 84992
    s_add_u32 s30, s49, 49152
    s_add_u32 s49, s49, 128
    s_and_b32 s49, s49, 2047
    s_waitcnt lgkmcnt(5)
    v_mfma_f32_32x32x16_bf16 v[32:47], v[80:83], v[68:71], v[32:47]
    buffer_load_dwordx4 v8, s[36:39], s30 offen lds
    ds_read_b64_tr_b16 v[80:81], v5 offset:10240
    ds_read_b64_tr_b16 v[82:83], v5 offset:10752
    v_mfma_f32_32x32x16_bf16 v[48:63], v[84:87], v[68:71], v[48:63]
    ds_read_b128 v[68:71], v13 offset:16384
    ds_read_b64_tr_b16 v[84:85], v6 offset:10240
    ds_read_b64_tr_b16 v[86:87], v6 offset:10752
    s_waitcnt vmcnt(19)
    s_waitcnt vmcnt(12)
    s_cmp_lg_u32 s20, 0
    s_cbranch_scc1 L_w_7
    s_mov_b32 s30, 200000
    s_mov_b32 s31, 26214400
    v_cmp_eq_u32 vcc, s27, v10
    s_nop 0
    s_cmp_eq_u64 vcc, -1
    s_cbranch_scc1 L_pdone_9
L_poll_8:
    buffer_load_dword v10, v9, s[32:35], s31 offen sc1
    s_waitcnt vmcnt(0)
    v_cmp_eq_u32 vcc, s27, v10
    s_nop 0
    s_cmp_eq_u64 vcc, -1
    s_cbranch_scc1 L_pdone_9
    s_sleep 1
    s_sub_u32 s30, s30, 1
    s_cmp_lg_u32 s30, 0
    s_cbranch_scc1 L_poll_8
L_pdone_9:
L_w_7:
    s_barrier
    v_and_b32 v24, 31, v1
    v_lshlrev_b32 v24, 3, v24
    v_lshrrev_b32 v25, 5, v1
    v_lshlrev_b32 v25, 17, v25
    v_add_u32 v24, v24, v25
    v_lshlrev_b32 v25, 2, v1
    s_lshl_b32 s87, s25, 8
    s_add_u32 s87, s87, 25165824
    s_lshl_b32 s88, s22, 8
    s_add_u32 s88, s88, 25690112
    s_waitcnt lgkmcnt(5)
    v_mfma_f32_32x32x16_bf16 v[32:47], v[72:75], v[64:67], v[32:47]
    ds_read_b64_tr_b16 v[72:73], v5 offset:12288
    ds_read_b64_tr_b16 v[74:75], v5 offset:12800
    v_mfma_f32_32x32x16_bf16 v[48:63], v[76:79], v[64:67], v[48:63]
    buffer_load_dword v140, v25, s[32:35], s88 offen sc1
    s_add_u32 s88, s88, 4096
    ds_read_b128 v[64:67], v14 offset:16384
    ds_read_b64_tr_b16 v[76:77], v6 offset:12288
    ds_read_b64_tr_b16 v[78:79], v6 offset:12800
    buffer_load_dword v141, v25, s[32:35], s88 offen sc1
    s_add_u32 s88, s88, 4096
    s_waitcnt lgkmcnt(5)
    v_mfma_f32_32x32x16_bf16 v[32:47], v[80:83], v[68:71], v[32:47]
    buffer_load_dword v142, v25, s[32:35], s88 offen sc1
    s_add_u32 s88, s88, 4096
    ds_read_b64_tr_b16 v[80:81], v5 offset:14336
    ds_read_b64_tr_b16 v[82:83], v5 offset:14848
    v_mfma_f32_32x32x16_bf16 v[48:63], v[84:87], v[68:71], v[48:63]
    buffer_load_dword v143, v25, s[32:35], s88 offen sc1
    s_add_u32 s88, s88, 4096
    ds_read_b128 v[68:71], v15 offset:16384
    ds_read_b64_tr_b16 v[84:85], v6 offset:14336
    ds_read_b64_tr_b16 v[86:87], v6 offset:14848
    buffer_load_dword v144, v25, s[32:35], s88 offen sc1
    s_add_u32 s88, s88, 4096
    s_waitcnt lgkmcnt(5)
    v_mfma_f32_32x32x16_bf16 v[32:47], v[72:75], v[64:67], v[32:47]
    buffer_load_dword v145, v25, s[32:35], s88 offen sc1
    s_add_u32 s88, s88, 4096
    ds_read_b64_tr_b16 v[72:73], v5 offset:16384
    ds_read_b64_tr_b16 v[74:75], v5 offset:16896
    v_mfma_f32_32x32x16_bf16 v[48:63], v[76:79], v[64:67], v[48:63]
    buffer_load_dword v146, v25, s[32:35], s88 offen sc1
    s_add_u32 s88, s88, 4096
    ds_read_b128 v[64:67], v12 offset:32768
    ds_read_b64_tr_b16 v[76:77], v6 offset:16384
    ds_read_b64_tr_b16 v[78:79], v6 offset:16896
    buffer_load_dword v147, v25, s[32:35], s88 offen sc1
    s_add_u32 s88, s88, 4096
    s_waitcnt lgkmcnt(5)
    v_mfma_f32_32x32x16_bf16 v[32:47], v[80:83], v[68:71], v[32:47]
    buffer_load_dword v148, v25, s[32:35], s88 offen sc1
    s_add_u32 s88, s88, 4096
    ds_read_b64_tr_b16 v[80:81], v5 offset:18432
    ds_read_b64_tr_b16 v[82:83], v5 offset:18944
    v_mfma_f32_32x32x16_bf16 v[48:63], v[84:87], v[68:71], v[48:63]
    buffer_load_dword v149, v25, s[32:35], s88 offen sc1
    s_add_u32 s88, s88, 4096
    ds_read_b128 v[68:71], v13 offset:32768
    ds_read_b64_tr_b16 v[84:85], v6 offset:18432
    ds_read_b64_tr_b16 v[86:87], v6 offset:18944
    buffer_load_dword v150, v25, s[32:35], s88 offen sc1
    s_add_u32 s88, s88, 4096
    buffer_load_dword v151, v25, s[32:35], s88 offen sc1
    s_add_u32 s88, s88, 4096
    s_waitcnt vmcnt(25)
    s_barrier
    s_waitcnt lgkmcnt(5)
    v_mfma_f32_32x32x16_bf16 v[32:47], v[72:75], v[64:67], v[32:47]
    ds_read_b64_tr_b16 v[72:73], v5 offset:20480
    ds_read_b64_tr_b16 v[74:75], v5 offset:20992
    v_mfma_f32_32x32x16_bf16 v[48:63], v[76:79], v[64:67], v[48:63]
    buffer_load_dword v152, v25, s[32:35], s88 offen sc1
    s_add_u32 s88, s88, 4096
    ds_read_b128 v[64:67], v14 offset:32768
    ds_read_b64_tr_b16 v[76:77], v6 offset:20480
    ds_read_b64_tr_b16 v[78:79], v6 offset:20992
    buffer_load_dword v153, v25, s[32:35], s88 offen sc1
    s_add_u32 s88, s88, 4096
    s_waitcnt lgkmcnt(5)
    v_mfma_f32_32x32x16_bf16 v[32:47], v[80:83], v[68:71], v[32:47]
    buffer_load_dword v154, v25, s[32:35], s88 offen sc1
    s_add_u32 s88, s88, 4096
    ds_read_b64_tr_b16 v[80:81], v5 offset:22528
    ds_read_b64_tr_b16 v[82:83], v5 offset:23040
    v_mfma_f32_32x32x16_bf16 v[48:63], v[84:87], v[68:71], v[48:63]
    buffer_load_dword v155, v25, s[32:35], s88 offen sc1
    ds_read_b128 v[68:71], v15 offset:32768
    ds_read_b64_tr_b16 v[84:85], v6 offset:22528
    ds_read_b64_tr_b16 v[86:87], v6 offset:23040
    buffer_load_dwordx2 v[124:125], v24, s[32:35], s87 offen sc1
    s_add_u32 s87, s87, 16384
    s_waitcnt lgkmcnt(5)
    v_mfma_f32_32x32x16_bf16 v[32:47], v[72:75], v[64:67], v[32:47]
    buffer_load_dwordx2 v[126:127], v24, s[32:35], s87 offen sc1
    s_add_u32 s87, s87, 16384
    ds_read_b64_tr_b16 v[72:73], v5 offset:24576
    ds_read_b64_tr_b16 v[74:75], v5 offset:25088
    v_mfma_f32_32x32x16_bf16 v[48:63], v[76:79], v[64:67], v[48:63]
    buffer_load_dwordx2 v[128:129], v24, s[32:35], s87 offen sc1
    s_add_u32 s87, s87, 16384
    ds_read_b128 v[64:67], v12 offset:49152
    ds_read_b64_tr_b16 v[76:77], v6 offset:24576
    ds_read_b64_tr_b16 v[78:79], v6 offset:25088
    buffer_load_dwordx2 v[130:131], v24, s[32:35], s87 offen sc1
    s_add_u32 s87, s87, 16384
    s_waitcnt lgkmcnt(5)
    v_mfma_f32_32x32x16_bf16 v[32:47], v[80:83], v[68:71], v[32:47]
    buffer_load_dwordx2 v[132:133], v24, s[32:35], s87 offen sc1
    s_add_u32 s87, s87, 16384
    ds_read_b64_tr_b16 v[80:81], v5 offset:26624
    ds_read_b64_tr_b16 v[82:83], v5 offset:27136
    v_mfma_f32_32x32x16_bf16 v[48:63], v[84:87], v[68:71], v[48:63]
    buffer_load_dwordx2 v[134:135], v24, s[32:35], s87 offen sc1
    s_add_u32 s87, s87, 16384
    ds_read_b128 v[68:71], v13 offset:49152
    ds_read_b64_tr_b16 v[84:85], v6 offset:26624
    ds_read_b64_tr_b16 v[86:87], v6 offset:27136
    buffer_load_dwordx2 v[136:137], v24, s[32:35], s87 offen sc1
    s_add_u32 s87, s87, 16384
    buffer_load_dwordx2 v[138:139], v24, s[32:35], s87 offen sc1
    s_waitcnt vmcnt(30)
    s_barrier
    s_waitcnt lgkmcnt(5)
    v_mfma_f32_32x32x16_bf16 v[32:47], v[72:75], v[64:67], v[32:47]
    ds_read_b64_tr_b16 v[72:73], v5 offset:28672
    ds_read_b64_tr_b16 v[74:75], v5 offset:29184
    s_add_u32 s86, s48, 0
    s_and_b32 s86, s86, 15
    s_lshl_b32 s86, s86, 17
    s_add_u32 m0, s53, 0
    s_add_u32 s30, s86, s51
    v_mfma_f32_32x32x16_bf16 v[48:63], v[76:79], v[64:67], v[48:63]
    buffer_load_dwordx4 v4, s[44:47], s30 offen lds
    ds_read_b128 v[64:67], v14 offset:49152
    ds_read_b64_tr_b16 v[76:77], v6 offset:28672
    ds_read_b64_tr_b16 v[78:79], v6 offset:29184
    s_add_u32 m0, s53, 1024
    s_add_u32 s30, s86, s51
    s_add_u32 s30, s30, 16384
    buffer_load_dwordx4 v4, s[44:47], s30 offen lds
    s_add_u32 s86, s48, 1
    s_and_b32 s86, s86, 15
    s_lshl_b32 s86, s86, 17
    s_add_u32 m0, s53, 8192
    s_add_u32 s30, s86, s51
    s_waitcnt lgkmcnt(5)
    v_mfma_f32_32x32x16_bf16 v[32:47], v[80:83], v[68:71], v[32:47]
    buffer_load_dwordx4 v4, s[44:47], s30 offen lds
    ds_read_b64_tr_b16 v[80:81], v5 offset:30720
    ds_read_b64_tr_b16 v[82:83], v5 offset:31232
    s_add_u32 m0, s53, 9216
    s_add_u32 s30, s86, s51
    s_add_u32 s30, s30, 16384
    v_mfma_f32_32x32x16_bf16 v[48:63], v[84:87], v[68:71], v[48:63]
    buffer_load_dwordx4 v4, s[44:47], s30 offen lds
    ds_read_b128 v[68:71], v15 offset:49152
    ds_read_b64_tr_b16 v[84:85], v6 offset:30720
    ds_read_b64_tr_b16 v[86:87], v6 offset:31232
    s_add_u32 s86, s48, 8
    s_and_b32 s86, s86, 15
    s_lshl_b32 s86, s86, 17
    s_add_u32 m0, s53, 98304
    s_add_u32 s30, s86, s51
    buffer_load_dwordx4 v4, s[44:47], s30 offen lds
    s_add_u32 m0, s53, 99328
    s_add_u32 s30, s86, s51
    s_add_u32 s30, s30, 16384
    s_waitcnt lgkmcnt(5)
    v_mfma_f32_32x32x16_bf16 v[32:47], v[72:75], v[64:67], v[32:47]
    buffer_load_dwordx4 v4, s[44:47], s30 offen lds
    ds_read_b64_tr_b16 v[72:73], v5 offset:32768
    ds_read_b64_tr_b16 v[74:75], v5 offset:33280
    s_add_u32 s86, s48, 2
    s_and_b32 s86, s86, 15
    s_lshl_b32 s86, s86, 17
    s_add_u32 m0, s53, 16384
    s_add_u32 s30, s86, s51
    v_mfma_f32_32x32x16_bf16 v[48:63], v[76:79], v[64:67], v[48:63]
    buffer_load_dwordx4 v4, s[44:47], s30 offen lds
    ds_read_b128 v[64:67], v16 offset:0
    ds_read_b64_tr_b16 v[76:77], v6 offset:32768
    ds_read_b64_tr_b16 v[78:79], v6 offset:33280
    s_add_u32 m0, s53, 17408
    s_add_u32 s30, s86, s51
    s_add_u32 s30, s30, 16384
    buffer_load_dwordx4 v4, s[44:47], s30 offen lds
    s_add_u32 s86, s48, 3
    s_and_b32 s86, s86, 15
    s_lshl_b32 s86, s86, 17
    s_add_u32 m0, s53, 24576
    s_add_u32 s30, s86, s51
    s_waitcnt lgkmcnt(5)
    v_mfma_f32_32x32x16_bf16 v[32:47], v[80:83], v[68:71], v[32:47]
    buffer_load_dwordx4 v4, s[44:47], s30 offen lds
    ds_read_b64_tr_b16 v[80:81], v5 offset:34816
    ds_read_b64_tr_b16 v[82:83], v5 offset:35328
    s_add_u32 m0, s53, 25600
    s_add_u32 s30, s86, s51
    s_add_u32 s30, s30, 16384
    v_mfma_f32_32x32x16_bf16 v[48:63], v[84:87], v[68:71], v[48:63]
    buffer_load_dwordx4 v4, s[44:47], s30 offen lds
    ds_read_b128 v[68:71], v17 offset:0
    ds_read_b64_tr_b16 v[84:85], v6 offset:34816
    ds_read_b64_tr_b16 v[86:87], v6 offset:35328
    s_add_u32 s86, s48, 9
    s_and_b32 s86, s86, 15
    s_lshl_b32 s86, s86, 17
    s_add_u32 m0, s53, 106496
    s_add_u32 s30, s86, s51
    buffer_load_dwordx4 v4, s[44:47], s30 offen lds
    s_add_u32 m0, s53, 107520
    s_add_u32 s30, s86, s51
    s_add_u32 s30, s30, 16384
    buffer_load_dwordx4 v4, s[44:47], s30 offen lds
    s_waitcnt vmcnt(36)
    s_barrier
    s_waitcnt lgkmcnt(5)
    v_mfma_f32_32x32x16_bf16 v[32:47], v[72:75], v[64:67], v[32:47]
    ds_read_b64_tr_b16 v[72:73], v5 offset:36864
    ds_read_b64_tr_b16 v[74:75], v5 offset:37376
    s_waitcnt vmcnt(12)
    v_add_f32 v140, v140, v141
    v_add_f32 v140, v140, v142
    v_add_f32 v140, v140, v143
    v_add_f32 v140, v140, v144
    v_add_f32 v140, v140, v145
    v_mfma_f32_32x32x16_bf16 v[48:63], v[76:79], v[64:67], v[48:63]
    ds_read_b128 v[64:67], v18 offset:0
    ds_read_b64_tr_b16 v[76:77], v6 offset:36864
    ds_read_b64_tr_b16 v[78:79], v6 offset:37376
    v_add_f32 v140, v140, v146
    v_add_f32 v140, v140, v147
    v_add_f32 v140, v140, v148
    v_add_f32 v140, v140, v149
    v_add_f32 v140, v140, v150
    v_add_f32 v140, v140, v151
    s_waitcnt lgkmcnt(5)
    v_mfma_f32_32x32x16_bf16 v[32:47], v[80:83], v[68:71], v[32:47]
    ds_read_b64_tr_b16 v[80:81], v5 offset:38912
    ds_read_b64_tr_b16 v[82:83], v5 offset:39424
    v_add_f32 v140, v140, v152
    v_add_f32 v140, v140, v153
    v_add_f32 v140, v140, v154
    v_add_f32 v140, v140, v155
    s_lshl_b32 s54, s20, 8
    s_add_u32 s54, s54, 149504
    v_mfma_f32_32x32x16_bf16 v[48:63], v[84:87], v[68:71], v[48:63]
    ds_read_b128 v[68:71], v19 offset:0
    ds_read_b64_tr_b16 v[84:85], v6 offset:38912
    ds_read_b64_tr_b16 v[86:87], v6 offset:39424
    v_lshlrev_b32 v20, 2, v1
    v_add_u32 v20, s54, v20
    ds_write_b32 v20, v140
    v_add_f32 v124, v124, v126
    v_add_f32 v125, v125, v127
    v_add_f32 v124, v124, v128
    s_waitcnt lgkmcnt(6)
    v_mfma_f32_32x32x16_bf16 v[32:47], v[72:75], v[64:67], v[32:47]
    ds_read_b64_tr_b16 v[72:73], v5 offset:40960
    ds_read_b64_tr_b16 v[74:75], v5 offset:41472
    v_add_f32 v125, v125, v129
    v_add_f32 v124, v124, v130
    v_add_f32 v125, v125, v131
    v_add_f32 v124, v124, v132
    v_add_f32 v125, v125, v133
    v_add_f32 v124, v124, v134
    v_mfma_f32_32x32x16_bf16 v[48:63], v[76:79], v[64:67], v[48:63]
    ds_read_b128 v[64:67], v16 offset:16384
    ds_read_b64_tr_b16 v[76:77], v6 offset:40960
    ds_read_b64_tr_b16 v[78:79], v6 offset:41472
    v_add_f32 v125, v125, v135
    v_add_f32 v124, v124, v136
    v_add_f32 v125, v125, v137
    v_add_f32 v124, v124, v138
    v_add_f32 v125, v125, v139
    v_mov_b32 v21, v124
    s_waitcnt lgkmcnt(6)
    v_mfma_f32_32x32x16_bf16 v[32:47], v[80:83], v[68:71], v[32:47]
    ds_read_b64_tr_b16 v[80:81], v5 offset:43008
    ds_read_b64_tr_b16 v[82:83], v5 offset:43520
    v_permlane32_swap_b32 v124, v21
    v_add_f32 v124, v124, v21
    v_mov_b32 v23, v125
    s_nop 1
    v_permlane32_swap_b32 v125, v23
    v_add_f32 v125, v125, v23
    v_mul_f32 v124, 0x3a800000, v124
    v_mfma_f32_32x32x16_bf16 v[48:63], v[84:87], v[68:71], v[48:63]
    ds_read_b128 v[68:71], v17 offset:16384
    ds_read_b64_tr_b16 v[84:85], v6 offset:43008
    ds_read_b64_tr_b16 v[86:87], v6 offset:43520
    v_mul_f32 v125, 0x3a800000, v125
    v_fma_f32 v125, -v124, v124, v125
    v_add_f32 v125, 0x3727c5ac, v125
    v_rsq_f32 v26, v125
    v_sub_f32 v24, 0, v124
    v_mov_b32 v28, 0xc0135761
    s_barrier
    s_waitcnt lgkmcnt(5)
    v_mfma_f32_32x32x16_bf16 v[32:47], v[72:75], v[64:67], v[32:47]
    ds_read_b64_tr_b16 v[72:73], v5 offset:45056
    ds_read_b64_tr_b16 v[74:75], v5 offset:45568
    v_mov_b32 v30, 0xbdd2d3e8
    v_mov_b32 v22, 1.0
    v_lshrrev_b32 v20, 5, v1
    v_lshlrev_b32 v20, 4, v20
    v_add_u32 v20, s54, v20
    s_waitcnt lgkmcnt(12)
    v_mfma_f32_32x32x16_bf16 v[48:63], v[76:79], v[64:67], v[48:63]
    ds_read_b128 v[64:67], v18 offset:16384
    ds_read_b64_tr_b16 v[76:77], v6 offset:45056
    ds_read_b64_tr_b16 v[78:79], v6 offset:45568
    ds_read_b128 v[176:179], v20 offset:0
    ds_read_b128 v[180:183], v20 offset:32
    ds_read_b128 v[184:187], v20 offset:64
    ds_read_b128 v[188:191], v20 offset:96
    ds_read_b128 v[192:195], v20 offset:128
    ds_read_b128 v[196:199], v20 offset:160
    s_waitcnt lgkmcnt(11)
    v_mfma_f32_32x32x16_bf16 v[32:47], v[80:83], v[68:71], v[32:47]
    ds_read_b64_tr_b16 v[80:81], v5 offset:47104
    ds_read_b64_tr_b16 v[82:83], v5 offset:47616
    ds_read_b128 v[200:203], v20 offset:192
    ds_read_b128 v[204:207], v20 offset:224
    s_lshr_b32 s87, s22, 2
    s_lshr_b32 s88, s87, 1
    s_add_u32 s88, s88, 1
    s_and_b32 s87, s87, 1
    v_mfma_f32_32x32x16_bf16 v[48:63], v[84:87], v[68:71], v[48:63]
    ds_read_b128 v[68:71], v19 offset:16384
    ds_read_b64_tr_b16 v[84:85], v6 offset:47104
    ds_read_b64_tr_b16 v[86:87], v6 offset:47616
    s_sub_u32 s57, 0, s88
    s_cmp_eq_u32 s87, 0
    s_cmp_eq_u32 s87, 0
    s_cselect_b32 s88, s88, s57
    s_lshl_b32 s87, s25, 5
    s_add_u32 s87, s87, s88
    v_and_b32 v22, 31, v1
    s_waitcnt lgkmcnt(13)
    v_mfma_f32_32x32x16_bf16 v[32:47], v[72:75], v[64:67], v[32:47]
    v_add_u32 v22, s87, v22
    v_mov_b32 v23, 2048
    v_cmp_gt_u32 s[58:59], v23, v22
    v_and_b32 v22, 2047, v22
    v_lshrrev_b32 v21, 5, v22
    v_lshlrev_b32 v21, 16, v21
    v_mfma_f32_32x32x16_bf16 v[48:63], v[76:79], v[64:67], v[48:63]
    v_and_b32 v22, 31, v22
    v_and_b32 v23, 32, v1
    v_add_u32 v22, v22, v23
    v_lshlrev_b32 v22, 4, v22
    v_add_u32 v21, v22, v21
    s_lshl_b32 s57, s22, 12
    s_waitcnt lgkmcnt(0)
    v_mfma_f32_32x32x16_bf16 v[32:47], v[80:83], v[68:71], v[32:47]
    v_mov_b32 v22, 1.0
    v_mfma_f32_32x32x16_bf16 v[48:63], v[84:87], v[68:71], v[48:63]
    s_barrier
    s_lshl_b32 s55, s22, 7
    s_lshl_b32 s56, s20, 12
    s_add_u32 s56, s56, 131072
    s_lshl_b32 s30, s25, 16
    s_add_u32 s92, s4, s30
    s_addc_u32 s93, s5, 0
    s_and_b32 s93, s93, 0xffff
    s_mov_b32 s94, 65536
    s_mov_b32 s95, 0x20000
    s_waitcnt lgkmcnt(3)
    v_pk_fma_f32 v[112:113], v[176:177], v[24:25], v[32:33] op_sel_hi:[1,0,1]
    v_pk_fma_f32 v[116:117], v[178:179], v[24:25], v[34:35] op_sel_hi:[1,0,1]
    v_pk_fma_f32 v[120:121], v[180:181], v[24:25], v[36:37] op_sel_hi:[1,0,1]
    v_pk_fma_f32 v[124:125], v[182:183], v[24:25], v[38:39] op_sel_hi:[1,0,1]
    v_pk_mul_f32 v[112:113], v[112:113], v[26:27] op_sel_hi:[1,0]
    v_pk_mul_f32 v[116:117], v[116:117], v[26:27] op_sel_hi:[1,0]
    v_pk_mul_f32 v[120:121], v[120:121], v[26:27] op_sel_hi:[1,0]
    v_pk_mul_f32 v[124:125], v[124:125], v[26:27] op_sel_hi:[1,0]
    v_pk_mul_f32 v[114:115], v[112:113], v[112:113]
    v_pk_mul_f32 v[118:119], v[116:117], v[116:117]
    v_pk_mul_f32 v[122:123], v[120:121], v[120:121]
    v_pk_mul_f32 v[126:127], v[124:125], v[124:125]
    v_pk_fma_f32 v[114:115], v[114:115], v[30:31], v[28:29] op_sel_hi:[1,0,0]
    v_pk_fma_f32 v[118:119], v[118:119], v[30:31], v[28:29] op_sel_hi:[1,0,0]
    v_pk_fma_f32 v[122:123], v[122:123], v[30:31], v[28:29] op_sel_hi:[1,0,0]
    v_pk_fma_f32 v[126:127], v[126:127], v[30:31], v[28:29] op_sel_hi:[1,0,0]
    v_pk_mul_f32 v[114:115], v[114:115], v[112:113]
    v_pk_mul_f32 v[118:119], v[118:119], v[116:117]
    v_pk_mul_f32 v[122:123], v[122:123], v[120:121]
    v_pk_mul_f32 v[126:127], v[126:127], v[124:125]
    v_exp_f32 v114, v114
    v_exp_f32 v115, v115
    v_exp_f32 v118, v118
    v_exp_f32 v119, v119
    v_exp_f32 v122, v122
    v_exp_f32 v123, v123
    v_exp_f32 v126, v126
    v_exp_f32 v127, v127
    v_pk_add_f32 v[114:115], v[114:115], v[22:23] op_sel_hi:[1,0]
    v_pk_add_f32 v[118:119], v[118:119], v[22:23] op_sel_hi:[1,0]
    v_pk_add_f32 v[122:123], v[122:123], v[22:23] op_sel_hi:[1,0]
    v_pk_add_f32 v[126:127], v[126:127], v[22:23] op_sel_hi:[1,0]
    v_rcp_f32 v114, v114
    v_rcp_f32 v115, v115
    v_rcp_f32 v118, v118
    v_rcp_f32 v119, v119
    v_rcp_f32 v122, v122
    v_rcp_f32 v123, v123
    v_rcp_f32 v126, v126
    v_rcp_f32 v127, v127
    v_pk_mul_f32 v[112:113], v[112:113], v[114:115]
    v_pk_mul_f32 v[116:117], v[116:117], v[118:119]
    v_pk_mul_f32 v[120:121], v[120:121], v[122:123]
    v_pk_mul_f32 v[124:125], v[124:125], v[126:127]
    v_cvt_pk_bf16_f32 v96, v112, v113
    v_cvt_pk_bf16_f32 v97, v116, v117
    v_cvt_pk_bf16_f32 v98, v120, v121
    v_cvt_pk_bf16_f32 v99, v124, v125
    v_cndmask_b32 v96, 0, v96, s[58:59]
    v_cndmask_b32 v97, 0, v97, s[58:59]
    v_cndmask_b32 v98, 0, v98, s[58:59]
    v_cndmask_b32 v99, 0, v99, s[58:59]
    buffer_store_dwordx4 v[96:99], v21, s[32:35], s57 offen offset:0 sc1
    v_pk_fma_f32 v[112:113], v[184:185], v[24:25], v[40:41] op_sel_hi:[1,0,1]
    v_pk_fma_f32 v[116:117], v[186:187], v[24:25], v[42:43] op_sel_hi:[1,0,1]
    v_pk_fma_f32 v[120:121], v[188:189], v[24:25], v[44:45] op_sel_hi:[1,0,1]
    v_pk_fma_f32 v[124:125], v[190:191], v[24:25], v[46:47] op_sel_hi:[1,0,1]
    v_pk_mul_f32 v[112:113], v[112:113], v[26:27] op_sel_hi:[1,0]
    v_pk_mul_f32 v[116:117], v[116:117], v[26:27] op_sel_hi:[1,0]
    v_pk_mul_f32 v[120:121], v[120:121], v[26:27] op_sel_hi:[1,0]
    v_pk_mul_f32 v[124:125], v[124:125], v[26:27] op_sel_hi:[1,0]
    v_pk_mul_f32 v[114:115], v[112:113], v[112:113]
    v_pk_mul_f32 v[118:119], v[116:117], v[116:117]
    v_pk_mul_f32 v[122:123], v[120:121], v[120:121]
    v_pk_mul_f32 v[126:127], v[124:125], v[124:125]
    v_pk_fma_f32 v[114:115], v[114:115], v[30:31], v[28:29] op_sel_hi:[1,0,0]
    v_pk_fma_f32 v[118:119], v[118:119], v[30:31], v[28:29] op_sel_hi:[1,0,0]
    v_pk_fma_f32 v[122:123], v[122:123], v[30:31], v[28:29] op_sel_hi:[1,0,0]
    v_pk_fma_f32 v[126:127], v[126:127], v[30:31], v[28:29] op_sel_hi:[1,0,0]
    v_pk_mul_f32 v[114:115], v[114:115], v[112:113]
    v_pk_mul_f32 v[118:119], v[118:119], v[116:117]
    v_pk_mul_f32 v[122:123], v[122:123], v[120:121]
    v_pk_mul_f32 v[126:127], v[126:127], v[124:125]
    v_exp_f32 v114, v114
    v_exp_f32 v115, v115
    v_exp_f32 v118, v118
    v_exp_f32 v119, v119
    v_exp_f32 v122, v122
    v_exp_f32 v123, v123
    v_exp_f32 v126, v126
    v_exp_f32 v127, v127
    v_pk_add_f32 v[114:115], v[114:115], v[22:23] op_sel_hi:[1,0]
    v_pk_add_f32 v[118:119], v[118:119], v[22:23] op_sel_hi:[1,0]
    v_pk_add_f32 v[122:123], v[122:123], v[22:23] op_sel_hi:[1,0]
    v_pk_add_f32 v[126:127], v[126:127], v[22:23] op_sel_hi:[1,0]
    v_rcp_f32 v114, v114
    v_rcp_f32 v115, v115
    v_rcp_f32 v118, v118
    v_rcp_f32 v119, v119
    v_rcp_f32 v122, v122
    v_rcp_f32 v123, v123
    v_rcp_f32 v126, v126
    v_rcp_f32 v127, v127
    v_pk_mul_f32 v[112:113], v[112:113], v[114:115]
    v_pk_mul_f32 v[116:117], v[116:117], v[118:119]
    v_pk_mul_f32 v[120:121], v[120:121], v[122:123]
    v_pk_mul_f32 v[124:125], v[124:125], v[126:127]
    v_cvt_pk_bf16_f32 v100, v112, v113
    v_cvt_pk_bf16_f32 v101, v116, v117
    v_cvt_pk_bf16_f32 v102, v120, v121
    v_cvt_pk_bf16_f32 v103, v124, v125
    v_cndmask_b32 v100, 0, v100, s[58:59]
    v_cndmask_b32 v101, 0, v101, s[58:59]
    v_cndmask_b32 v102, 0, v102, s[58:59]
    v_cndmask_b32 v103, 0, v103, s[58:59]
    buffer_store_dwordx4 v[100:103], v21, s[32:35], s57 offen offset:1024 sc1
    v_pk_fma_f32 v[112:113], v[192:193], v[24:25], v[48:49] op_sel_hi:[1,0,1]
    v_pk_fma_f32 v[116:117], v[194:195], v[24:25], v[50:51] op_sel_hi:[1,0,1]
    v_pk_fma_f32 v[120:121], v[196:197], v[24:25], v[52:53] op_sel_hi:[1,0,1]
    v_pk_fma_f32 v[124:125], v[198:199], v[24:25], v[54:55] op_sel_hi:[1,0,1]
    v_pk_mul_f32 v[112:113], v[112:113], v[26:27] op_sel_hi:[1,0]
    v_pk_mul_f32 v[116:117], v[116:117], v[26:27] op_sel_hi:[1,0]
    v_pk_mul_f32 v[120:121], v[120:121], v[26:27] op_sel_hi:[1,0]
    v_pk_mul_f32 v[124:125], v[124:125], v[26:27] op_sel_hi:[1,0]
    v_pk_mul_f32 v[114:115], v[112:113], v[112:113]
    v_pk_mul_f32 v[118:119], v[116:117], v[116:117]
    v_pk_mul_f32 v[122:123], v[120:121], v[120:121]
    v_pk_mul_f32 v[126:127], v[124:125], v[124:125]
    v_pk_fma_f32 v[114:115], v[114:115], v[30:31], v[28:29] op_sel_hi:[1,0,0]
    v_pk_fma_f32 v[118:119], v[118:119], v[30:31], v[28:29] op_sel_hi:[1,0,0]
    v_pk_fma_f32 v[122:123], v[122:123], v[30:31], v[28:29] op_sel_hi:[1,0,0]
    v_pk_fma_f32 v[126:127], v[126:127], v[30:31], v[28:29] op_sel_hi:[1,0,0]
    v_pk_mul_f32 v[114:115], v[114:115], v[112:113]
    v_pk_mul_f32 v[118:119], v[118:119], v[116:117]
    v_pk_mul_f32 v[122:123], v[122:123], v[120:121]
    v_pk_mul_f32 v[126:127], v[126:127], v[124:125]
    v_exp_f32 v114, v114
    v_exp_f32 v115, v115
    v_exp_f32 v118, v118
    v_exp_f32 v119, v119
    v_exp_f32 v122, v122
    v_exp_f32 v123, v123
    v_exp_f32 v126, v126
    v_exp_f32 v127, v127
    v_pk_add_f32 v[114:115], v[114:115], v[22:23] op_sel_hi:[1,0]
    v_pk_add_f32 v[118:119], v[118:119], v[22:23] op_sel_hi:[1,0]
    v_pk_add_f32 v[122:123], v[122:123], v[22:23] op_sel_hi:[1,0]
    v_pk_add_f32 v[126:127], v[126:127], v[22:23] op_sel_hi:[1,0]
    v_rcp_f32 v114, v114
    v_rcp_f32 v115, v115
    v_rcp_f32 v118, v118
    v_rcp_f32 v119, v119
    v_rcp_f32 v122, v122
    v_rcp_f32 v123, v123
    v_rcp_f32 v126, v126
    v_rcp_f32 v127, v127
    v_pk_mul_f32 v[112:113], v[112:113], v[114:115]
    v_pk_mul_f32 v[116:117], v[116:117], v[118:119]
    v_pk_mul_f32 v[120:121], v[120:121], v[122:123]
    v_pk_mul_f32 v[124:125], v[124:125], v[126:127]
    v_cvt_pk_bf16_f32 v104, v112, v113
    v_cvt_pk_bf16_f32 v105, v116, v117
    v_cvt_pk_bf16_f32 v106, v120, v121
    v_cvt_pk_bf16_f32 v107, v124, v125
    v_cndmask_b32 v104, 0, v104, s[58:59]
    v_cndmask_b32 v105, 0, v105, s[58:59]
    v_cndmask_b32 v106, 0, v106, s[58:59]
    v_cndmask_b32 v107, 0, v107, s[58:59]
    buffer_store_dwordx4 v[104:107], v21, s[32:35], s57 offen offset:2048 sc1
    v_pk_fma_f32 v[112:113], v[200:201], v[24:25], v[56:57] op_sel_hi:[1,0,1]
    v_pk_fma_f32 v[116:117], v[202:203], v[24:25], v[58:59] op_sel_hi:[1,0,1]
    v_pk_fma_f32 v[120:121], v[204:205], v[24:25], v[60:61] op_sel_hi:[1,0,1]
    v_pk_fma_f32 v[124:125], v[206:207], v[24:25], v[62:63] op_sel_hi:[1,0,1]
    v_pk_mul_f32 v[112:113], v[112:113], v[26:27] op_sel_hi:[1,0]
    v_pk_mul_f32 v[116:117], v[116:117], v[26:27] op_sel_hi:[1,0]
    v_pk_mul_f32 v[120:121], v[120:121], v[26:27] op_sel_hi:[1,0]
    v_pk_mul_f32 v[124:125], v[124:125], v[26:27] op_sel_hi:[1,0]
    v_pk_mul_f32 v[114:115], v[112:113], v[112:113]
    v_pk_mul_f32 v[118:119], v[116:117], v[116:117]
    v_pk_mul_f32 v[122:123], v[120:121], v[120:121]
    v_pk_mul_f32 v[126:127], v[124:125], v[124:125]
    v_pk_fma_f32 v[114:115], v[114:115], v[30:31], v[28:29] op_sel_hi:[1,0,0]
    v_pk_fma_f32 v[118:119], v[118:119], v[30:31], v[28:29] op_sel_hi:[1,0,0]
    v_pk_fma_f32 v[122:123], v[122:123], v[30:31], v[28:29] op_sel_hi:[1,0,0]
    v_pk_fma_f32 v[126:127], v[126:127], v[30:31], v[28:29] op_sel_hi:[1,0,0]
    v_pk_mul_f32 v[114:115], v[114:115], v[112:113]
    v_pk_mul_f32 v[118:119], v[118:119], v[116:117]
    v_pk_mul_f32 v[122:123], v[122:123], v[120:121]
    v_pk_mul_f32 v[126:127], v[126:127], v[124:125]
    v_exp_f32 v114, v114
    v_exp_f32 v115, v115
    v_exp_f32 v118, v118
    v_exp_f32 v119, v119
    v_exp_f32 v122, v122
    v_exp_f32 v123, v123
    v_exp_f32 v126, v126
    v_exp_f32 v127, v127
    v_pk_add_f32 v[114:115], v[114:115], v[22:23] op_sel_hi:[1,0]
    v_pk_add_f32 v[118:119], v[118:119], v[22:23] op_sel_hi:[1,0]
    v_pk_add_f32 v[122:123], v[122:123], v[22:23] op_sel_hi:[1,0]
    v_pk_add_f32 v[126:127], v[126:127], v[22:23] op_sel_hi:[1,0]
    v_rcp_f32 v114, v114
    v_rcp_f32 v115, v115
    v_rcp_f32 v118, v118
    v_rcp_f32 v119, v119
    v_rcp_f32 v122, v122
    v_rcp_f32 v123, v123
    v_rcp_f32 v126, v126
    v_rcp_f32 v127, v127
    v_pk_mul_f32 v[112:113], v[112:113], v[114:115]
    v_pk_mul_f32 v[116:117], v[116:117], v[118:119]
    v_pk_mul_f32 v[120:121], v[120:121], v[122:123]
    v_pk_mul_f32 v[124:125], v[124:125], v[126:127]
    v_cvt_pk_bf16_f32 v108, v112, v113
    v_cvt_pk_bf16_f32 v109, v116, v117
    v_cvt_pk_bf16_f32 v110, v120, v121
    v_cvt_pk_bf16_f32 v111, v124, v125
    v_cndmask_b32 v108, 0, v108, s[58:59]
    v_cndmask_b32 v109, 0, v109, s[58:59]
    v_cndmask_b32 v110, 0, v110, s[58:59]
    v_cndmask_b32 v111, 0, v111, s[58:59]
    buffer_store_dwordx4 v[108:111], v21, s[32:35], s57 offen offset:3072 sc1
    v_lshrrev_b32 v20, 4, v1
    v_cmp_eq_u32 vcc, 3, v20
    v_mov_b32 v21, 1
    s_nop 0
    v_cndmask_b32 v20, v20, v21, vcc
    s_add_u32 s28, s21, 15
    v_add_u32 v20, s28, v20
    v_and_b32 v20, 15, v20
    v_add_u32 v20, 32, v20
    v_lshlrev_b32 v20, 11, v20
    v_and_b32 v9, 15, v1
    v_lshlrev_b32 v9, 7, v9
    v_add_u32 v9, v9, v20
    v_mov_b32 v20, 0x7ffffff0
    v_cmp_gt_u32 vcc, 64, v0
    s_nop 1
    v_cndmask_b32 v9, v20, v9, vcc
    s_waitcnt vmcnt(0)
    s_barrier
    s_add_u32 s28, s21, 32
    s_lshl_b32 s28, s28, 4
    s_add_u32 s28, s28, s22
    s_lshl_b32 s28, s28, 7
    s_add_u32 s28, s28, 26214400
    v_mov_b32 v20, s27
    buffer_store_dword v20, v234, s[32:35], s28 offen sc1
    s_add_u32 s86, s48, 4
    s_and_b32 s86, s86, 15
    s_lshl_b32 s86, s86, 17
    s_add_u32 m0, s53, 32768
    s_add_u32 s30, s86, s51
    buffer_load_dwordx4 v4, s[44:47], s30 offen lds
    s_add_u32 m0, s53, 33792
    s_add_u32 s30, s86, s51
    s_add_u32 s30, s30, 16384
    buffer_load_dwordx4 v4, s[44:47], s30 offen lds
    s_add_u32 s86, s48, 5
    s_and_b32 s86, s86, 15
    s_lshl_b32 s86, s86, 17
    s_add_u32 m0, s53, 40960
    s_add_u32 s30, s86, s51
    buffer_load_dwordx4 v4, s[44:47], s30 offen lds
    s_add_u32 m0, s53, 41984
    s_add_u32 s30, s86, s51
    s_add_u32 s30, s30, 16384
    buffer_load_dwordx4 v4, s[44:47], s30 offen lds
    s_add_u32 s86, s48, 6
    s_and_b32 s86, s86, 15
    s_lshl_b32 s86, s86, 17
    s_add_u32 m0, s53, 49152
    s_add_u32 s30, s86, s51
    buffer_load_dwordx4 v4, s[44:47], s30 offen lds
    s_add_u32 m0, s53, 50176
    s_add_u32 s30, s86, s51
    s_add_u32 s30, s30, 16384
    buffer_load_dwordx4 v4, s[44:47], s30 offen lds
    s_add_u32 s86, s48, 7
    s_and_b32 s86, s86, 15
    s_lshl_b32 s86, s86, 17
    s_add_u32 m0, s53, 57344
    s_add_u32 s30, s86, s51
    buffer_load_dwordx4 v4, s[44:47], s30 offen lds
    s_add_u32 m0, s53, 58368
    s_add_u32 s30, s86, s51
    s_add_u32 s30, s30, 16384
    buffer_load_dwordx4 v4, s[44:47], s30 offen lds
    s_add_u32 s86, s48, 10
    s_and_b32 s86, s86, 15
    s_lshl_b32 s86, s86, 17
    s_add_u32 m0, s53, 114688
    s_add_u32 s30, s86, s51
    buffer_load_dwordx4 v4, s[44:47], s30 offen lds
    s_add_u32 m0, s53, 115712
    s_add_u32 s30, s86, s51
    s_add_u32 s30, s30, 16384
    buffer_load_dwordx4 v4, s[44:47], s30 offen lds
    s_add_u32 s86, s48, 11
    s_and_b32 s86, s86, 15
    s_lshl_b32 s86, s86, 17
    s_add_u32 m0, s53, 122880
    s_add_u32 s30, s86, s51
    buffer_load_dwordx4 v4, s[44:47], s30 offen lds
    s_add_u32 m0, s53, 123904
    s_add_u32 s30, s86, s51
    s_add_u32 s30, s30, 16384
    buffer_load_dwordx4 v4, s[44:47], s30 offen lds
    s_add_u32 s86, s48, 12
    s_and_b32 s86, s86, 15
    s_lshl_b32 s86, s86, 17
    s_add_u32 m0, s53, 65536
    s_add_u32 s30, s86, s51
    buffer_load_dwordx4 v4, s[44:47], s30 offen lds
    s_add_u32 m0, s53, 66560
    s_add_u32 s30, s86, s51
    s_add_u32 s30, s30, 16384
    buffer_load_dwordx4 v4, s[44:47], s30 offen lds
    s_add_u32 s86, s48, 13
    s_and_b32 s86, s86, 15
    s_lshl_b32 s86, s86, 17
    s_add_u32 m0, s53, 73728
    s_add_u32 s30, s86, s51
    buffer_load_dwordx4 v4, s[44:47], s30 offen lds
    s_add_u32 m0, s53, 74752
    s_add_u32 s30, s86, s51
    s_add_u32 s30, s30, 16384
    buffer_load_dwordx4 v4, s[44:47], s30 offen lds
    s_cmp_lg_u32 s20, 0
    s_cbranch_scc1 L_join_10
    s_mov_b32 s30, 200000
    s_mov_b32 s31, 26214400
L_poll_11:
    buffer_load_dwordx2 v[10:11], v9, s[32:35], s31 offen sc1
    s_waitcnt vmcnt(0)
    v_cmp_eq_u32 vcc, s27, v10
    v_cmp_eq_u32 s[28:29], s27, v11
    s_nop 0
    s_and_b64 vcc, vcc, s[28:29]
    s_cmp_eq_u64 vcc, -1
    s_cbranch_scc1 L_pdone_12
    s_sleep 1
    s_sub_u32 s30, s30, 1
    s_cmp_lg_u32 s30, 0
    s_cbranch_scc1 L_poll_11
L_pdone_12:
L_join_10:
    s_waitcnt vmcnt(0)
    s_barrier
    s_lshl_b32 s30, s25, 16
    s_add_u32 s36, s18, s30
    s_addc_u32 s37, s19, 0
    s_and_b32 s37, s37, 0xffff
    s_mov_b32 s38, 65536
    s_mov_b32 s39, 0x20000
    s_lshl_b32 s49, s48, 12
    buffer_load_dwordx4 a[0:3], v2, s[36:39], s49 offen offset:0 sc1
    buffer_load_dwordx4 a[4:7], v2, s[36:39], s49 offen offset:1024 sc1
    buffer_load_dwordx4 a[8:11], v2, s[36:39], s49 offen offset:2048 sc1
    buffer_load_dwordx4 a[12:15], v2, s[36:39], s49 offen offset:3072 sc1
    s_add_u32 s49, s49, 4096
    s_and_b32 s49, s49, 65535
    buffer_load_dwordx4 a[16:19], v2, s[36:39], s49 offen offset:0 sc1
    buffer_load_dwordx4 a[20:23], v2, s[36:39], s49 offen offset:1024 sc1
    buffer_load_dwordx4 a[24:27], v2, s[36:39], s49 offen offset:2048 sc1
    buffer_load_dwordx4 a[28:31], v2, s[36:39], s49 offen offset:3072 sc1
    s_add_u32 s49, s49, 4096
    s_and_b32 s49, s49, 65535
    buffer_load_dwordx4 a[32:35], v2, s[36:39], s49 offen offset:0 sc1
    buffer_load_dwordx4 a[36:39], v2, s[36:39], s49 offen offset:1024 sc1
    buffer_load_dwordx4 a[40:43], v2, s[36:39], s49 offen offset:2048 sc1
    buffer_load_dwordx4 a[44:47], v2, s[36:39], s49 offen offset:3072 sc1
    s_add_u32 s49, s49, 4096
    s_and_b32 s49, s49, 65535
    buffer_load_dwordx4 a[48:51], v2, s[36:39], s49 offen offset:0 sc1
    buffer_load_dwordx4 a[52:55], v2, s[36:39], s49 offen offset:1024 sc1
    buffer_load_dwordx4 a[56:59], v2, s[36:39], s49 offen offset:2048 sc1
    buffer_load_dwordx4 a[60:63], v2, s[36:39], s49 offen offset:3072 sc1
    s_add_u32 s49, s49, 4096
    s_and_b32 s49, s49, 65535
    v_lshrrev_b32 v22, 5, v1
    v_mul_u32_u24 v22, 4, v22
    v_bfe_u32 v23, v1, 2, 2
    v_add_u32 v22, v22, v23
    v_lshlrev_b32 v22, 7, v22
    v_bfe_u32 v23, v1, 4, 1
    v_lshlrev_b32 v23, 1, v23
    v_bfe_u32 v24, v1, 1, 1
    v_add_u32 v23, v23, v24
    v_bfe_u32 v24, v1, 3, 1
    v_lshlrev_b32 v24, 2, v24
    v_add_u32 v23, v23, v24
    v_lshlrev_b32 v23, 4, v23
    v_add_u32 v22, v22, v23
    v_and_b32 v23, 1, v1
    v_lshlrev_b32 v23, 3, v23
    v_add_u32 v12, v22, v23
    v_xor_b32 v13, 64, v12
    v_add_u32 v14, 0x10000, v12
    v_add_u32 v15, 0x10000, v13
    v_mov_b32 v32, 0
    v_mov_b32 v33, 0
    v_mov_b32 v34, 0
    v_mov_b32 v35, 0
    v_mov_b32 v36, 0
    v_mov_b32 v37, 0
    v_mov_b32 v38, 0
    v_mov_b32 v39, 0
    v_mov_b32 v40, 0
    v_mov_b32 v41, 0
    v_mov_b32 v42, 0
    v_mov_b32 v43, 0
    v_mov_b32 v44, 0
    v_mov_b32 v45, 0
    v_mov_b32 v46, 0
    v_mov_b32 v47, 0
    v_mov_b32 v48, 0
    v_mov_b32 v49, 0
    v_mov_b32 v50, 0
    v_mov_b32 v51, 0
    v_mov_b32 v52, 0
    v_mov_b32 v53, 0
    v_mov_b32 v54, 0
    v_mov_b32 v55, 0
    v_mov_b32 v56, 0
    v_mov_b32 v57, 0
    v_mov_b32 v58, 0
    v_mov_b32 v59, 0
    v_mov_b32 v60, 0
    v_mov_b32 v61, 0
    v_mov_b32 v62, 0
    v_mov_b32 v63, 0
    ds_read_b64_tr_b16 v[64:65], v12 offset:0
    ds_read_b64_tr_b16 v[66:67], v12 offset:1024
    ds_read_b64_tr_b16 v[68:69], v13 offset:0
    ds_read_b64_tr_b16 v[70:71], v13 offset:1024
    ds_read_b64_tr_b16 v[72:73], v12 offset:2048
    ds_read_b64_tr_b16 v[74:75], v12 offset:3072
    ds_read_b64_tr_b16 v[76:77], v13 offset:2048
    ds_read_b64_tr_b16 v[78:79], v13 offset:3072
    ds_read_b64_tr_b16 v[80:81], v12 offset:4096
    ds_read_b64_tr_b16 v[82:83], v12 offset:5120
    ds_read_b64_tr_b16 v[84:85], v13 offset:4096
    ds_read_b64_tr_b16 v[86:87], v13 offset:5120
    s_waitcnt vmcnt(15) lgkmcnt(8)
    v_mfma_f32_32x32x16_bf16 v[32:47], v[64:67], a[0:3], v[32:47]
    ds_read_b64_tr_b16 v[64:65], v12 offset:6144
    ds_read_b64_tr_b16 v[66:67], v12 offset:7168
    v_mfma_f32_32x32x16_bf16 v[48:63], v[68:71], a[0:3], v[48:63]
    buffer_load_dwordx4 a[64:67], v2, s[36:39], s49 offen offset:0 sc1
    ds_read_b64_tr_b16 v[68:69], v13 offset:6144
    ds_read_b64_tr_b16 v[70:71], v13 offset:7168
    s_waitcnt vmcnt(15) lgkmcnt(8)
    v_mfma_f32_32x32x16_bf16 v[32:47], v[72:75], a[4:7], v[32:47]
    buffer_load_dwordx4 a[68:71], v2, s[36:39], s49 offen offset:1024 sc1
    ds_read_b64_tr_b16 v[72:73], v12 offset:8192
    ds_read_b64_tr_b16 v[74:75], v12 offset:9216
    v_mfma_f32_32x32x16_bf16 v[48:63], v[76:79], a[4:7], v[48:63]
    buffer_load_dwordx4 a[72:75], v2, s[36:39], s49 offen offset:2048 sc1
    ds_read_b64_tr_b16 v[76:77], v13 offset:8192
    ds_read_b64_tr_b16 v[78:79], v13 offset:9216
    s_waitcnt vmcnt(16) lgkmcnt(8)
    v_mfma_f32_32x32x16_bf16 v[32:47], v[80:83], a[8:11], v[32:47]
    buffer_load_dwordx4 a[76:79], v2, s[36:39], s49 offen offset:3072 sc1
    s_add_u32 s49, s49, 4096
    s_and_b32 s49, s49, 65535
    ds_read_b64_tr_b16 v[80:81], v12 offset:10240
    ds_read_b64_tr_b16 v[82:83], v12 offset:11264
    v_mfma_f32_32x32x16_bf16 v[48:63], v[84:87], a[8:11], v[48:63]
    buffer_load_dwordx4 a[80:83], v2, s[36:39], s49 offen offset:0 sc1
    ds_read_b64_tr_b16 v[84:85], v13 offset:10240
    ds_read_b64_tr_b16 v[86:87], v13 offset:11264
    s_waitcnt vmcnt(17) lgkmcnt(8)
    v_mfma_f32_32x32x16_bf16 v[32:47], v[64:67], a[12:15], v[32:47]
    buffer_load_dwordx4 a[84:87], v2, s[36:39], s49 offen offset:1024 sc1
    ds_read_b64_tr_b16 v[64:65], v12 offset:12288
    ds_read_b64_tr_b16 v[66:67], v12 offset:13312
    v_mfma_f32_32x32x16_bf16 v[48:63], v[68:71], a[12:15], v[48:63]
    buffer_load_dwordx4 a[88:91], v2, s[36:39], s49 offen offset:2048 sc1
    ds_read_b64_tr_b16 v[68:69], v13 offset:12288
    ds_read_b64_tr_b16 v[70:71], v13 offset:13312
    s_waitcnt vmcnt(18) lgkmcnt(8)
    v_mfma_f32_32x32x16_bf16 v[32:47], v[72:75], a[16:19], v[32:47]
    buffer_load_dwordx4 a[92:95], v2, s[36:39], s49 offen offset:3072 sc1
    s_add_u32 s49, s49, 4096
    s_and_b32 s49, s49, 65535
    ds_read_b64_tr_b16 v[72:73], v12 offset:14336
    ds_read_b64_tr_b16 v[74:75], v12 offset:15360
    v_mfma_f32_32x32x16_bf16 v[48:63], v[76:79], a[16:19], v[48:63]
    buffer_load_dwordx4 a[96:99], v2, s[36:39], s49 offen offset:0 sc1
    ds_read_b64_tr_b16 v[76:77], v13 offset:14336
    ds_read_b64_tr_b16 v[78:79], v13 offset:15360
    s_waitcnt vmcnt(19) lgkmcnt(8)
    v_mfma_f32_32x32x16_bf16 v[32:47], v[80:83], a[20:23], v[32:47]
    buffer_load_dwordx4 a[100:103], v2, s[36:39], s49 offen offset:1024 sc1
    ds_read_b64_tr_b16 v[80:81], v12 offset:16384
    ds_read_b64_tr_b16 v[82:83], v12 offset:17408
    v_mfma_f32_32x32x16_bf16 v[48:63], v[84:87], a[20:23], v[48:63]
    buffer_load_dwordx4 a[104:107], v2, s[36:39], s49 offen offset:2048 sc1
    ds_read_b64_tr_b16 v[84:85], v13 offset:16384
    ds_read_b64_tr_b16 v[86:87], v13 offset:17408
    s_waitcnt vmcnt(20) lgkmcnt(8)
    v_mfma_f32_32x32x16_bf16 v[32:47], v[64:67], a[24:27], v[32:47]
    buffer_load_dwordx4 a[108:111], v2, s[36:39], s49 offen offset:3072 sc1
    s_add_u32 s49, s49, 4096
    s_and_b32 s49, s49, 65535
    ds_read_b64_tr_b16 v[64:65], v12 offset:18432
    ds_read_b64_tr_b16 v[66:67], v12 offset:19456
    v_mfma_f32_32x32x16_bf16 v[48:63], v[68:71], a[24:27], v[48:63]
    buffer_load_dwordx4 a[112:115], v2, s[36:39], s49 offen offset:0 sc1
    ds_read_b64_tr_b16 v[68:69], v13 offset:18432
    ds_read_b64_tr_b16 v[70:71], v13 offset:19456
    s_waitcnt vmcnt(21) lgkmcnt(8)
    v_mfma_f32_32x32x16_bf16 v[32:47], v[72:75], a[28:31], v[32:47]
    buffer_load_dwordx4 a[116:119], v2, s[36:39], s49 offen offset:1024 sc1
    ds_read_b64_tr_b16 v[72:73], v12 offset:20480
    ds_read_b64_tr_b16 v[74:75], v12 offset:21504
    v_mfma_f32_32x32x16_bf16 v[48:63], v[76:79], a[28:31], v[48:63]
    buffer_load_dwordx4 a[120:123], v2, s[36:39], s49 offen offset:2048 sc1
    ds_read_b64_tr_b16 v[76:77], v13 offset:20480
    ds_read_b64_tr_b16 v[78:79], v13 offset:21504
    s_waitcnt vmcnt(22) lgkmcnt(8)
    v_mfma_f32_32x32x16_bf16 v[32:47], v[80:83], a[32:35], v[32:47]
    buffer_load_dwordx4 a[124:127], v2, s[36:39], s49 offen offset:3072 sc1
    s_add_u32 s49, s49, 4096
    s_and_b32 s49, s49, 65535
    ds_read_b64_tr_b16 v[80:81], v12 offset:22528
    ds_read_b64_tr_b16 v[82:83], v12 offset:23552
    v_mfma_f32_32x32x16_bf16 v[48:63], v[84:87], a[32:35], v[48:63]
    buffer_load_dwordx4 a[128:131], v2, s[36:39], s49 offen offset:0 sc1
    ds_read_b64_tr_b16 v[84:85], v13 offset:22528
    ds_read_b64_tr_b16 v[86:87], v13 offset:23552
    s_waitcnt vmcnt(23) lgkmcnt(8)
    v_mfma_f32_32x32x16_bf16 v[32:47], v[64:67], a[36:39], v[32:47]
    buffer_load_dwordx4 a[132:135], v2, s[36:39], s49 offen offset:1024 sc1
    ds_read_b64_tr_b16 v[64:65], v12 offset:24576
    ds_read_b64_tr_b16 v[66:67], v12 offset:25600
    v_mfma_f32_32x32x16_bf16 v[48:63], v[68:71], a[36:39], v[48:63]
    buffer_load_dwordx4 a[136:139], v2, s[36:39], s49 offen offset:2048 sc1
    ds_read_b64_tr_b16 v[68:69], v13 offset:24576
    ds_read_b64_tr_b16 v[70:71], v13 offset:25600
    s_waitcnt vmcnt(24) lgkmcnt(8)
    v_mfma_f32_32x32x16_bf16 v[32:47], v[72:75], a[40:43], v[32:47]
    buffer_load_dwordx4 a[140:143], v2, s[36:39], s49 offen offset:3072 sc1
    s_add_u32 s49, s49, 4096
    s_and_b32 s49, s49, 65535
    ds_read_b64_tr_b16 v[72:73], v12 offset:26624
    ds_read_b64_tr_b16 v[74:75], v12 offset:27648
    v_mfma_f32_32x32x16_bf16 v[48:63], v[76:79], a[40:43], v[48:63]
    buffer_load_dwordx4 a[144:147], v2, s[36:39], s49 offen offset:0 sc1
    ds_read_b64_tr_b16 v[76:77], v13 offset:26624
    ds_read_b64_tr_b16 v[78:79], v13 offset:27648
    s_waitcnt vmcnt(25) lgkmcnt(8)
    v_mfma_f32_32x32x16_bf16 v[32:47], v[80:83], a[44:47], v[32:47]
    buffer_load_dwordx4 a[148:151], v2, s[36:39], s49 offen offset:1024 sc1
    ds_read_b64_tr_b16 v[80:81], v12 offset:28672
    ds_read_b64_tr_b16 v[82:83], v12 offset:29696
    v_mfma_f32_32x32x16_bf16 v[48:63], v[84:87], a[44:47], v[48:63]
    buffer_load_dwordx4 a[152:155], v2, s[36:39], s49 offen offset:2048 sc1
    ds_read_b64_tr_b16 v[84:85], v13 offset:28672
    ds_read_b64_tr_b16 v[86:87], v13 offset:29696
    s_waitcnt vmcnt(26) lgkmcnt(8)
    v_mfma_f32_32x32x16_bf16 v[32:47], v[64:67], a[48:51], v[32:47]
    buffer_load_dwordx4 a[156:159], v2, s[36:39], s49 offen offset:3072 sc1
    s_add_u32 s49, s49, 4096
    s_and_b32 s49, s49, 65535
    ds_read_b64_tr_b16 v[64:65], v12 offset:30720
    ds_read_b64_tr_b16 v[66:67], v12 offset:31744
    v_mfma_f32_32x32x16_bf16 v[48:63], v[68:71], a[48:51], v[48:63]
    buffer_load_dwordx4 a[160:163], v2, s[36:39], s49 offen offset:0 sc1
    ds_read_b64_tr_b16 v[68:69], v13 offset:30720
    ds_read_b64_tr_b16 v[70:71], v13 offset:31744
    s_waitcnt vmcnt(27) lgkmcnt(8)
    v_mfma_f32_32x32x16_bf16 v[32:47], v[72:75], a[52:55], v[32:47]
    buffer_load_dwordx4 a[164:167], v2, s[36:39], s49 offen offset:1024 sc1
    ds_read_b64_tr_b16 v[72:73], v12 offset:32768
    ds_read_b64_tr_b16 v[74:75], v12 offset:33792
    v_mfma_f32_32x32x16_bf16 v[48:63], v[76:79], a[52:55], v[48:63]
    buffer_load_dwordx4 a[168:171], v2, s[36:39], s49 offen offset:2048 sc1
    ds_read_b64_tr_b16 v[76:77], v13 offset:32768
    ds_read_b64_tr_b16 v[78:79], v13 offset:33792
    s_waitcnt vmcnt(28) lgkmcnt(8)
    v_mfma_f32_32x32x16_bf16 v[32:47], v[80:83], a[56:59], v[32:47]
    buffer_load_dwordx4 a[172:175], v2, s[36:39], s49 offen offset:3072 sc1
    s_add_u32 s49, s49, 4096
    s_and_b32 s49, s49, 65535
    ds_read_b64_tr_b16 v[80:81], v12 offset:34816
    ds_read_b64_tr_b16 v[82:83], v12 offset:35840
    v_mfma_f32_32x32x16_bf16 v[48:63], v[84:87], a[56:59], v[48:63]
    buffer_load_dwordx4 a[176:179], v2, s[36:39], s49 offen offset:0 sc1
    ds_read_b64_tr_b16 v[84:85], v13 offset:34816
    ds_read_b64_tr_b16 v[86:87], v13 offset:35840
    s_waitcnt vmcnt(29) lgkmcnt(8)
    v_mfma_f32_32x32x16_bf16 v[32:47], v[64:67], a[60:63], v[32:47]
    buffer_load_dwordx4 a[180:183], v2, s[36:39], s49 offen offset:1024 sc1
    ds_read_b64_tr_b16 v[64:65], v12 offset:36864
    ds_read_b64_tr_b16 v[66:67], v12 offset:37888
    v_mfma_f32_32x32x16_bf16 v[48:63], v[68:71], a[60:63], v[48:63]
    buffer_load_dwordx4 a[184:187], v2, s[36:39], s49 offen offset:2048 sc1
    ds_read_b64_tr_b16 v[68:69], v13 offset:36864
    ds_read_b64_tr_b16 v[70:71], v13 offset:37888
    s_waitcnt vmcnt(30) lgkmcnt(8)
    v_mfma_f32_32x32x16_bf16 v[32:47], v[72:75], a[64:67], v[32:47]
    buffer_load_dwordx4 a[188:191], v2, s[36:39], s49 offen offset:3072 sc1
    s_add_u32 s49, s49, 4096
    s_and_b32 s49, s49, 65535
    ds_read_b64_tr_b16 v[72:73], v12 offset:38912
    ds_read_b64_tr_b16 v[74:75], v12 offset:39936
    v_mfma_f32_32x32x16_bf16 v[48:63], v[76:79], a[64:67], v[48:63]
    buffer_load_dwordx4 a[0:3], v2, s[36:39], s49 offen offset:0 sc1
    ds_read_b64_tr_b16 v[76:77], v13 offset:38912
    ds_read_b64_tr_b16 v[78:79], v13 offset:39936
    s_waitcnt vmcnt(31) lgkmcnt(8)
    v_mfma_f32_32x32x16_bf16 v[32:47], v[80:83], a[68:71], v[32:47]
    buffer_load_dwordx4 a[4:7], v2, s[36:39], s49 offen offset:1024 sc1
    ds_read_b64_tr_b16 v[80:81], v12 offset:40960
    ds_read_b64_tr_b16 v[82:83], v12 offset:41984
    v_mfma_f32_32x32x16_bf16 v[48:63], v[84:87], a[68:71], v[48:63]
    buffer_load_dwordx4 a[8:11], v2, s[36:39], s49 offen offset:2048 sc1
    ds_read_b64_tr_b16 v[84:85], v13 offset:40960
    ds_read_b64_tr_b16 v[86:87], v13 offset:41984
    s_waitcnt vmcnt(32) lgkmcnt(8)
    v_mfma_f32_32x32x16_bf16 v[32:47], v[64:67], a[72:75], v[32:47]
    buffer_load_dwordx4 a[12:15], v2, s[36:39], s49 offen offset:3072 sc1
    s_add_u32 s49, s49, 4096
    s_and_b32 s49, s49, 65535
    ds_read_b64_tr_b16 v[64:65], v12 offset:43008
    ds_read_b64_tr_b16 v[66:67], v12 offset:44032
    v_mfma_f32_32x32x16_bf16 v[48:63], v[68:71], a[72:75], v[48:63]
    buffer_load_dwordx4 a[16:19], v2, s[36:39], s49 offen offset:0 sc1
    ds_read_b64_tr_b16 v[68:69], v13 offset:43008
    ds_read_b64_tr_b16 v[70:71], v13 offset:44032
    s_waitcnt vmcnt(33) lgkmcnt(8)
    v_mfma_f32_32x32x16_bf16 v[32:47], v[72:75], a[76:79], v[32:47]
    buffer_load_dwordx4 a[20:23], v2, s[36:39], s49 offen offset:1024 sc1
    ds_read_b64_tr_b16 v[72:73], v12 offset:45056
    ds_read_b64_tr_b16 v[74:75], v12 offset:46080
    v_mfma_f32_32x32x16_bf16 v[48:63], v[76:79], a[76:79], v[48:63]
    buffer_load_dwordx4 a[24:27], v2, s[36:39], s49 offen offset:2048 sc1
    ds_read_b64_tr_b16 v[76:77], v13 offset:45056
    ds_read_b64_tr_b16 v[78:79], v13 offset:46080
    s_waitcnt vmcnt(34) lgkmcnt(8)
    v_mfma_f32_32x32x16_bf16 v[32:47], v[80:83], a[80:83], v[32:47]
    buffer_load_dwordx4 a[28:31], v2, s[36:39], s49 offen offset:3072 sc1
    s_add_u32 s49, s49, 4096
    s_and_b32 s49, s49, 65535
    ds_read_b64_tr_b16 v[80:81], v12 offset:47104
    ds_read_b64_tr_b16 v[82:83], v12 offset:48128
    v_mfma_f32_32x32x16_bf16 v[48:63], v[84:87], a[80:83], v[48:63]
    buffer_load_dwordx4 a[32:35], v2, s[36:39], s49 offen offset:0 sc1
    ds_read_b64_tr_b16 v[84:85], v13 offset:47104
    ds_read_b64_tr_b16 v[86:87], v13 offset:48128
    s_waitcnt vmcnt(35) lgkmcnt(8)
    v_mfma_f32_32x32x16_bf16 v[32:47], v[64:67], a[84:87], v[32:47]
    buffer_load_dwordx4 a[36:39], v2, s[36:39], s49 offen offset:1024 sc1
    ds_read_b64_tr_b16 v[64:65], v12 offset:49152
    ds_read_b64_tr_b16 v[66:67], v12 offset:50176
    v_mfma_f32_32x32x16_bf16 v[48:63], v[68:71], a[84:87], v[48:63]
    buffer_load_dwordx4 a[40:43], v2, s[36:39], s49 offen offset:2048 sc1
    ds_read_b64_tr_b16 v[68:69], v13 offset:49152
    ds_read_b64_tr_b16 v[70:71], v13 offset:50176
    s_waitcnt vmcnt(36) lgkmcnt(8)
    v_mfma_f32_32x32x16_bf16 v[32:47], v[72:75], a[88:91], v[32:47]
    buffer_load_dwordx4 a[44:47], v2, s[36:39], s49 offen offset:3072 sc1
    s_add_u32 s49, s49, 4096
    s_and_b32 s49, s49, 65535
    ds_read_b64_tr_b16 v[72:73], v12 offset:51200
    ds_read_b64_tr_b16 v[74:75], v12 offset:52224
    v_mfma_f32_32x32x16_bf16 v[48:63], v[76:79], a[88:91], v[48:63]
    buffer_load_dwordx4 a[48:51], v2, s[36:39], s49 offen offset:0 sc1
    ds_read_b64_tr_b16 v[76:77], v13 offset:51200
    ds_read_b64_tr_b16 v[78:79], v13 offset:52224
    s_waitcnt vmcnt(37) lgkmcnt(8)
    v_mfma_f32_32x32x16_bf16 v[32:47], v[80:83], a[92:95], v[32:47]
    buffer_load_dwordx4 a[52:55], v2, s[36:39], s49 offen offset:1024 sc1
    ds_read_b64_tr_b16 v[80:81], v12 offset:53248
    ds_read_b64_tr_b16 v[82:83], v12 offset:54272
    v_mfma_f32_32x32x16_bf16 v[48:63], v[84:87], a[92:95], v[48:63]
    buffer_load_dwordx4 a[56:59], v2, s[36:39], s49 offen offset:2048 sc1
    ds_read_b64_tr_b16 v[84:85], v13 offset:53248
    ds_read_b64_tr_b16 v[86:87], v13 offset:54272
    s_waitcnt vmcnt(38) lgkmcnt(8)
    v_mfma_f32_32x32x16_bf16 v[32:47], v[64:67], a[96:99], v[32:47]
    buffer_load_dwordx4 a[60:63], v2, s[36:39], s49 offen offset:3072 sc1
    s_add_u32 s49, s49, 4096
    s_and_b32 s49, s49, 65535
    ds_read_b64_tr_b16 v[64:65], v12 offset:55296
    ds_read_b64_tr_b16 v[66:67], v12 offset:56320
    s_add_u32 s86, s48, 14
    s_and_b32 s86, s86, 15
    s_lshl_b32 s86, s86, 17
    s_add_u32 m0, s53, 81920
    s_add_u32 s30, s86, s51
    v_mfma_f32_32x32x16_bf16 v[48:63], v[68:71], a[96:99], v[48:63]
    buffer_load_dwordx4 v4, s[44:47], s30 offen lds
    ds_read_b64_tr_b16 v[68:69], v13 offset:55296
    ds_read_b64_tr_b16 v[70:71], v13 offset:56320
    s_add_u32 m0, s53, 82944
    s_add_u32 s30, s86, s51
    s_add_u32 s30, s30, 16384
    s_waitcnt vmcnt(39) lgkmcnt(8)
    v_mfma_f32_32x32x16_bf16 v[32:47], v[72:75], a[100:103], v[32:47]
    buffer_load_dwordx4 v4, s[44:47], s30 offen lds
    ds_read_b64_tr_b16 v[72:73], v12 offset:57344
    ds_read_b64_tr_b16 v[74:75], v12 offset:58368
    s_add_u32 s86, s48, 15
    s_and_b32 s86, s86, 15
    s_lshl_b32 s86, s86, 17
    s_add_u32 m0, s53, 90112
    s_add_u32 s30, s86, s51
    v_mfma_f32_32x32x16_bf16 v[48:63], v[76:79], a[100:103], v[48:63]
    buffer_load_dwordx4 v4, s[44:47], s30 offen lds
    ds_read_b64_tr_b16 v[76:77], v13 offset:57344
    ds_read_b64_tr_b16 v[78:79], v13 offset:58368
    s_add_u32 m0, s53, 91136
    s_add_u32 s30, s86, s51
    s_add_u32 s30, s30, 16384
    s_waitcnt vmcnt(40) lgkmcnt(8)
    v_mfma_f32_32x32x16_bf16 v[32:47], v[80:83], a[104:107], v[32:47]
    buffer_load_dwordx4 v4, s[44:47], s30 offen lds
    ds_read_b64_tr_b16 v[80:81], v12 offset:59392
    ds_read_b64_tr_b16 v[82:83], v12 offset:60416
    v_mfma_f32_32x32x16_bf16 v[48:63], v[84:87], a[104:107], v[48:63]
    s_add_u32 m0, s56, 0
    s_add_u32 s30, s55, 0
    buffer_load_dwordx4 v7, s[92:95], s30 offen lds
    ds_read_b64_tr_b16 v[84:85], v13 offset:59392
    ds_read_b64_tr_b16 v[86:87], v13 offset:60416
    s_waitcnt vmcnt(41) lgkmcnt(8)
    v_mfma_f32_32x32x16_bf16 v[32:47], v[64:67], a[108:111], v[32:47]
    s_add_u32 m0, s56, 1024
    s_add_u32 s30, s55, 16384
    buffer_load_dwordx4 v8, s[92:95], s30 offen lds
    ds_read_b64_tr_b16 v[64:65], v12 offset:61440
    ds_read_b64_tr_b16 v[66:67], v12 offset:62464
    v_mfma_f32_32x32x16_bf16 v[48:63], v[68:71], a[108:111], v[48:63]
    s_add_u32 m0, s56, 2048
    s_add_u32 s30, s55, 32768
    buffer_load_dwordx4 v7, s[92:95], s30 offen lds
    ds_read_b64_tr_b16 v[68:69], v13 offset:61440
    ds_read_b64_tr_b16 v[70:71], v13 offset:62464
    s_waitcnt vmcnt(42) lgkmcnt(8)
    v_mfma_f32_32x32x16_bf16 v[32:47], v[72:75], a[112:115], v[32:47]
    s_add_u32 m0, s56, 3072
    s_add_u32 s30, s55, 49152
    buffer_load_dwordx4 v8, s[92:95], s30 offen lds
    ds_read_b64_tr_b16 v[72:73], v12 offset:63488
    ds_read_b64_tr_b16 v[74:75], v12 offset:64512
    v_mfma_f32_32x32x16_bf16 v[48:63], v[76:79], a[112:115], v[48:63]
    v_cmp_le_u32 vcc, 28, v1
    v_mov_b32 v23, 0
    v_mov_b32 v21, 28
    v_cndmask_b32 v21, v23, v21, vcc
    v_sub_u32 v29, v1, v21
    v_lshlrev_b32 v29, 4, v29
    v_mov_b32 v21, 7168
    v_cndmask_b32 v21, v23, v21, vcc
    v_add_u32 v29, v29, v21
    v_cmp_gt_u32 vcc, 56, v1
    v_mov_b32 v21, 0x7ffffff0
    s_nop 0
    v_cndmask_b32 v29, v21, v29, vcc
    s_lshl_b32 s89, s21, 6
    s_lshl_b32 s90, s20, 4
    s_add_u32 s89, s89, s90
    s_mul_i32 s89, s89, 7168
    s_mul_i32 s90, s22, 448
    s_add_u32 s89, s89, s90
    s_mov_b32 s92, s10
    s_and_b32 s93, s11, 0xffff
    s_mov_b32 s94, 7340032
    s_mov_b32 s95, 0x20000
    buffer_load_dwordx4 v[160:163], v29, s[92:95], s89 offen
    s_add_u32 s89, s89, 14336
    ds_read_b64_tr_b16 v[76:77], v13 offset:63488
    ds_read_b64_tr_b16 v[78:79], v13 offset:64512
    s_waitcnt vmcnt(43) lgkmcnt(8)
    v_mfma_f32_32x32x16_bf16 v[32:47], v[80:83], a[116:119], v[32:47]
    buffer_load_dwordx4 v[164:167], v29, s[92:95], s89 offen
    s_add_u32 s89, s89, 14336
    ds_read_b64_tr_b16 v[80:81], v14 offset:32768
    ds_read_b64_tr_b16 v[82:83], v14 offset:33792
    v_mfma_f32_32x32x16_bf16 v[48:63], v[84:87], a[116:119], v[48:63]
    buffer_load_dwordx4 v[168:171], v29, s[92:95], s89 offen
    s_add_u32 s89, s89, 14336
    ds_read_b64_tr_b16 v[84:85], v15 offset:32768
    ds_read_b64_tr_b16 v[86:87], v15 offset:33792
    buffer_load_dwordx4 v[172:175], v29, s[92:95], s89 offen
    s_add_u32 s89, s89, 14336
    s_and_b32 s54, s24, 1
    v_lshrrev_b32 v20, 4, v1
    v_mul_u32_u24 v21, 7168, v20
    v_lshlrev_b32 v20, 2, v20
    v_and_b32 v22, 15, v1
    v_xor_b32 v22, v22, v20
    v_lshlrev_b32 v22, 4, v22
    v_add_u32 v4, v21, v22
    s_lshl_b32 s30, s54, 6
    v_add_u32 v4, s30, v4
    s_xor_b32 s30, s54, 1
    s_lshl_b32 s30, s30, 8
    v_add_u32 v20, 0, v1
    v_mul_u32_u24 v21, 5462, v20
    v_lshrrev_b32 v21, 16, v21
    v_mul_u32_u24 v22, 12, v21
    v_sub_u32 v20, v20, v22
    v_lshlrev_b32 v22, 4, v20
    v_add_u32 v23, 256, v22
    v_add_u32 v22, s30, v22
    v_cmp_gt_u32 vcc, 4, v20
    s_nop 1
    v_cndmask_b32 v22, v23, v22, vcc
    v_mul_u32_u24 v21, 7168, v21
    v_add_u32 v5, v21, v22
    v_add_u32 v20, 64, v1
    v_mul_u32_u24 v21, 5462, v20
    v_lshrrev_b32 v21, 16, v21
    v_mul_u32_u24 v22, 12, v21
    v_sub_u32 v20, v20, v22
    v_lshlrev_b32 v22, 4, v20
    v_add_u32 v23, 256, v22
    v_add_u32 v22, s30, v22
    v_cmp_gt_u32 vcc, 4, v20
    s_nop 1
    v_cndmask_b32 v22, v23, v22, vcc
    v_mul_u32_u24 v21, 7168, v21
    v_add_u32 v6, v21, v22
    v_add_u32 v20, 128, v1
    v_mul_u32_u24 v21, 5462, v20
    v_lshrrev_b32 v21, 16, v21
    v_mul_u32_u24 v22, 12, v21
    v_sub_u32 v20, v20, v22
    v_lshlrev_b32 v22, 4, v20
    v_add_u32 v23, 256, v22
    v_add_u32 v22, s30, v22
    v_cmp_gt_u32 vcc, 4, v20
    s_nop 1
    v_cndmask_b32 v22, v23, v22, vcc
    v_mul_u32_u24 v21, 7168, v21
    v_add_u32 v7, v21, v22
    s_mul_i32 s30, s24, 448
    s_sub_u32 s31, 7340032, s30
    s_add_u32 s40, s10, s30
    s_addc_u32 s41, s11, 0
    s_and_b32 s41, s41, 0xffff
    s_mov_b32 s42, s31
    s_mov_b32 s43, 0x20000
    s_and_b32 s30, s23, 7
    s_and_b32 s31, s24, 3
    s_lshl_b32 s31, s31, 1
    s_add_u32 s30, s30, s31
    s_and_b32 s48, s30, 7
    s_mul_i32 s51, s20, 114688
    s_lshl_b32 s53, s20, 12
    s_mul_i32 s52, s20, 3072
    s_waitcnt vmcnt(45) lgkmcnt(8)
    v_mfma_f32_32x32x16_bf16 v[32:47], v[64:67], a[120:123], v[32:47]
    ds_read_b64_tr_b16 v[64:65], v14 offset:34816
    ds_read_b64_tr_b16 v[66:67], v14 offset:35840
    v_mfma_f32_32x32x16_bf16 v[48:63], v[68:71], a[120:123], v[48:63]
    buffer_load_dwordx4 v[176:179], v29, s[92:95], s89 offen
    s_add_u32 s89, s89, 14336
    ds_read_b64_tr_b16 v[68:69], v15 offset:34816
    ds_read_b64_tr_b16 v[70:71], v15 offset:35840
    s_waitcnt vmcnt(45) lgkmcnt(8)
    v_mfma_f32_32x32x16_bf16 v[32:47], v[72:75], a[124:127], v[32:47]
    buffer_load_dwordx4 v[180:183], v29, s[92:95], s89 offen
    s_add_u32 s89, s89, 14336
    ds_read_b64_tr_b16 v[72:73], v14 offset:36864
    ds_read_b64_tr_b16 v[74:75], v14 offset:37888
    v_mfma_f32_32x32x16_bf16 v[48:63], v[76:79], a[124:127], v[48:63]
    buffer_load_dwordx4 v[184:187], v29, s[92:95], s89 offen
    s_add_u32 s89, s89, 14336
    ds_read_b64_tr_b16 v[76:77], v15 offset:36864
    ds_read_b64_tr_b16 v[78:79], v15 offset:37888
    buffer_load_dwordx4 v[188:191], v29, s[92:95], s89 offen
    s_barrier
    s_waitcnt vmcnt(47) lgkmcnt(8)
    v_mfma_f32_32x32x16_bf16 v[32:47], v[80:83], a[128:131], v[32:47]
    ds_read_b64_tr_b16 v[80:81], v14 offset:38912
    ds_read_b64_tr_b16 v[82:83], v14 offset:39936
    v_mfma_f32_32x32x16_bf16 v[48:63], v[84:87], a[128:131], v[48:63]
    ds_read_b64_tr_b16 v[84:85], v15 offset:38912
    ds_read_b64_tr_b16 v[86:87], v15 offset:39936
    s_waitcnt vmcnt(46) lgkmcnt(8)
    v_mfma_f32_32x32x16_bf16 v[32:47], v[64:67], a[132:135], v[32:47]
    ds_read_b64_tr_b16 v[64:65], v14 offset:40960
    ds_read_b64_tr_b16 v[66:67], v14 offset:41984
    v_mfma_f32_32x32x16_bf16 v[48:63], v[68:71], a[132:135], v[48:63]
    ds_read_b64_tr_b16 v[68:69], v15 offset:40960
    ds_read_b64_tr_b16 v[70:71], v15 offset:41984
    s_waitcnt vmcnt(45) lgkmcnt(8)
    v_mfma_f32_32x32x16_bf16 v[32:47], v[72:75], a[136:139], v[32:47]
    ds_read_b64_tr_b16 v[72:73], v14 offset:43008
    ds_read_b64_tr_b16 v[74:75], v14 offset:44032
    v_mfma_f32_32x32x16_bf16 v[48:63], v[76:79], a[136:139], v[48:63]
    ds_read_b64_tr_b16 v[76:77], v15 offset:43008
    ds_read_b64_tr_b16 v[78:79], v15 offset:44032
    s_waitcnt vmcnt(44) lgkmcnt(8)
    v_mfma_f32_32x32x16_bf16 v[32:47], v[80:83], a[140:143], v[32:47]
    ds_read_b64_tr_b16 v[80:81], v14 offset:45056
    ds_read_b64_tr_b16 v[82:83], v14 offset:46080
    v_mfma_f32_32x32x16_bf16 v[48:63], v[84:87], a[140:143], v[48:63]
    ds_read_b64_tr_b16 v[84:85], v15 offset:45056
    ds_read_b64_tr_b16 v[86:87], v15 offset:46080
    s_waitcnt vmcnt(43) lgkmcnt(8)
    v_mfma_f32_32x32x16_bf16 v[32:47], v[64:67], a[144:147], v[32:47]
    ds_read_b64_tr_b16 v[64:65], v14 offset:47104
    ds_read_b64_tr_b16 v[66:67], v14 offset:48128
    v_mfma_f32_32x32x16_bf16 v[48:63], v[68:71], a[144:147], v[48:63]
    ds_read_b64_tr_b16 v[68:69], v15 offset:47104
    ds_read_b64_tr_b16 v[70:71], v15 offset:48128
    s_add_u32 m0, s53, 0
    s_add_u32 s50, s48, 0
    s_and_b32 s50, s50, 7
    s_mul_i32 s50, s50, 458752
    s_add_u32 s50, s50, s51
    s_waitcnt vmcnt(42) lgkmcnt(8)
    v_mfma_f32_32x32x16_bf16 v[32:47], v[72:75], a[148:151], v[32:47]
    buffer_load_dwordx4 v4, s[40:43], s50 offen lds
    ds_read_b64_tr_b16 v[72:73], v14 offset:49152
    ds_read_b64_tr_b16 v[74:75], v14 offset:50176
    s_add_u32 m0, s53, 1024
    s_add_u32 s50, s50, 28672
    v_mfma_f32_32x32x16_bf16 v[48:63], v[76:79], a[148:151], v[48:63]
    buffer_load_dwordx4 v4, s[40:43], s50 offen lds
    ds_read_b64_tr_b16 v[76:77], v15 offset:49152
    ds_read_b64_tr_b16 v[78:79], v15 offset:50176
    s_add_u32 m0, s53, 2048
    s_add_u32 s50, s50, 28672
    s_waitcnt vmcnt(43) lgkmcnt(8)
    v_mfma_f32_32x32x16_bf16 v[32:47], v[80:83], a[152:155], v[32:47]
    buffer_load_dwordx4 v4, s[40:43], s50 offen lds
    ds_read_b64_tr_b16 v[80:81], v14 offset:51200
    ds_read_b64_tr_b16 v[82:83], v14 offset:52224
    s_add_u32 m0, s53, 3072
    s_add_u32 s50, s50, 28672
    v_mfma_f32_32x32x16_bf16 v[48:63], v[84:87], a[152:155], v[48:63]
    buffer_load_dwordx4 v4, s[40:43], s50 offen lds
    ds_read_b64_tr_b16 v[84:85], v15 offset:51200
    ds_read_b64_tr_b16 v[86:87], v15 offset:52224
    s_add_u32 m0, s53, 16384
    s_add_u32 s50, s48, 1
    s_and_b32 s50, s50, 7
    s_mul_i32 s50, s50, 458752
    s_add_u32 s50, s50, s51
    s_waitcnt vmcnt(44) lgkmcnt(8)
    v_mfma_f32_32x32x16_bf16 v[32:47], v[64:67], a[156:159], v[32:47]
    buffer_load_dwordx4 v4, s[40:43], s50 offen lds
    ds_read_b64_tr_b16 v[64:65], v14 offset:53248
    ds_read_b64_tr_b16 v[66:67], v14 offset:54272
    s_add_u32 m0, s53, 17408
    s_add_u32 s50, s50, 28672
    v_mfma_f32_32x32x16_bf16 v[48:63], v[68:71], a[156:159], v[48:63]
    buffer_load_dwordx4 v4, s[40:43], s50 offen lds
    ds_read_b64_tr_b16 v[68:69], v15 offset:53248
    ds_read_b64_tr_b16 v[70:71], v15 offset:54272
    s_add_u32 m0, s53, 18432
    s_add_u32 s50, s50, 28672
    s_waitcnt vmcnt(45) lgkmcnt(8)
    v_mfma_f32_32x32x16_bf16 v[32:47], v[72:75], a[160:163], v[32:47]
    buffer_load_dwordx4 v4, s[40:43], s50 offen lds
    ds_read_b64_tr_b16 v[72:73], v14 offset:55296
    ds_read_b64_tr_b16 v[74:75], v14 offset:56320
    s_add_u32 m0, s53, 19456
    s_add_u32 s50, s50, 28672
    v_mfma_f32_32x32x16_bf16 v[48:63], v[76:79], a[160:163], v[48:63]
    buffer_load_dwordx4 v4, s[40:43], s50 offen lds
    ds_read_b64_tr_b16 v[76:77], v15 offset:55296
    ds_read_b64_tr_b16 v[78:79], v15 offset:56320
    s_waitcnt vmcnt(46) lgkmcnt(8)
    v_mfma_f32_32x32x16_bf16 v[32:47], v[80:83], a[164:167], v[32:47]
    ds_read_b64_tr_b16 v[80:81], v14 offset:57344
    ds_read_b64_tr_b16 v[82:83], v14 offset:58368
    v_mfma_f32_32x32x16_bf16 v[48:63], v[84:87], a[164:167], v[48:63]
    ds_read_b64_tr_b16 v[84:85], v15 offset:57344
    ds_read_b64_tr_b16 v[86:87], v15 offset:58368
    s_waitcnt vmcnt(45) lgkmcnt(8)
    v_mfma_f32_32x32x16_bf16 v[32:47], v[64:67], a[168:171], v[32:47]
    ds_read_b64_tr_b16 v[64:65], v14 offset:59392
    ds_read_b64_tr_b16 v[66:67], v14 offset:60416
    v_mfma_f32_32x32x16_bf16 v[48:63], v[68:71], a[168:171], v[48:63]
    ds_read_b64_tr_b16 v[68:69], v15 offset:59392
    ds_read_b64_tr_b16 v[70:71], v15 offset:60416
    s_waitcnt vmcnt(44) lgkmcnt(8)
    v_mfma_f32_32x32x16_bf16 v[32:47], v[72:75], a[172:175], v[32:47]
    ds_read_b64_tr_b16 v[72:73], v14 offset:61440
    ds_read_b64_tr_b16 v[74:75], v14 offset:62464
    v_mfma_f32_32x32x16_bf16 v[48:63], v[76:79], a[172:175], v[48:63]
    ds_read_b64_tr_b16 v[76:77], v15 offset:61440
    ds_read_b64_tr_b16 v[78:79], v15 offset:62464
    s_waitcnt vmcnt(43) lgkmcnt(8)
    v_mfma_f32_32x32x16_bf16 v[32:47], v[80:83], a[176:179], v[32:47]
    ds_read_b64_tr_b16 v[80:81], v14 offset:63488
    ds_read_b64_tr_b16 v[82:83], v14 offset:64512
    v_mfma_f32_32x32x16_bf16 v[48:63], v[84:87], a[176:179], v[48:63]
    ds_read_b64_tr_b16 v[84:85], v15 offset:63488
    ds_read_b64_tr_b16 v[86:87], v15 offset:64512
    s_waitcnt vmcnt(42) lgkmcnt(8)
    v_mfma_f32_32x32x16_bf16 v[32:47], v[64:67], a[180:183], v[32:47]
    ds_read_b64_tr_b16 v[64:65], v14 offset:0
    ds_read_b64_tr_b16 v[66:67], v14 offset:1024
    v_mfma_f32_32x32x16_bf16 v[48:63], v[68:71], a[180:183], v[48:63]
    ds_read_b64_tr_b16 v[68:69], v15 offset:0
    ds_read_b64_tr_b16 v[70:71], v15 offset:1024
    s_waitcnt vmcnt(41) lgkmcnt(8)
    v_mfma_f32_32x32x16_bf16 v[32:47], v[72:75], a[184:187], v[32:47]
    ds_read_b64_tr_b16 v[72:73], v14 offset:2048
    ds_read_b64_tr_b16 v[74:75], v14 offset:3072
    v_mfma_f32_32x32x16_bf16 v[48:63], v[76:79], a[184:187], v[48:63]
    ds_read_b64_tr_b16 v[76:77], v15 offset:2048
    ds_read_b64_tr_b16 v[78:79], v15 offset:3072
    s_waitcnt vmcnt(40) lgkmcnt(8)
    v_mfma_f32_32x32x16_bf16 v[32:47], v[80:83], a[188:191], v[32:47]
    ds_read_b64_tr_b16 v[80:81], v14 offset:4096
    ds_read_b64_tr_b16 v[82:83], v14 offset:5120
    v_mfma_f32_32x32x16_bf16 v[48:63], v[84:87], a[188:191], v[48:63]
    ds_read_b64_tr_b16 v[84:85], v15 offset:4096
    ds_read_b64_tr_b16 v[86:87], v15 offset:5120
    s_waitcnt vmcnt(39) lgkmcnt(8)
    v_mfma_f32_32x32x16_bf16 v[32:47], v[64:67], a[0:3], v[32:47]
    ds_read_b64_tr_b16 v[64:65], v14 offset:6144
    ds_read_b64_tr_b16 v[66:67], v14 offset:7168
    v_mfma_f32_32x32x16_bf16 v[48:63], v[68:71], a[0:3], v[48:63]
    ds_read_b64_tr_b16 v[68:69], v15 offset:6144
    ds_read_b64_tr_b16 v[70:71], v15 offset:7168
    s_waitcnt vmcnt(38) lgkmcnt(8)
    v_mfma_f32_32x32x16_bf16 v[32:47], v[72:75], a[4:7], v[32:47]
    ds_read_b64_tr_b16 v[72:73], v14 offset:8192
    ds_read_b64_tr_b16 v[74:75], v14 offset:9216
    v_mfma_f32_32x32x16_bf16 v[48:63], v[76:79], a[4:7], v[48:63]
    ds_read_b64_tr_b16 v[76:77], v15 offset:8192
    ds_read_b64_tr_b16 v[78:79], v15 offset:9216
    s_waitcnt vmcnt(16)
    s_barrier
    s_waitcnt vmcnt(37) lgkmcnt(8)
    v_mfma_f32_32x32x16_bf16 v[32:47], v[80:83], a[8:11], v[32:47]
    ds_read_b64_tr_b16 v[80:81], v14 offset:10240
    ds_read_b64_tr_b16 v[82:83], v14 offset:11264
    v_mfma_f32_32x32x16_bf16 v[48:63], v[84:87], a[8:11], v[48:63]
    ds_read_b64_tr_b16 v[84:85], v15 offset:10240
    ds_read_b64_tr_b16 v[86:87], v15 offset:11264
    s_waitcnt vmcnt(36) lgkmcnt(8)
    v_mfma_f32_32x32x16_bf16 v[32:47], v[64:67], a[12:15], v[32:47]
    ds_read_b64_tr_b16 v[64:65], v14 offset:12288
    ds_read_b64_tr_b16 v[66:67], v14 offset:13312
    v_mfma_f32_32x32x16_bf16 v[48:63], v[68:71], a[12:15], v[48:63]
    ds_read_b64_tr_b16 v[68:69], v15 offset:12288
    ds_read_b64_tr_b16 v[70:71], v15 offset:13312
    s_waitcnt vmcnt(35) lgkmcnt(8)
    v_mfma_f32_32x32x16_bf16 v[32:47], v[72:75], a[16:19], v[32:47]
    ds_read_b64_tr_b16 v[72:73], v14 offset:14336
    ds_read_b64_tr_b16 v[74:75], v14 offset:15360
    v_mfma_f32_32x32x16_bf16 v[48:63], v[76:79], a[16:19], v[48:63]
    ds_read_b64_tr_b16 v[76:77], v15 offset:14336
    ds_read_b64_tr_b16 v[78:79], v15 offset:15360
    s_waitcnt vmcnt(34) lgkmcnt(8)
    v_mfma_f32_32x32x16_bf16 v[32:47], v[80:83], a[20:23], v[32:47]
    ds_read_b64_tr_b16 v[80:81], v14 offset:16384
    ds_read_b64_tr_b16 v[82:83], v14 offset:17408
    v_mfma_f32_32x32x16_bf16 v[48:63], v[84:87], a[20:23], v[48:63]
    ds_read_b64_tr_b16 v[84:85], v15 offset:16384
    ds_read_b64_tr_b16 v[86:87], v15 offset:17408
    s_waitcnt vmcnt(33) lgkmcnt(8)
    v_mfma_f32_32x32x16_bf16 v[32:47], v[64:67], a[24:27], v[32:47]
    ds_read_b64_tr_b16 v[64:65], v14 offset:18432
    ds_read_b64_tr_b16 v[66:67], v14 offset:19456
    v_mfma_f32_32x32x16_bf16 v[48:63], v[68:71], a[24:27], v[48:63]
    ds_read_b64_tr_b16 v[68:69], v15 offset:18432
    ds_read_b64_tr_b16 v[70:71], v15 offset:19456
    s_waitcnt vmcnt(32) lgkmcnt(8)
    v_mfma_f32_32x32x16_bf16 v[32:47], v[72:75], a[28:31], v[32:47]
    ds_read_b64_tr_b16 v[72:73], v14 offset:20480
    ds_read_b64_tr_b16 v[74:75], v14 offset:21504
    v_mfma_f32_32x32x16_bf16 v[48:63], v[76:79], a[28:31], v[48:63]
    ds_read_b64_tr_b16 v[76:77], v15 offset:20480
    ds_read_b64_tr_b16 v[78:79], v15 offset:21504
    s_waitcnt vmcnt(31) lgkmcnt(8)
    v_mfma_f32_32x32x16_bf16 v[32:47], v[80:83], a[32:35], v[32:47]
    ds_read_b64_tr_b16 v[80:81], v14 offset:22528
    ds_read_b64_tr_b16 v[82:83], v14 offset:23552
    v_mfma_f32_32x32x16_bf16 v[48:63], v[84:87], a[32:35], v[48:63]
    ds_read_b64_tr_b16 v[84:85], v15 offset:22528
    ds_read_b64_tr_b16 v[86:87], v15 offset:23552
    s_waitcnt vmcnt(30) lgkmcnt(8)
    v_mfma_f32_32x32x16_bf16 v[32:47], v[64:67], a[36:39], v[32:47]
    ds_read_b64_tr_b16 v[64:65], v14 offset:24576
    ds_read_b64_tr_b16 v[66:67], v14 offset:25600
    v_mfma_f32_32x32x16_bf16 v[48:63], v[68:71], a[36:39], v[48:63]
    ds_read_b64_tr_b16 v[68:69], v15 offset:24576
    ds_read_b64_tr_b16 v[70:71], v15 offset:25600
    s_waitcnt vmcnt(29) lgkmcnt(8)
    v_mfma_f32_32x32x16_bf16 v[32:47], v[72:75], a[40:43], v[32:47]
    ds_read_b64_tr_b16 v[72:73], v14 offset:26624
    ds_read_b64_tr_b16 v[74:75], v14 offset:27648
    v_mfma_f32_32x32x16_bf16 v[48:63], v[76:79], a[40:43], v[48:63]
    ds_read_b64_tr_b16 v[76:77], v15 offset:26624
    ds_read_b64_tr_b16 v[78:79], v15 offset:27648
    s_waitcnt vmcnt(28) lgkmcnt(8)
    v_mfma_f32_32x32x16_bf16 v[32:47], v[80:83], a[44:47], v[32:47]
    ds_read_b64_tr_b16 v[80:81], v14 offset:28672
    ds_read_b64_tr_b16 v[82:83], v14 offset:29696
    v_mfma_f32_32x32x16_bf16 v[48:63], v[84:87], a[44:47], v[48:63]
    ds_read_b64_tr_b16 v[84:85], v15 offset:28672
    ds_read_b64_tr_b16 v[86:87], v15 offset:29696
    s_waitcnt vmcnt(27) lgkmcnt(8)
    v_mfma_f32_32x32x16_bf16 v[32:47], v[64:67], a[48:51], v[32:47]
    ds_read_b64_tr_b16 v[64:65], v14 offset:30720
    ds_read_b64_tr_b16 v[66:67], v14 offset:31744
    v_mfma_f32_32x32x16_bf16 v[48:63], v[68:71], a[48:51], v[48:63]
    ds_read_b64_tr_b16 v[68:69], v15 offset:30720
    ds_read_b64_tr_b16 v[70:71], v15 offset:31744
    s_waitcnt vmcnt(26) lgkmcnt(8)
    v_mfma_f32_32x32x16_bf16 v[32:47], v[72:75], a[52:55], v[32:47]
    v_mfma_f32_32x32x16_bf16 v[48:63], v[76:79], a[52:55], v[48:63]
    s_waitcnt vmcnt(25) lgkmcnt(4)
    v_mfma_f32_32x32x16_bf16 v[32:47], v[80:83], a[56:59], v[32:47]
    v_mfma_f32_32x32x16_bf16 v[48:63], v[84:87], a[56:59], v[48:63]
    s_waitcnt vmcnt(24) lgkmcnt(0)
    v_mfma_f32_32x32x16_bf16 v[32:47], v[64:67], a[60:63], v[32:47]
    v_mfma_f32_32x32x16_bf16 v[48:63], v[68:71], a[60:63], v[48:63]
    v_and_b32 v20, 31, v1
    v_lshlrev_b32 v21, 7, v20
    v_lshrrev_b32 v20, 1, v20
    v_and_b32 v20, 7, v20
    v_lshlrev_b32 v20, 4, v20
    v_add_u32 v21, v21, v20
    v_lshrrev_b32 v20, 5, v1
    v_lshlrev_b32 v20, 3, v20
    v_add_u32 v21, v21, v20
    v_add_u32 v21, s56, v21
    v_xor_b32 v20, 0, v21
    ds_read_b64 v[80:81], v20
    v_xor_b32 v20, 16, v21
    ds_read_b64 v[82:83], v20
    v_xor_b32 v20, 32, v21
    ds_read_b64 v[84:85], v20
    v_xor_b32 v20, 48, v21
    ds_read_b64 v[86:87], v20
    v_xor_b32 v20, 64, v21
    ds_read_b64 v[88:89], v20
    v_xor_b32 v20, 80, v21
    ds_read_b64 v[90:91], v20
    v_xor_b32 v20, 96, v21
    ds_read_b64 v[92:93], v20
    v_xor_b32 v20, 112, v21
    ds_read_b64 v[94:95], v20
    s_waitcnt lgkmcnt(0)
    v_mov_b32 v100, 0
    v_mov_b32 v101, 0
    v_mov_b32 v102, 0
    v_mov_b32 v103, 0
    v_lshlrev_b32 v96, 16, v80
    v_and_b32 v97, 0xffff0000, v80
    v_pk_add_f32 v[32:33], v[32:33], v[96:97]
    v_cvt_pk_bf16_f32 v240, v32, v33
    v_pk_add_f32 v[100:101], v[100:101], v[32:33]
    v_pk_fma_f32 v[102:103], v[32:33], v[32:33], v[102:103]
    v_lshlrev_b32 v96, 16, v81
    v_and_b32 v97, 0xffff0000, v81
    v_pk_add_f32 v[34:35], v[34:35], v[96:97]
    v_cvt_pk_bf16_f32 v241, v34, v35
    v_pk_add_f32 v[100:101], v[100:101], v[34:35]
    v_pk_fma_f32 v[102:103], v[34:35], v[34:35], v[102:103]
    v_lshlrev_b32 v96, 16, v82
    v_and_b32 v97, 0xffff0000, v82
    v_pk_add_f32 v[36:37], v[36:37], v[96:97]
    v_cvt_pk_bf16_f32 v242, v36, v37
    v_pk_add_f32 v[100:101], v[100:101], v[36:37]
    v_pk_fma_f32 v[102:103], v[36:37], v[36:37], v[102:103]
    v_lshlrev_b32 v96, 16, v83
    v_and_b32 v97, 0xffff0000, v83
    v_pk_add_f32 v[38:39], v[38:39], v[96:97]
    v_cvt_pk_bf16_f32 v243, v38, v39
    v_pk_add_f32 v[100:101], v[100:101], v[38:39]
    v_pk_fma_f32 v[102:103], v[38:39], v[38:39], v[102:103]
    s_lshl_b32 s57, s25, 16
    s_lshl_b32 s31, s22, 12
    s_add_u32 s57, s57, s31
    s_add_u32 s57, s57, 4194304
    buffer_store_dwordx4 v[240:243], v2, s[32:35], s57 offen offset:0 sc1
    v_lshlrev_b32 v96, 16, v84
    v_and_b32 v97, 0xffff0000, v84
    v_pk_add_f32 v[40:41], v[40:41], v[96:97]
    v_cvt_pk_bf16_f32 v244, v40, v41
    v_pk_add_f32 v[100:101], v[100:101], v[40:41]
    v_pk_fma_f32 v[102:103], v[40:41], v[40:41], v[102:103]
    v_lshlrev_b32 v96, 16, v85
    v_and_b32 v97, 0xffff0000, v85
    v_pk_add_f32 v[42:43], v[42:43], v[96:97]
    v_cvt_pk_bf16_f32 v245, v42, v43
    v_pk_add_f32 v[100:101], v[100:101], v[42:43]
    v_pk_fma_f32 v[102:103], v[42:43], v[42:43], v[102:103]
    v_lshlrev_b32 v96, 16, v86
    v_and_b32 v97, 0xffff0000, v86
    v_pk_add_f32 v[44:45], v[44:45], v[96:97]
    v_cvt_pk_bf16_f32 v246, v44, v45
    v_pk_add_f32 v[100:101], v[100:101], v[44:45]
    v_pk_fma_f32 v[102:103], v[44:45], v[44:45], v[102:103]
    v_lshlrev_b32 v96, 16, v87
    v_and_b32 v97, 0xffff0000, v87
    v_pk_add_f32 v[46:47], v[46:47], v[96:97]
    v_cvt_pk_bf16_f32 v247, v46, v47
    v_pk_add_f32 v[100:101], v[100:101], v[46:47]
    v_pk_fma_f32 v[102:103], v[46:47], v[46:47], v[102:103]
    buffer_store_dwordx4 v[244:247], v2, s[32:35], s57 offen offset:1024 sc1
    v_lshlrev_b32 v96, 16, v88
    v_and_b32 v97, 0xffff0000, v88
    v_pk_add_f32 v[48:49], v[48:49], v[96:97]
    v_cvt_pk_bf16_f32 v248, v48, v49
    v_pk_add_f32 v[100:101], v[100:101], v[48:49]
    v_pk_fma_f32 v[102:103], v[48:49], v[48:49], v[102:103]
    v_lshlrev_b32 v96, 16, v89
    v_and_b32 v97, 0xffff0000, v89
    v_pk_add_f32 v[50:51], v[50:51], v[96:97]
    v_cvt_pk_bf16_f32 v249, v50, v51
    v_pk_add_f32 v[100:101], v[100:101], v[50:51]
    v_pk_fma_f32 v[102:103], v[50:51], v[50:51], v[102:103]
    v_lshlrev_b32 v96, 16, v90
    v_and_b32 v97, 0xffff0000, v90
    v_pk_add_f32 v[52:53], v[52:53], v[96:97]
    v_cvt_pk_bf16_f32 v250, v52, v53
    v_pk_add_f32 v[100:101], v[100:101], v[52:53]
    v_pk_fma_f32 v[102:103], v[52:53], v[52:53], v[102:103]
    v_lshlrev_b32 v96, 16, v91
    v_and_b32 v97, 0xffff0000, v91
    v_pk_add_f32 v[54:55], v[54:55], v[96:97]
    v_cvt_pk_bf16_f32 v251, v54, v55
    v_pk_add_f32 v[100:101], v[100:101], v[54:55]
    v_pk_fma_f32 v[102:103], v[54:55], v[54:55], v[102:103]
    buffer_store_dwordx4 v[248:251], v2, s[32:35], s57 offen offset:2048 sc1
    v_lshlrev_b32 v96, 16, v92
    v_and_b32 v97, 0xffff0000, v92
    v_pk_add_f32 v[56:57], v[56:57], v[96:97]
    v_cvt_pk_bf16_f32 v252, v56, v57
    v_pk_add_f32 v[100:101], v[100:101], v[56:57]
    v_pk_fma_f32 v[102:103], v[56:57], v[56:57], v[102:103]
    v_lshlrev_b32 v96, 16, v93
    v_and_b32 v97, 0xffff0000, v93
    v_pk_add_f32 v[58:59], v[58:59], v[96:97]
    v_cvt_pk_bf16_f32 v253, v58, v59
    v_pk_add_f32 v[100:101], v[100:101], v[58:59]
    v_pk_fma_f32 v[102:103], v[58:59], v[58:59], v[102:103]
    v_lshlrev_b32 v96, 16, v94
    v_and_b32 v97, 0xffff0000, v94
    v_pk_add_f32 v[60:61], v[60:61], v[96:97]
    v_cvt_pk_bf16_f32 v254, v60, v61
    v_pk_add_f32 v[100:101], v[100:101], v[60:61]
    v_pk_fma_f32 v[102:103], v[60:61], v[60:61], v[102:103]
    v_lshlrev_b32 v96, 16, v95
    v_and_b32 v97, 0xffff0000, v95
    v_pk_add_f32 v[62:63], v[62:63], v[96:97]
    v_cvt_pk_bf16_f32 v255, v62, v63
    v_pk_add_f32 v[100:101], v[100:101], v[62:63]
    v_pk_fma_f32 v[102:103], v[62:63], v[62:63], v[102:103]
    buffer_store_dwordx4 v[252:255], v2, s[32:35], s57 offen offset:3072 sc1
    v_add_f32 v100, v100, v101
    v_add_f32 v102, v102, v103
    v_mov_b32 v96, v100
    s_nop 1
    v_permlane32_swap_b32 v100, v96
    v_add_f32 v100, v100, v96
    v_mov_b32 v97, v102
    s_nop 1
    v_permlane32_swap_b32 v102, v97
    v_add_f32 v102, v102, v97
    v_mov_b32 v101, v102
    v_lshlrev_b32 v20, 3, v1
    v_cmp_gt_u32 vcc, 32, v1
    v_mov_b32 v21, 0x7ffffff0
    s_nop 0
    v_cndmask_b32 v20, v21, v20, vcc
    s_lshl_b32 s30, s22, 14
    s_lshl_b32 s31, s25, 8
    s_add_u32 s30, s30, s31
    s_add_u32 s30, s30, 25427968
    buffer_store_dwordx2 v[100:101], v20, s[32:35], s30 offen sc1
    v_and_b32 v11, 15, v1
    v_lshlrev_b32 v11, 7, v11
    s_add_u32 s28, s23, 48
    s_lshl_b32 s28, s28, 11
    v_add_u32 v11, s28, v11
    v_lshrrev_b32 v20, 4, v1
    v_lshlrev_b32 v20, 2, v20
    v_add_u32 v11, v11, v20
    v_mov_b32 v20, 0x7ffffff0
    v_cmp_gt_u32 vcc, 64, v0
    s_nop 1
    v_cndmask_b32 v11, v20, v11, vcc
    s_waitcnt vmcnt(0)
    s_barrier
    s_add_u32 s28, s21, 48
    s_lshl_b32 s28, s28, 4
    s_add_u32 s28, s28, s22
    s_lshl_b32 s28, s28, 7
    s_add_u32 s28, s28, 26214400
    v_mov_b32 v22, s27
    buffer_store_dword v22, v234, s[32:35], s28 offen sc1
    v_and_b32 v20, 3, v1
    v_and_b32 v21, 1, v1
    v_lshlrev_b32 v21, 4, v21
    v_mov_b32 v22, 0x3f80
    v_lshlrev_b32 v22, v21, v22
    v_mov_b32 v21, 0
    v_cmp_gt_u32 vcc, 2, v20
    s_nop 1
    v_cndmask_b32 v124, v21, v22, vcc
    v_cndmask_b32 v125, v22, v21, vcc
    v_and_b32 v21, 60, v1
    v_cmp_le_u32 vcc, 28, v21
    v_mov_b32 v22, 28
    v_mov_b32 v23, 0
    v_cndmask_b32 v22, v23, v22, vcc
    v_sub_u32 v21, v21, v22
    v_mov_b32 v22, 896
    v_cndmask_b32 v22, v23, v22, vcc
    v_lshlrev_b32 v21, 3, v21
    v_add_u32 v21, v21, v20
    v_lshlrev_b32 v21, 2, v21
    v_add_u32 v21, v21, v22
    s_mul_i32 s30, s20, 1792
    s_add_u32 s30, s30, 151552
    v_add_u32 v21, s30, v21
    v_cmp_gt_u32 vcc, 56, v1
    v_mov_b32 v22, 160768
    s_nop 0
    v_cndmask_b32 v30, v22, v21, vcc
    v_mov_b32 v128, 0
    v_mov_b32 v129, 0
    v_mov_b32 v130, 0
    v_mov_b32 v131, 0
    v_mov_b32 v132, 0
    v_mov_b32 v133, 0
    v_mov_b32 v134, 0
    v_mov_b32 v135, 0
    v_mfma_f32_4x4x4_16b_bf16 v[128:131], v[160:161], v[124:125], v[128:131]
    s_nop 0
    v_mfma_f32_4x4x4_16b_bf16 v[132:135], v[162:163], v[124:125], v[132:135]
    v_mfma_f32_4x4x4_16b_bf16 v[128:131], v[164:165], v[124:125], v[128:131]
    s_nop 0
    v_mfma_f32_4x4x4_16b_bf16 v[132:135], v[166:167], v[124:125], v[132:135]
    v_mfma_f32_4x4x4_16b_bf16 v[128:131], v[168:169], v[124:125], v[128:131]
    s_nop 0
    v_mfma_f32_4x4x4_16b_bf16 v[132:135], v[170:171], v[124:125], v[132:135]
    v_mfma_f32_4x4x4_16b_bf16 v[128:131], v[172:173], v[124:125], v[128:131]
    s_nop 0
    v_mfma_f32_4x4x4_16b_bf16 v[132:135], v[174:175], v[124:125], v[132:135]
    v_mfma_f32_4x4x4_16b_bf16 v[128:131], v[176:177], v[124:125], v[128:131]
    s_nop 0
    v_mfma_f32_4x4x4_16b_bf16 v[132:135], v[178:179], v[124:125], v[132:135]
    v_mfma_f32_4x4x4_16b_bf16 v[128:131], v[180:181], v[124:125], v[128:131]
    s_nop 0
    v_mfma_f32_4x4x4_16b_bf16 v[132:135], v[182:183], v[124:125], v[132:135]
    v_mfma_f32_4x4x4_16b_bf16 v[128:131], v[184:185], v[124:125], v[128:131]
    s_nop 0
    v_mfma_f32_4x4x4_16b_bf16 v[132:135], v[186:187], v[124:125], v[132:135]
    v_mfma_f32_4x4x4_16b_bf16 v[128:131], v[188:189], v[124:125], v[128:131]
    s_nop 0
    v_mfma_f32_4x4x4_16b_bf16 v[132:135], v[190:191], v[124:125], v[132:135]
    s_nop 2
    ds_write_b32 v30, v128 offset:0
    s_nop 0
    ds_write_b32 v30, v132 offset:16
    ds_write_b32 v30, v129 offset:32
    ds_write_b32 v30, v133 offset:48
    ds_write_b32 v30, v130 offset:64
    ds_write_b32 v30, v134 offset:80
    ds_write_b32 v30, v131 offset:96
    ds_write_b32 v30, v135 offset:112
    s_waitcnt lgkmcnt(0)
    s_add_u32 m0, s53, 32768
    s_add_u32 s50, s48, 2
    s_and_b32 s50, s50, 7
    s_mul_i32 s50, s50, 458752
    s_add_u32 s50, s50, s51
    buffer_load_dwordx4 v4, s[40:43], s50 offen lds
    s_add_u32 m0, s53, 33792
    s_add_u32 s50, s50, 28672
    buffer_load_dwordx4 v4, s[40:43], s50 offen lds
    s_add_u32 m0, s53, 34816
    s_add_u32 s50, s50, 28672
    buffer_load_dwordx4 v4, s[40:43], s50 offen lds
    s_add_u32 m0, s53, 35840
    s_add_u32 s50, s50, 28672
    buffer_load_dwordx4 v4, s[40:43], s50 offen lds
    s_add_u32 m0, s53, 49152
    s_add_u32 s50, s48, 3
    s_and_b32 s50, s50, 7
    s_mul_i32 s50, s50, 458752
    s_add_u32 s50, s50, s51
    buffer_load_dwordx4 v4, s[40:43], s50 offen lds
    s_add_u32 m0, s53, 50176
    s_add_u32 s50, s50, 28672
    buffer_load_dwordx4 v4, s[40:43], s50 offen lds
    s_add_u32 m0, s53, 51200
    s_add_u32 s50, s50, 28672
    buffer_load_dwordx4 v4, s[40:43], s50 offen lds
    s_add_u32 m0, s53, 52224
    s_add_u32 s50, s50, 28672
    buffer_load_dwordx4 v4, s[40:43], s50 offen lds
    s_cmp_lg_u32 s20, 0
    s_cbranch_scc1 L_join_13
    s_mov_b32 s30, 200000
    s_mov_b32 s31, 26214400
L_poll_14:
    buffer_load_dword v16, v11, s[32:35], s31 offen sc1
    s_waitcnt vmcnt(0)
    v_cmp_eq_u32 vcc, s27, v16
    s_nop 0
    s_cmp_eq_u64 vcc, -1
    s_cbranch_scc1 L_pdone_15
    s_sleep 1
    s_sub_u32 s30, s30, 1
    s_cmp_lg_u32 s30, 0
    s_cbranch_scc1 L_poll_14
L_pdone_15:
L_join_13:
    s_waitcnt vmcnt(0)
    s_barrier
    s_lshl_b32 s30, s26, 16
    s_add_u32 s30, s30, 4194304
    s_add_u32 s36, s18, s30
    s_addc_u32 s37, s19, 0
    s_and_b32 s37, s37, 0xffff
    s_mov_b32 s38, 65536
    s_mov_b32 s39, 0x20000
    s_add_u32 s49, s48, 0
    s_and_b32 s49, s49, 7
    s_lshl_b32 s49, s49, 12
    buffer_load_dwordx4 a[0:3], v2, s[36:39], s49 offen offset:0 sc1
    buffer_load_dwordx4 a[4:7], v2, s[36:39], s49 offen offset:1024 sc1
    buffer_load_dwordx4 a[8:11], v2, s[36:39], s49 offen offset:2048 sc1
    buffer_load_dwordx4 a[12:15], v2, s[36:39], s49 offen offset:3072 sc1
    s_add_u32 s49, s48, 1
    s_and_b32 s49, s49, 7
    s_lshl_b32 s49, s49, 12
    buffer_load_dwordx4 a[16:19], v2, s[36:39], s49 offen offset:0 sc1
    buffer_load_dwordx4 a[20:23], v2, s[36:39], s49 offen offset:1024 sc1
    buffer_load_dwordx4 a[24:27], v2, s[36:39], s49 offen offset:2048 sc1
    buffer_load_dwordx4 a[28:31], v2, s[36:39], s49 offen offset:3072 sc1
    v_and_b32 v20, 31, v1
    v_lshlrev_b32 v20, 3, v20
    v_lshrrev_b32 v21, 5, v1
    v_lshlrev_b32 v21, 17, v21
    v_add_u32 v20, v20, v21
    s_lshl_b32 s30, s26, 8
    s_add_u32 s30, s30, 25427968
    buffer_load_dwordx2 v[176:177], v20, s[32:35], s30 offen sc1
    s_add_u32 s30, s30, 16384
    buffer_load_dwordx2 v[178:179], v20, s[32:35], s30 offen sc1
    s_add_u32 s30, s30, 16384
    buffer_load_dwordx2 v[180:181], v20, s[32:35], s30 offen sc1
    s_add_u32 s30, s30, 16384
    buffer_load_dwordx2 v[182:183], v20, s[32:35], s30 offen sc1
    s_add_u32 s30, s30, 16384
    buffer_load_dwordx2 v[184:185], v20, s[32:35], s30 offen sc1
    s_add_u32 s30, s30, 16384
    buffer_load_dwordx2 v[186:187], v20, s[32:35], s30 offen sc1
    s_add_u32 s30, s30, 16384
    buffer_load_dwordx2 v[188:189], v20, s[32:35], s30 offen sc1
    s_add_u32 s30, s30, 16384
    buffer_load_dwordx2 v[190:191], v20, s[32:35], s30 offen sc1
    v_lshrrev_b32 v20, 5, v1
    v_lshlrev_b32 v20, 2, v20
    v_bfe_u32 v23, v1, 2, 2
    v_add_u32 v20, v20, v23
    v_lshlrev_b32 v21, 8, v20
    v_mul_u32_u24 v20, 192, v20
    v_lshlrev_b32 v22, 6, v23
    v_add_u32 v21, v21, v22
    v_bfe_u32 v23, v1, 4, 1
    v_lshlrev_b32 v23, 5, v23
    v_add_u32 v21, v21, v23
    v_add_u32 v20, v20, v23
    v_and_b32 v23, 3, v1
    v_lshlrev_b32 v23, 3, v23
    v_add_u32 v12, v21, v23
    v_add_u32 v20, v20, v23
    v_add_u32 v9, 65536, v20
    v_xor_b32 v13, 64, v12
    v_xor_b32 v14, 128, v12
    v_xor_b32 v15, 192, v12
    ds_read_b64_tr_b16 v[144:145], v12 offset:0
    ds_read_b64_tr_b16 v[146:147], v12 offset:2048
    ds_read_b64_tr_b16 v[148:149], v13 offset:0
    ds_read_b64_tr_b16 v[150:151], v13 offset:2048
    ds_read_b64_tr_b16 v[152:153], v14 offset:0
    ds_read_b64_tr_b16 v[154:155], v14 offset:2048
    ds_read_b64_tr_b16 v[156:157], v15 offset:0
    ds_read_b64_tr_b16 v[158:159], v15 offset:2048
    s_add_u32 s49, s48, 2
    s_and_b32 s49, s49, 7
    s_lshl_b32 s49, s49, 12
    buffer_load_dwordx4 a[32:35], v2, s[36:39], s49 offen offset:0 sc1
    buffer_load_dwordx4 a[36:39], v2, s[36:39], s49 offen offset:1024 sc1
    v_mov_b32 v32, 0
    v_mov_b32 v33, 0
    v_mov_b32 v34, 0
    v_mov_b32 v35, 0
    v_mov_b32 v36, 0
    v_mov_b32 v37, 0
    v_mov_b32 v38, 0
    v_mov_b32 v39, 0
    v_mov_b32 v40, 0
    v_mov_b32 v41, 0
    v_mov_b32 v42, 0
    v_mov_b32 v43, 0
    v_mov_b32 v44, 0
    v_mov_b32 v45, 0
    v_mov_b32 v46, 0
    v_mov_b32 v47, 0
    v_mov_b32 v48, 0
    v_mov_b32 v49, 0
    v_mov_b32 v50, 0
    v_mov_b32 v51, 0
    v_mov_b32 v52, 0
    v_mov_b32 v53, 0
    v_mov_b32 v54, 0
    v_mov_b32 v55, 0
    v_mov_b32 v56, 0
    v_mov_b32 v57, 0
    v_mov_b32 v58, 0
    v_mov_b32 v59, 0
    v_mov_b32 v60, 0
    v_mov_b32 v61, 0
    v_mov_b32 v62, 0
    v_mov_b32 v63, 0
    v_mov_b32 v64, 0
    v_mov_b32 v65, 0
    v_mov_b32 v66, 0
    v_mov_b32 v67, 0
    v_mov_b32 v68, 0
    v_mov_b32 v69, 0
    v_mov_b32 v70, 0
    v_mov_b32 v71, 0
    v_mov_b32 v72, 0
    v_mov_b32 v73, 0
    v_mov_b32 v74, 0
    v_mov_b32 v75, 0
    v_mov_b32 v76, 0
    v_mov_b32 v77, 0
    v_mov_b32 v78, 0
    v_mov_b32 v79, 0
    v_mov_b32 v80, 0
    v_mov_b32 v81, 0
    v_mov_b32 v82, 0
    v_mov_b32 v83, 0
    v_mov_b32 v84, 0
    v_mov_b32 v85, 0
    v_mov_b32 v86, 0
    v_mov_b32 v87, 0
    v_mov_b32 v88, 0
    v_mov_b32 v89, 0
    v_mov_b32 v90, 0
    v_mov_b32 v91, 0
    v_mov_b32 v92, 0
    v_mov_b32 v93, 0
    v_mov_b32 v94, 0
    v_mov_b32 v95, 0
    v_mov_b32 v96, 0
    v_mov_b32 v97, 0
    v_mov_b32 v98, 0
    v_mov_b32 v99, 0
    v_mov_b32 v100, 0
    v_mov_b32 v101, 0
    v_mov_b32 v102, 0
    v_mov_b32 v103, 0
    v_mov_b32 v104, 0
    v_mov_b32 v105, 0
    v_mov_b32 v106, 0
    v_mov_b32 v107, 0
    v_mov_b32 v108, 0
    v_mov_b32 v109, 0
    v_mov_b32 v110, 0
    v_mov_b32 v111, 0
    v_mov_b32 v112, 0
    v_mov_b32 v113, 0
    v_mov_b32 v114, 0
    v_mov_b32 v115, 0
    v_mov_b32 v116, 0
    v_mov_b32 v117, 0
    v_mov_b32 v118, 0
    v_mov_b32 v119, 0
    v_mov_b32 v120, 0
    v_mov_b32 v121, 0
    v_mov_b32 v122, 0
    v_mov_b32 v123, 0
    v_mov_b32 v124, 0
    v_mov_b32 v125, 0
    v_mov_b32 v126, 0
    v_mov_b32 v127, 0
    v_mov_b32 v128, 0
    v_mov_b32 v129, 0
    v_mov_b32 v130, 0
    v_mov_b32 v131, 0
    v_mov_b32 v132, 0
    v_mov_b32 v133, 0
    v_mov_b32 v134, 0
    v_mov_b32 v135, 0
    v_mov_b32 v136, 0
    v_mov_b32 v137, 0
    v_mov_b32 v138, 0
    v_mov_b32 v139, 0
    v_mov_b32 v140, 0
    v_mov_b32 v141, 0
    v_mov_b32 v142, 0
    v_mov_b32 v143, 0
    v_mov_b32 v214, 0x3f803f80
    v_mov_b32 v215, 0x3f803f80
    s_waitcnt vmcnt(17) lgkmcnt(4)
    v_mfma_f32_32x32x16_bf16 v[32:47], v[144:147], a[0:3], v[32:47]
    ds_read_b64_tr_b16 v[144:145], v12 offset:4096
    ds_read_b64_tr_b16 v[146:147], v12 offset:6144
    v_lshlrev_b32 v24, 2, v0
    v_mov_b32 v26, 0x7ffffff0
    v_cmp_gt_u32 vcc, 224, v0
    v_mfma_f32_32x32x16_bf16 v[48:63], v[148:151], a[0:3], v[48:63]
    buffer_load_dwordx4 a[40:43], v2, s[36:39], s49 offen offset:2048 sc1
    ds_read_b64_tr_b16 v[148:149], v13 offset:4096
    ds_read_b64_tr_b16 v[150:151], v13 offset:6144
    v_cndmask_b32 v28, v26, v24, vcc
    v_add_u32 v25, 151552, v24
    ds_read_b32 v200, v25 offset:0
    s_waitcnt lgkmcnt(5)
    v_mfma_f32_32x32x16_bf16 v[64:79], v[152:155], a[0:3], v[64:79]
    ds_read_b64_tr_b16 v[152:153], v14 offset:4096
    ds_read_b64_tr_b16 v[154:155], v14 offset:6144
    ds_read_b32 v201, v25 offset:896
    ds_read_b32 v202, v25 offset:1792
    ds_read_b32 v203, v25 offset:2688
    v_mfma_f32_32x32x16_bf16 v[80:95], v[156:159], a[0:3], v[80:95]
    ds_read_b64_tr_b16 v[156:157], v15 offset:4096
    ds_read_b64_tr_b16 v[158:159], v15 offset:6144
    ds_read_b32 v204, v25 offset:3584
    ds_read_b32 v205, v25 offset:4480
    ds_read_b32 v206, v25 offset:5376
    s_waitcnt vmcnt(17) lgkmcnt(11)
    v_mfma_f32_32x32x16_bf16 v[32:47], v[144:147], a[4:7], v[32:47]
    ds_read_b64_tr_b16 v[144:145], v12 offset:8192
    ds_read_b64_tr_b16 v[146:147], v12 offset:10240
    ds_read_b32 v207, v25 offset:6272
    s_mul_i32 s87, s21, 14336
    s_mul_i32 s88, s22, 896
    v_mfma_f32_32x32x16_bf16 v[48:63], v[148:151], a[4:7], v[48:63]
    buffer_load_dwordx4 a[44:47], v2, s[36:39], s49 offen offset:3072 sc1
    ds_read_b64_tr_b16 v[148:149], v13 offset:8192
    ds_read_b64_tr_b16 v[150:151], v13 offset:10240
    s_add_u32 s87, s87, s88
    s_add_u32 s87, s87, 25755648
    s_waitcnt lgkmcnt(2)
    s_waitcnt lgkmcnt(8)
    v_mfma_f32_32x32x16_bf16 v[64:79], v[152:155], a[4:7], v[64:79]
    ds_read_b64_tr_b16 v[152:153], v14 offset:8192
    ds_read_b64_tr_b16 v[154:155], v14 offset:10240
    v_add_f32 v200, v200, v201
    v_add_f32 v200, v200, v202
    v_add_f32 v200, v200, v203
    v_mfma_f32_32x32x16_bf16 v[80:95], v[156:159], a[4:7], v[80:95]
    ds_read_b64_tr_b16 v[156:157], v15 offset:8192
    ds_read_b64_tr_b16 v[158:159], v15 offset:10240
    v_add_f32 v200, v200, v204
    v_add_f32 v200, v200, v205
    v_add_f32 v200, v200, v206
    s_waitcnt vmcnt(17) lgkmcnt(4)
    v_mfma_f32_32x32x16_bf16 v[32:47], v[144:147], a[8:11], v[32:47]
    ds_read_b64_tr_b16 v[144:145], v12 offset:12288
    ds_read_b64_tr_b16 v[146:147], v12 offset:14336
    s_add_u32 s49, s48, 3
    s_and_b32 s49, s49, 7
    s_lshl_b32 s49, s49, 12
    v_add_f32 v200, v200, v207
    buffer_store_dword v200, v28, s[32:35], s87 offen sc1
    v_mfma_f32_32x32x16_bf16 v[48:63], v[148:151], a[8:11], v[48:63]
    buffer_load_dwordx4 a[48:51], v2, s[36:39], s49 offen offset:0 sc1
    ds_read_b64_tr_b16 v[148:149], v13 offset:12288
    ds_read_b64_tr_b16 v[150:151], v13 offset:14336
    s_waitcnt lgkmcnt(4)
    v_mfma_f32_32x32x16_bf16 v[64:79], v[152:155], a[8:11], v[64:79]
    ds_read_b64_tr_b16 v[152:153], v14 offset:12288
    ds_read_b64_tr_b16 v[154:155], v14 offset:14336
    v_mfma_f32_32x32x16_bf16 v[80:95], v[156:159], a[8:11], v[80:95]
    ds_read_b64_tr_b16 v[156:157], v15 offset:12288
    ds_read_b64_tr_b16 v[158:159], v15 offset:14336
    s_waitcnt vmcnt(18) lgkmcnt(4)
    v_mfma_f32_32x32x16_bf16 v[32:47], v[144:147], a[12:15], v[32:47]
    ds_read_b64_tr_b16 v[144:145], v12 offset:16384
    ds_read_b64_tr_b16 v[146:147], v12 offset:18432
    v_mfma_f32_32x32x16_bf16 v[48:63], v[148:151], a[12:15], v[48:63]
    buffer_load_dwordx4 a[52:55], v2, s[36:39], s49 offen offset:1024 sc1
    ds_read_b64_tr_b16 v[148:149], v13 offset:16384
    ds_read_b64_tr_b16 v[150:151], v13 offset:18432
    s_waitcnt lgkmcnt(4)
    v_mfma_f32_32x32x16_bf16 v[64:79], v[152:155], a[12:15], v[64:79]
    ds_read_b64_tr_b16 v[152:153], v14 offset:16384
    ds_read_b64_tr_b16 v[154:155], v14 offset:18432
    v_mfma_f32_32x32x16_bf16 v[80:95], v[156:159], a[12:15], v[80:95]
    ds_read_b64_tr_b16 v[156:157], v15 offset:16384
    ds_read_b64_tr_b16 v[158:159], v15 offset:18432
    s_barrier
    s_waitcnt vmcnt(18) lgkmcnt(4)
    v_mfma_f32_32x32x16_bf16 v[32:47], v[144:147], a[16:19], v[32:47]
    ds_read_b64_tr_b16 v[144:145], v12 offset:20480
    ds_read_b64_tr_b16 v[146:147], v12 offset:22528
    s_add_u32 m0, s53, 0
    s_add_u32 s50, s48, 4
    s_and_b32 s50, s50, 7
    s_mul_i32 s50, s50, 458752
    s_add_u32 s50, s50, s51
    v_mfma_f32_32x32x16_bf16 v[48:63], v[148:151], a[16:19], v[48:63]
    buffer_load_dwordx4 v4, s[40:43], s50 offen lds
    ds_read_b64_tr_b16 v[148:149], v13 offset:20480
    ds_read_b64_tr_b16 v[150:151], v13 offset:22528
    s_add_u32 m0, s53, 1024
    s_add_u32 s50, s50, 28672
    s_waitcnt lgkmcnt(4)
    v_mfma_f32_32x32x16_bf16 v[64:79], v[152:155], a[16:19], v[64:79]
    buffer_load_dwordx4 v4, s[40:43], s50 offen lds
    ds_read_b64_tr_b16 v[152:153], v14 offset:20480
    ds_read_b64_tr_b16 v[154:155], v14 offset:22528
    s_add_u32 m0, s53, 2048
    s_add_u32 s50, s50, 28672
    v_mfma_f32_32x32x16_bf16 v[80:95], v[156:159], a[16:19], v[80:95]
    buffer_load_dwordx4 v4, s[40:43], s50 offen lds
    ds_read_b64_tr_b16 v[156:157], v15 offset:20480
    ds_read_b64_tr_b16 v[158:159], v15 offset:22528
    s_waitcnt vmcnt(20) lgkmcnt(4)
    v_mfma_f32_32x32x16_bf16 v[32:47], v[144:147], a[20:23], v[32:47]
    ds_read_b64_tr_b16 v[144:145], v12 offset:24576
    ds_read_b64_tr_b16 v[146:147], v12 offset:26624
    s_add_u32 m0, s53, 3072
    s_add_u32 s50, s50, 28672
    v_mfma_f32_32x32x16_bf16 v[48:63], v[148:151], a[20:23], v[48:63]
    buffer_load_dwordx4 v4, s[40:43], s50 offen lds
    ds_read_b64_tr_b16 v[148:149], v13 offset:24576
    ds_read_b64_tr_b16 v[150:151], v13 offset:26624
    s_waitcnt lgkmcnt(4)
    v_mfma_f32_32x32x16_bf16 v[64:79], v[152:155], a[20:23], v[64:79]
    buffer_load_dwordx4 a[56:59], v2, s[36:39], s49 offen offset:2048 sc1
    ds_read_b64_tr_b16 v[152:153], v14 offset:24576
    ds_read_b64_tr_b16 v[154:155], v14 offset:26624
    v_mfma_f32_32x32x16_bf16 v[80:95], v[156:159], a[20:23], v[80:95]
    buffer_load_dwordx4 a[60:63], v2, s[36:39], s49 offen offset:3072 sc1
    ds_read_b64_tr_b16 v[156:157], v15 offset:24576
    ds_read_b64_tr_b16 v[158:159], v15 offset:26624
    s_waitcnt vmcnt(22) lgkmcnt(4)
    v_mfma_f32_32x32x16_bf16 v[32:47], v[144:147], a[24:27], v[32:47]
    ds_read_b64_tr_b16 v[144:145], v12 offset:28672
    ds_read_b64_tr_b16 v[146:147], v12 offset:30720
    s_add_u32 s49, s48, 4
    s_and_b32 s49, s49, 7
    s_lshl_b32 s49, s49, 12
    v_mfma_f32_32x32x16_bf16 v[48:63], v[148:151], a[24:27], v[48:63]
    buffer_load_dwordx4 a[64:67], v2, s[36:39], s49 offen offset:0 sc1
    ds_read_b64_tr_b16 v[148:149], v13 offset:28672
    ds_read_b64_tr_b16 v[150:151], v13 offset:30720
    s_waitcnt lgkmcnt(4)
    v_mfma_f32_32x32x16_bf16 v[64:79], v[152:155], a[24:27], v[64:79]
    ds_read_b64_tr_b16 v[152:153], v14 offset:28672
    ds_read_b64_tr_b16 v[154:155], v14 offset:30720
    v_mfma_f32_32x32x16_bf16 v[80:95], v[156:159], a[24:27], v[80:95]
    ds_read_b64_tr_b16 v[156:157], v15 offset:28672
    ds_read_b64_tr_b16 v[158:159], v15 offset:30720
    s_waitcnt vmcnt(22) lgkmcnt(4)
    v_mfma_f32_32x32x16_bf16 v[32:47], v[144:147], a[28:31], v[32:47]
    ds_read_b64_tr_b16 v[144:145], v12 offset:32768
    ds_read_b64_tr_b16 v[146:147], v12 offset:34816
    v_mfma_f32_32x32x16_bf16 v[48:63], v[148:151], a[28:31], v[48:63]
    buffer_load_dwordx4 a[68:71], v2, s[36:39], s49 offen offset:1024 sc1
    ds_read_b64_tr_b16 v[148:149], v13 offset:32768
    ds_read_b64_tr_b16 v[150:151], v13 offset:34816
    s_waitcnt lgkmcnt(4)
    v_mfma_f32_32x32x16_bf16 v[64:79], v[152:155], a[28:31], v[64:79]
    ds_read_b64_tr_b16 v[152:153], v14 offset:32768
    ds_read_b64_tr_b16 v[154:155], v14 offset:34816
    v_mfma_f32_32x32x16_bf16 v[80:95], v[156:159], a[28:31], v[80:95]
    ds_read_b64_tr_b16 v[156:157], v15 offset:32768
    ds_read_b64_tr_b16 v[158:159], v15 offset:34816
    s_barrier
    s_waitcnt vmcnt(14) lgkmcnt(4)
    v_mfma_f32_32x32x16_bf16 v[32:47], v[144:147], a[32:35], v[32:47]
    ds_read_b64_tr_b16 v[144:145], v12 offset:36864
    ds_read_b64_tr_b16 v[146:147], v12 offset:38912
    s_add_u32 m0, s53, 16384
    s_add_u32 s50, s48, 5
    s_and_b32 s50, s50, 7
    s_mul_i32 s50, s50, 458752
    s_add_u32 s50, s50, s51
    s_waitcnt vmcnt(15)
    v_add_f32 v176, v176, v178
    v_add_f32 v177, v177, v179
    v_mfma_f32_32x32x16_bf16 v[48:63], v[148:151], a[32:35], v[48:63]
    buffer_load_dwordx4 v4, s[40:43], s50 offen lds
    ds_read_b64_tr_b16 v[148:149], v13 offset:36864
    ds_read_b64_tr_b16 v[150:151], v13 offset:38912
    s_add_u32 m0, s53, 17408
    s_add_u32 s50, s50, 28672
    v_add_f32 v176, v176, v180
    v_add_f32 v177, v177, v181
    v_add_f32 v176, v176, v182
    s_waitcnt lgkmcnt(4)
    v_mfma_f32_32x32x16_bf16 v[64:79], v[152:155], a[32:35], v[64:79]
    buffer_load_dwordx4 v4, s[40:43], s50 offen lds
    ds_read_b64_tr_b16 v[152:153], v14 offset:36864
    ds_read_b64_tr_b16 v[154:155], v14 offset:38912
    s_add_u32 m0, s53, 18432
    s_add_u32 s50, s50, 28672
    v_add_f32 v177, v177, v183
    v_add_f32 v176, v176, v184
    v_add_f32 v177, v177, v185
    v_mfma_f32_32x32x16_bf16 v[80:95], v[156:159], a[32:35], v[80:95]
    buffer_load_dwordx4 v4, s[40:43], s50 offen lds
    ds_read_b64_tr_b16 v[156:157], v15 offset:36864
    ds_read_b64_tr_b16 v[158:159], v15 offset:38912
    v_add_f32 v176, v176, v186
    v_add_f32 v177, v177, v187
    v_add_f32 v176, v176, v188
    s_waitcnt vmcnt(16) lgkmcnt(4)
    v_mfma_f32_32x32x16_bf16 v[32:47], v[144:147], a[36:39], v[32:47]
    ds_read_b64_tr_b16 v[144:145], v12 offset:40960
    ds_read_b64_tr_b16 v[146:147], v12 offset:43008
    s_add_u32 m0, s53, 19456
    s_add_u32 s50, s50, 28672
    v_add_f32 v177, v177, v189
    v_add_f32 v176, v176, v190
    v_add_f32 v177, v177, v191
    v_mfma_f32_32x32x16_bf16 v[48:63], v[148:151], a[36:39], v[48:63]
    buffer_load_dwordx4 v4, s[40:43], s50 offen lds
    ds_read_b64_tr_b16 v[148:149], v13 offset:40960
    ds_read_b64_tr_b16 v[150:151], v13 offset:43008
    v_mov_b32 v24, v176
    s_nop 1
    v_permlane32_swap_b32 v176, v24
    v_add_f32 v176, v176, v24
    s_waitcnt lgkmcnt(4)
    v_mfma_f32_32x32x16_bf16 v[64:79], v[152:155], a[36:39], v[64:79]
    buffer_load_dwordx4 a[72:75], v2, s[36:39], s49 offen offset:2048 sc1
    ds_read_b64_tr_b16 v[152:153], v14 offset:40960
    ds_read_b64_tr_b16 v[154:155], v14 offset:43008
    s_add_u32 m0, s52, 65536
    s_add_u32 s55, s48, 0
    s_and_b32 s55, s55, 7
    s_mul_i32 s55, s55, 458752
    s_add_u32 s55, s55, s51
    v_mov_b32 v25, v177
    s_nop 1
    v_permlane32_swap_b32 v177, v25
    v_add_f32 v177, v177, v25
    v_mfma_f32_32x32x16_bf16 v[80:95], v[156:159], a[36:39], v[80:95]
    buffer_load_dwordx4 v5, s[40:43], s55 offen lds
    ds_read_b64_tr_b16 v[156:157], v15 offset:40960
    ds_read_b64_tr_b16 v[158:159], v15 offset:43008
    v_mul_f32 v176, 0x3a800000, v176
    v_mul_f32 v177, 0x3a800000, v177
    v_fma_f32 v177, -v176, v176, v177
    s_waitcnt vmcnt(18) lgkmcnt(4)
    v_mfma_f32_32x32x16_bf16 v[32:47], v[144:147], a[40:43], v[32:47]
    ds_read_b64_tr_b16 v[144:145], v12 offset:45056
    ds_read_b64_tr_b16 v[146:147], v12 offset:47104
    s_add_u32 m0, s52, 66560
    v_add_f32 v177, 0x3727c5ac, v177
    v_rsq_f32 v174, v177
    v_sub_f32 v172, 0, v176
    v_mfma_f32_32x32x16_bf16 v[48:63], v[148:151], a[40:43], v[48:63]
    buffer_load_dwordx4 v6, s[40:43], s55 offen lds
    ds_read_b64_tr_b16 v[148:149], v13 offset:45056
    ds_read_b64_tr_b16 v[150:151], v13 offset:47104
    s_add_u32 m0, s52, 67584
    v_mov_b32 v208, 0xc0135761
    v_mov_b32 v210, 0xbdd2d3e8
    v_mov_b32 v212, 1.0
    s_waitcnt lgkmcnt(4)
    v_mfma_f32_32x32x16_bf16 v[64:79], v[152:155], a[40:43], v[64:79]
    buffer_load_dwordx4 v7, s[40:43], s55 offen lds
    ds_read_b64_tr_b16 v[152:153], v14 offset:45056
    ds_read_b64_tr_b16 v[154:155], v14 offset:47104
    v_mfma_f32_32x32x16_bf16 v[80:95], v[156:159], a[40:43], v[80:95]
    buffer_load_dwordx4 a[76:79], v2, s[36:39], s49 offen offset:3072 sc1
    ds_read_b64_tr_b16 v[156:157], v15 offset:45056
    ds_read_b64_tr_b16 v[158:159], v15 offset:47104
    s_waitcnt vmcnt(20) lgkmcnt(4)
    v_mfma_f32_32x32x16_bf16 v[32:47], v[144:147], a[44:47], v[32:47]
    ds_read_b64_tr_b16 v[144:145], v12 offset:49152
    ds_read_b64_tr_b16 v[146:147], v12 offset:51200
    s_add_u32 s49, s48, 5
    s_and_b32 s49, s49, 7
    s_lshl_b32 s49, s49, 12
    v_mfma_f32_32x32x16_bf16 v[48:63], v[148:151], a[44:47], v[48:63]
    buffer_load_dwordx4 a[80:83], v2, s[36:39], s49 offen offset:0 sc1
    ds_read_b64_tr_b16 v[148:149], v13 offset:49152
    ds_read_b64_tr_b16 v[150:151], v13 offset:51200
    s_waitcnt lgkmcnt(4)
    v_mfma_f32_32x32x16_bf16 v[64:79], v[152:155], a[44:47], v[64:79]
    buffer_load_dwordx4 a[84:87], v2, s[36:39], s49 offen offset:1024 sc1
    ds_read_b64_tr_b16 v[152:153], v14 offset:49152
    ds_read_b64_tr_b16 v[154:155], v14 offset:51200
    v_mfma_f32_32x32x16_bf16 v[80:95], v[156:159], a[44:47], v[80:95]
    ds_read_b64_tr_b16 v[156:157], v15 offset:49152
    ds_read_b64_tr_b16 v[158:159], v15 offset:51200
    s_waitcnt vmcnt(15)
    s_barrier
    s_waitcnt vmcnt(20) lgkmcnt(4)
    v_mfma_f32_32x32x16_bf16 v[32:47], v[144:147], a[48:51], v[32:47]
    ds_read_b64_tr_b16 v[144:145], v12 offset:53248
    ds_read_b64_tr_b16 v[146:147], v12 offset:55296
    s_add_u32 m0, s53, 32768
    s_add_u32 s50, s48, 6
    s_and_b32 s50, s50, 7
    s_mul_i32 s50, s50, 458752
    s_add_u32 s50, s50, s51
    v_mfma_f32_32x32x16_bf16 v[48:63], v[148:151], a[48:51], v[48:63]
    buffer_load_dwordx4 v4, s[40:43], s50 offen lds
    ds_read_b64_tr_b16 v[148:149], v13 offset:53248
    ds_read_b64_tr_b16 v[150:151], v13 offset:55296
    s_add_u32 m0, s53, 33792
    s_add_u32 s50, s50, 28672
    s_waitcnt lgkmcnt(4)
    v_mfma_f32_32x32x16_bf16 v[64:79], v[152:155], a[48:51], v[64:79]
    buffer_load_dwordx4 v4, s[40:43], s50 offen lds
    ds_read_b64_tr_b16 v[152:153], v14 offset:53248
    ds_read_b64_tr_b16 v[154:155], v14 offset:55296
    s_add_u32 m0, s53, 34816
    s_add_u32 s50, s50, 28672
    v_mfma_f32_32x32x16_bf16 v[80:95], v[156:159], a[48:51], v[80:95]
    buffer_load_dwordx4 v4, s[40:43], s50 offen lds
    ds_read_b64_tr_b16 v[156:157], v15 offset:53248
    ds_read_b64_tr_b16 v[158:159], v15 offset:55296
    s_waitcnt vmcnt(22) lgkmcnt(4)
    v_mfma_f32_32x32x16_bf16 v[32:47], v[144:147], a[52:55], v[32:47]
    ds_read_b64_tr_b16 v[144:145], v12 offset:57344
    ds_read_b64_tr_b16 v[146:147], v12 offset:59392
    s_add_u32 m0, s53, 35840
    s_add_u32 s50, s50, 28672
    v_mfma_f32_32x32x16_bf16 v[48:63], v[148:151], a[52:55], v[48:63]
    buffer_load_dwordx4 v4, s[40:43], s50 offen lds
    ds_read_b64_tr_b16 v[148:149], v13 offset:57344
    ds_read_b64_tr_b16 v[150:151], v13 offset:59392
    s_waitcnt lgkmcnt(4)
    v_mfma_f32_32x32x16_bf16 v[64:79], v[152:155], a[52:55], v[64:79]
    buffer_load_dwordx4 a[88:91], v2, s[36:39], s49 offen offset:2048 sc1
    ds_read_b64_tr_b16 v[152:153], v14 offset:57344
    ds_read_b64_tr_b16 v[154:155], v14 offset:59392
    s_add_u32 m0, s52, 77824
    s_add_u32 s55, s48, 1
    s_and_b32 s55, s55, 7
    s_mul_i32 s55, s55, 458752
    s_add_u32 s55, s55, s51
    v_mfma_f32_32x32x16_bf16 v[80:95], v[156:159], a[52:55], v[80:95]
    buffer_load_dwordx4 v5, s[40:43], s55 offen lds
    ds_read_b64_tr_b16 v[156:157], v15 offset:57344
    ds_read_b64_tr_b16 v[158:159], v15 offset:59392
    s_waitcnt vmcnt(20) lgkmcnt(4)
    v_mfma_f32_32x32x16_bf16 v[32:47], v[144:147], a[56:59], v[32:47]
    ds_read_b64_tr_b16 v[144:145], v12 offset:61440
    ds_read_b64_tr_b16 v[146:147], v12 offset:63488
    s_add_u32 m0, s52, 78848
    v_mfma_f32_32x32x16_bf16 v[48:63], v[148:151], a[56:59], v[48:63]
    buffer_load_dwordx4 v6, s[40:43], s55 offen lds
    ds_read_b64_tr_b16 v[148:149], v13 offset:61440
    ds_read_b64_tr_b16 v[150:151], v13 offset:63488
    s_add_u32 m0, s52, 79872
    s_waitcnt lgkmcnt(4)
    v_mfma_f32_32x32x16_bf16 v[64:79], v[152:155], a[56:59], v[64:79]
    buffer_load_dwordx4 v7, s[40:43], s55 offen lds
    ds_read_b64_tr_b16 v[152:153], v14 offset:61440
    ds_read_b64_tr_b16 v[154:155], v14 offset:63488
    v_mfma_f32_32x32x16_bf16 v[80:95], v[156:159], a[56:59], v[80:95]
    buffer_load_dwordx4 a[92:95], v2, s[36:39], s49 offen offset:3072 sc1
    ds_read_b64_tr_b16 v[156:157], v15 offset:61440
    ds_read_b64_tr_b16 v[158:159], v15 offset:63488
    s_waitcnt vmcnt(22) lgkmcnt(4)
    v_mfma_f32_32x32x16_bf16 v[32:47], v[144:147], a[60:63], v[32:47]
    ds_read_b64_tr_b16 v[144:145], v12 offset:0
    ds_read_b64_tr_b16 v[146:147], v12 offset:2048
    s_add_u32 s49, s48, 6
    s_and_b32 s49, s49, 7
    s_lshl_b32 s49, s49, 12
    v_mfma_f32_32x32x16_bf16 v[48:63], v[148:151], a[60:63], v[48:63]
    buffer_load_dwordx4 a[96:99], v2, s[36:39], s49 offen offset:0 sc1
    ds_read_b64_tr_b16 v[148:149], v13 offset:0
    ds_read_b64_tr_b16 v[150:151], v13 offset:2048
    s_waitcnt lgkmcnt(4)
    v_mfma_f32_32x32x16_bf16 v[64:79], v[152:155], a[60:63], v[64:79]
    buffer_load_dwordx4 a[100:103], v2, s[36:39], s49 offen offset:1024 sc1
    ds_read_b64_tr_b16 v[152:153], v14 offset:0
    ds_read_b64_tr_b16 v[154:155], v14 offset:2048
    v_mfma_f32_32x32x16_bf16 v[80:95], v[156:159], a[60:63], v[80:95]
    ds_read_b64_tr_b16 v[156:157], v15 offset:0
    ds_read_b64_tr_b16 v[158:159], v15 offset:2048
    s_waitcnt vmcnt(18)
    s_waitcnt vmcnt(32)
    s_barrier
    s_add_u32 s28, s22, 64
    s_lshl_b32 s28, s28, 4
    s_add_u32 s28, s28, s21
    s_lshl_b32 s28, s28, 7
    s_add_u32 s28, s28, 26214400
    v_mov_b32 v20, s27
    buffer_store_dword v20, v234, s[32:35], s28 offen sc1
    s_waitcnt vmcnt(24) lgkmcnt(4)
    v_mfma_f32_32x32x16_bf16 v[32:47], v[144:147], a[64:67], v[32:47]
    ds_read_b64_tr_b16 v[144:145], v12 offset:4096
    ds_read_b64_tr_b16 v[146:147], v12 offset:6144
    s_add_u32 m0, s53, 49152
    s_add_u32 s50, s48, 7
    s_and_b32 s50, s50, 7
    s_mul_i32 s50, s50, 458752
    s_add_u32 s50, s50, s51
    v_lshrrev_b32 v24, 5, v1
    v_lshlrev_b32 v24, 4, v24
    v_add_u32 v24, 159744, v24
    v_mfma_f32_32x32x16_bf16 v[48:63], v[148:151], a[64:67], v[48:63]
    buffer_load_dwordx4 v4, s[40:43], s50 offen lds
    ds_read_b64_tr_b16 v[148:149], v13 offset:4096
    ds_read_b64_tr_b16 v[150:151], v13 offset:6144
    s_add_u32 m0, s53, 50176
    s_add_u32 s50, s50, 28672
    s_lshl_b32 s87, s54, 7
    v_add_u32 v17, s87, v24
    s_xor_b32 s87, s54, 1
    s_waitcnt lgkmcnt(4)
    v_mfma_f32_32x32x16_bf16 v[64:79], v[152:155], a[64:67], v[64:79]
    buffer_load_dwordx4 v4, s[40:43], s50 offen lds
    ds_read_b64_tr_b16 v[152:153], v14 offset:4096
    ds_read_b64_tr_b16 v[154:155], v14 offset:6144
    s_add_u32 m0, s53, 51200
    s_add_u32 s50, s50, 28672
    s_lshl_b32 s87, s87, 9
    v_add_u32 v18, s87, v24
    v_add_u32 v19, 640, v24
    v_mfma_f32_32x32x16_bf16 v[80:95], v[156:159], a[64:67], v[80:95]
    buffer_load_dwordx4 v4, s[40:43], s50 offen lds
    ds_read_b64_tr_b16 v[156:157], v15 offset:4096
    ds_read_b64_tr_b16 v[158:159], v15 offset:6144
    s_mul_i32 s57, s26, 229376
    s_mul_i32 s87, s24, 14336
    s_add_u32 s57, s57, s87
    s_waitcnt vmcnt(26) lgkmcnt(4)
    v_mfma_f32_32x32x16_bf16 v[32:47], v[144:147], a[68:71], v[32:47]
    ds_read_b64_tr_b16 v[144:145], v12 offset:8192
    ds_read_b64_tr_b16 v[146:147], v12 offset:10240
    s_add_u32 m0, s53, 52224
    s_add_u32 s50, s50, 28672
    s_add_u32 s57, s57, 8388608
    s_lshl_b32 s87, s54, 11
    s_add_u32 s82, s57, s87
    v_mfma_f32_32x32x16_bf16 v[48:63], v[148:151], a[68:71], v[48:63]
    buffer_load_dwordx4 v4, s[40:43], s50 offen lds
    ds_read_b64_tr_b16 v[148:149], v13 offset:8192
    ds_read_b64_tr_b16 v[150:151], v13 offset:10240
    v_lshrrev_b32 v24, 3, v1
    v_lshlrev_b32 v24, 11, v24
    v_lshrrev_b32 v25, 4, v1
    s_waitcnt lgkmcnt(4)
    v_mfma_f32_32x32x16_bf16 v[64:79], v[152:155], a[68:71], v[64:79]
    buffer_load_dwordx4 a[104:107], v2, s[36:39], s49 offen offset:2048 sc1
    ds_read_b64_tr_b16 v[152:153], v14 offset:8192
    ds_read_b64_tr_b16 v[154:155], v14 offset:10240
    s_add_u32 m0, s52, 90112
    s_add_u32 s55, s48, 2
    s_and_b32 s55, s55, 7
    s_mul_i32 s55, s55, 458752
    s_add_u32 s55, s55, s51
    v_and_b32 v25, 1, v25
    v_lshlrev_b32 v25, 2, v25
    v_and_b32 v8, 7, v1
    v_mfma_f32_32x32x16_bf16 v[80:95], v[156:159], a[68:71], v[80:95]
    buffer_load_dwordx4 v5, s[40:43], s55 offen lds
    ds_read_b64_tr_b16 v[156:157], v15 offset:8192
    ds_read_b64_tr_b16 v[158:159], v15 offset:10240
    v_xor_b32 v8, v8, v25
    v_lshlrev_b32 v8, 4, v8
    v_add_u32 v8, v8, v24
    s_waitcnt vmcnt(24) lgkmcnt(4)
    v_mfma_f32_32x32x16_bf16 v[32:47], v[144:147], a[72:75], v[32:47]
    ds_read_b64_tr_b16 v[144:145], v12 offset:12288
    ds_read_b64_tr_b16 v[146:147], v12 offset:14336
    s_add_u32 m0, s52, 91136
    s_lshr_b32 s87, s22, 1
    s_lshl_b32 s87, s87, 8
    s_sub_u32 s88, 7340032, s87
    v_mfma_f32_32x32x16_bf16 v[48:63], v[148:151], a[72:75], v[48:63]
    buffer_load_dwordx4 v6, s[40:43], s55 offen lds
    ds_read_b64_tr_b16 v[148:149], v13 offset:12288
    ds_read_b64_tr_b16 v[150:151], v13 offset:14336
    s_add_u32 m0, s52, 92160
    s_add_u32 s44, s12, s87
    s_addc_u32 s45, s13, 0
    s_and_b32 s45, s45, 0xffff
    s_mov_b32 s46, s88
    s_mov_b32 s47, 0x20000
    s_lshl_b32 s81, s20, 11
    s_lshl_b32 s87, s20, 15
    s_waitcnt lgkmcnt(4)
    v_mfma_f32_32x32x16_bf16 v[64:79], v[152:155], a[72:75], v[64:79]
    buffer_load_dwordx4 v7, s[40:43], s55 offen lds
    ds_read_b64_tr_b16 v[152:153], v14 offset:12288
    ds_read_b64_tr_b16 v[154:155], v14 offset:14336
    s_and_b32 s88, s22, 1
    s_lshl_b32 s88, s88, 7
    s_add_u32 s80, s87, s88
    v_mfma_f32_32x32x16_bf16 v[80:95], v[156:159], a[72:75], v[80:95]
    buffer_load_dwordx4 a[108:111], v2, s[36:39], s49 offen offset:3072 sc1
    ds_read_b64_tr_b16 v[156:157], v15 offset:12288
    ds_read_b64_tr_b16 v[158:159], v15 offset:14336
    s_xor_b32 s88, s88, 128
    s_add_u32 s84, s87, s88
    s_lshr_b32 s87, s22, 1
    s_waitcnt vmcnt(23) lgkmcnt(4)
    v_mfma_f32_32x32x16_bf16 v[32:47], v[144:147], a[76:79], v[32:47]
    ds_read_b64_tr_b16 v[144:145], v12 offset:16384
    ds_read_b64_tr_b16 v[146:147], v12 offset:18432
    s_add_u32 s49, s48, 7
    s_and_b32 s49, s49, 7
    s_lshl_b32 s49, s49, 12
    s_add_u32 s87, s87, s21
    s_add_u32 s88, s87, 0
    s_and_b32 s88, s88, 3
    v_mfma_f32_32x32x16_bf16 v[48:63], v[148:151], a[76:79], v[48:63]
    buffer_load_dwordx4 a[112:115], v2, s[36:39], s49 offen offset:0 sc1
    ds_read_b64_tr_b16 v[148:149], v13 offset:16384
    ds_read_b64_tr_b16 v[150:151], v13 offset:18432
    s_lshl_b32 s88, s88, 3
    s_or_b32 s72, s88, 0x80000
    s_add_u32 s88, s87, 1
    s_waitcnt lgkmcnt(4)
    v_mfma_f32_32x32x16_bf16 v[64:79], v[152:155], a[76:79], v[64:79]
    buffer_load_dwordx4 a[116:119], v2, s[36:39], s49 offen offset:1024 sc1
    ds_read_b64_tr_b16 v[152:153], v14 offset:16384
    ds_read_b64_tr_b16 v[154:155], v14 offset:18432
    s_and_b32 s88, s88, 3
    s_lshl_b32 s88, s88, 3
    s_or_b32 s73, s88, 0x80000
    v_mfma_f32_32x32x16_bf16 v[80:95], v[156:159], a[76:79], v[80:95]
    ds_read_b64_tr_b16 v[156:157], v15 offset:16384
    ds_read_b64_tr_b16 v[158:159], v15 offset:18432
    s_add_u32 s88, s87, 2
    s_and_b32 s88, s88, 3
    s_lshl_b32 s88, s88, 3
    s_waitcnt vmcnt(19)
    s_waitcnt vmcnt(26)
    s_barrier
    s_waitcnt vmcnt(24) lgkmcnt(4)
    v_mfma_f32_32x32x16_bf16 v[32:47], v[144:147], a[80:83], v[32:47]
    ds_read_b64_tr_b16 v[144:145], v12 offset:20480
    ds_read_b64_tr_b16 v[146:147], v12 offset:22528
    s_add_u32 m0, s53, 0
    s_add_u32 s50, s48, 0
    s_and_b32 s50, s50, 7
    s_add_u32 s50, s50, 8
    s_mul_i32 s50, s50, 458752
    s_add_u32 s50, s50, s51
    s_or_b32 s74, s88, 0x80000
    s_add_u32 s88, s87, 3
    s_and_b32 s88, s88, 3
    v_mfma_f32_32x32x16_bf16 v[48:63], v[148:151], a[80:83], v[48:63]
    buffer_load_dwordx4 v4, s[40:43], s50 offen lds
    ds_read_b64_tr_b16 v[148:149], v13 offset:20480
    ds_read_b64_tr_b16 v[150:151], v13 offset:22528
    s_add_u32 m0, s53, 1024
    s_add_u32 s50, s50, 28672
    s_lshl_b32 s88, s88, 3
    s_or_b32 s75, s88, 0x80000
    s_bitcmp0_b32 s22, 0
    s_mov_b32 s88, 0x64482c10
    s_cselect_b32 s64, 0x54381c00, s88
    s_waitcnt lgkmcnt(4)
    v_mfma_f32_32x32x16_bf16 v[64:79], v[152:155], a[80:83], v[64:79]
    buffer_load_dwordx4 v4, s[40:43], s50 offen lds
    ds_read_b64_tr_b16 v[152:153], v14 offset:20480
    ds_read_b64_tr_b16 v[154:155], v14 offset:22528
    s_add_u32 m0, s53, 2048
    s_add_u32 s50, s50, 28672
    s_bitcmp0_b32 s22, 0
    s_mov_b32 s88, 0xd4b89c80
    s_cselect_b32 s65, 0xc4a88c70, s88
    s_bitcmp0_b32 s22, 0
    s_mov_b32 s88, 0x28201408
    s_cselect_b32 s66, 0x24180c04, s88
    s_bitcmp0_b32 s22, 0
    s_mov_b32 s88, 0x584c4034
    s_cselect_b32 s67, 0x50443c30, s88
    v_mfma_f32_32x32x16_bf16 v[80:95], v[156:159], a[80:83], v[80:95]
    buffer_load_dwordx4 v4, s[40:43], s50 offen lds
    ds_read_b64_tr_b16 v[156:157], v15 offset:20480
    ds_read_b64_tr_b16 v[158:159], v15 offset:22528
    s_bitcmp0_b32 s22, 0
    s_mov_b32 s88, 0x84786c60
    s_cselect_b32 s68, 0x7c74685c, s88
    s_bitcmp0_b32 s22, 0
    s_mov_b32 s88, 0xb0a49890
    s_cselect_b32 s69, 0xaca09488, s88
    s_bitcmp0_b32 s22, 0
    s_mov_b32 s88, 0xdcd0c8bc
    s_cselect_b32 s70, 0xd8ccc0b4, s88
    s_waitcnt vmcnt(26) lgkmcnt(4)
    v_mfma_f32_32x32x16_bf16 v[32:47], v[144:147], a[84:87], v[32:47]
    ds_read_b64_tr_b16 v[144:145], v12 offset:24576
    ds_read_b64_tr_b16 v[146:147], v12 offset:26624
    s_add_u32 m0, s53, 3072
    s_add_u32 s50, s50, 28672
    v_mfma_f32_32x32x16_bf16 v[48:63], v[148:151], a[84:87], v[48:63]
    buffer_load_dwordx4 v4, s[40:43], s50 offen lds
    ds_read_b64_tr_b16 v[148:149], v13 offset:24576
    ds_read_b64_tr_b16 v[150:151], v13 offset:26624
    s_waitcnt lgkmcnt(4)
    v_mfma_f32_32x32x16_bf16 v[64:79], v[152:155], a[84:87], v[64:79]
    buffer_load_dwordx4 a[120:123], v2, s[36:39], s49 offen offset:2048 sc1
    ds_read_b64_tr_b16 v[152:153], v14 offset:24576
    ds_read_b64_tr_b16 v[154:155], v14 offset:26624
    s_add_u32 m0, s52, 102400
    s_add_u32 s55, s48, 3
    s_and_b32 s55, s55, 7
    s_mul_i32 s55, s55, 458752
    s_add_u32 s55, s55, s51
    v_mfma_f32_32x32x16_bf16 v[80:95], v[156:159], a[84:87], v[80:95]
    buffer_load_dwordx4 v5, s[40:43], s55 offen lds
    ds_read_b64_tr_b16 v[156:157], v15 offset:24576
    ds_read_b64_tr_b16 v[158:159], v15 offset:26624
    s_waitcnt vmcnt(24) lgkmcnt(4)
    v_mfma_f32_32x32x16_bf16 v[32:47], v[144:147], a[88:91], v[32:47]
    ds_read_b64_tr_b16 v[144:145], v12 offset:28672
    ds_read_b64_tr_b16 v[146:147], v12 offset:30720
    s_add_u32 m0, s52, 103424
    v_mfma_f32_32x32x16_bf16 v[48:63], v[148:151], a[88:91], v[48:63]
    buffer_load_dwordx4 v6, s[40:43], s55 offen lds
    ds_read_b64_tr_b16 v[148:149], v13 offset:28672
    ds_read_b64_tr_b16 v[150:151], v13 offset:30720
    s_add_u32 m0, s52, 104448
    s_waitcnt lgkmcnt(4)
    v_mfma_f32_32x32x16_bf16 v[64:79], v[152:155], a[88:91], v[64:79]
    buffer_load_dwordx4 v7, s[40:43], s55 offen lds
    ds_read_b64_tr_b16 v[152:153], v14 offset:28672
    ds_read_b64_tr_b16 v[154:155], v14 offset:30720
    v_mfma_f32_32x32x16_bf16 v[80:95], v[156:159], a[88:91], v[80:95]
    buffer_load_dwordx4 a[124:127], v2, s[36:39], s49 offen offset:3072 sc1
    ds_read_b64_tr_b16 v[156:157], v15 offset:28672
    ds_read_b64_tr_b16 v[158:159], v15 offset:30720
    s_waitcnt vmcnt(23) lgkmcnt(4)
    v_mfma_f32_32x32x16_bf16 v[32:47], v[144:147], a[92:95], v[32:47]
    ds_read_b64_tr_b16 v[144:145], v12 offset:32768
    ds_read_b64_tr_b16 v[146:147], v12 offset:34816
    ds_read_b64_tr_b16 v[160:161], v9 offset:0
    ds_read_b64_tr_b16 v[162:163], v9 offset:1536
    s_add_u32 s49, s48, 0
    s_and_b32 s49, s49, 7
    s_add_u32 s49, s49, 8
    s_lshl_b32 s49, s49, 12
    v_mfma_f32_32x32x16_bf16 v[48:63], v[148:151], a[92:95], v[48:63]
    buffer_load_dwordx4 a[128:131], v2, s[36:39], s49 offen offset:0 sc1
    ds_read_b64_tr_b16 v[148:149], v13 offset:32768
    ds_read_b64_tr_b16 v[150:151], v13 offset:34816
    ds_read_b64_tr_b16 v[164:165], v9 offset:64
    ds_read_b64_tr_b16 v[166:167], v9 offset:1600
    s_waitcnt lgkmcnt(8)
    v_mfma_f32_32x32x16_bf16 v[64:79], v[152:155], a[92:95], v[64:79]
    buffer_load_dwordx4 a[132:135], v2, s[36:39], s49 offen offset:1024 sc1
    ds_read_b64_tr_b16 v[152:153], v14 offset:32768
    ds_read_b64_tr_b16 v[154:155], v14 offset:34816
    ds_read_b64_tr_b16 v[168:169], v9 offset:128
    ds_read_b64_tr_b16 v[170:171], v9 offset:1664
    v_mfma_f32_32x32x16_bf16 v[80:95], v[156:159], a[92:95], v[80:95]
    ds_read_b64_tr_b16 v[156:157], v15 offset:32768
    ds_read_b64_tr_b16 v[158:159], v15 offset:34816
    s_waitcnt vmcnt(18)
    s_waitcnt vmcnt(26)
    s_barrier
    s_waitcnt vmcnt(24) lgkmcnt(0)
    v_mfma_f32_32x32x16_bf16 v[32:47], v[144:147], a[96:99], v[32:47]
    ds_read_b64_tr_b16 v[144:145], v12 offset:36864
    ds_read_b64_tr_b16 v[146:147], v12 offset:38912
    s_add_u32 m0, s53, 16384
    s_add_u32 s50, s48, 1
    s_and_b32 s50, s50, 7
    s_add_u32 s50, s50, 8
    s_mul_i32 s50, s50, 458752
    s_add_u32 s50, s50, s51
    v_mfma_f32_32x32x16_bf16 v[48:63], v[148:151], a[96:99], v[48:63]
    buffer_load_dwordx4 v4, s[40:43], s50 offen lds
    ds_read_b64_tr_b16 v[148:149], v13 offset:36864
    ds_read_b64_tr_b16 v[150:151], v13 offset:38912
    v_mfma_f32_32x32x16_bf16 v[64:79], v[152:155], a[96:99], v[64:79]
    ds_read_b64_tr_b16 v[152:153], v14 offset:36864
    ds_read_b64_tr_b16 v[154:155], v14 offset:38912
    s_add_u32 m0, s53, 17408
    s_add_u32 s50, s50, 28672
    v_mfma_f32_32x32x16_bf16 v[80:95], v[156:159], a[96:99], v[80:95]
    buffer_load_dwordx4 v4, s[40:43], s50 offen lds
    ds_read_b64_tr_b16 v[156:157], v15 offset:36864
    ds_read_b64_tr_b16 v[158:159], v15 offset:38912
    s_waitcnt lgkmcnt(14)
    v_mfma_f32_32x32x16_bf16 v[96:111], v[160:163], a[0:3], v[96:111]
    ds_read_b64_tr_b16 v[160:161], v9 offset:3072
    ds_read_b64_tr_b16 v[162:163], v9 offset:4608
    s_add_u32 m0, s53, 18432
    s_add_u32 s50, s50, 28672
    v_mfma_f32_32x32x16_bf16 v[112:127], v[164:167], a[0:3], v[112:127]
    buffer_load_dwordx4 v4, s[40:43], s50 offen lds
    ds_read_b64_tr_b16 v[164:165], v9 offset:3136
    ds_read_b64_tr_b16 v[166:167], v9 offset:4672
    s_waitcnt lgkmcnt(14)
    v_mfma_f32_32x32x16_bf16 v[128:143], v[168:171], a[0:3], v[128:143]
    ds_read_b64_tr_b16 v[168:169], v9 offset:3200
    ds_read_b64_tr_b16 v[170:171], v9 offset:4736
    s_waitcnt vmcnt(26) lgkmcnt(6)
    v_mfma_f32_32x32x16_bf16 v[32:47], v[144:147], a[100:103], v[32:47]
    ds_read_b64_tr_b16 v[144:145], v12 offset:40960
    ds_read_b64_tr_b16 v[146:147], v12 offset:43008
    s_add_u32 m0, s53, 19456
    s_add_u32 s50, s50, 28672
    v_mfma_f32_32x32x16_bf16 v[48:63], v[148:151], a[100:103], v[48:63]
    buffer_load_dwordx4 v4, s[40:43], s50 offen lds
    ds_read_b64_tr_b16 v[148:149], v13 offset:40960
    ds_read_b64_tr_b16 v[150:151], v13 offset:43008
    v_mfma_f32_32x32x16_bf16 v[64:79], v[152:155], a[100:103], v[64:79]
    ds_read_b64_tr_b16 v[152:153], v14 offset:40960
    ds_read_b64_tr_b16 v[154:155], v14 offset:43008
    v_mfma_f32_32x32x16_bf16 v[80:95], v[156:159], a[100:103], v[80:95]
    buffer_load_dwordx4 a[136:139], v2, s[36:39], s49 offen offset:2048 sc1
    ds_read_b64_tr_b16 v[156:157], v15 offset:40960
    ds_read_b64_tr_b16 v[158:159], v15 offset:43008
    s_waitcnt lgkmcnt(8)
    v_mfma_f32_32x32x16_bf16 v[96:111], v[160:163], a[4:7], v[96:111]
    ds_read_b64_tr_b16 v[160:161], v9 offset:6144
    ds_read_b64_tr_b16 v[162:163], v9 offset:7680
    s_add_u32 m0, s52, 114688
    s_add_u32 s55, s48, 4
    s_and_b32 s55, s55, 7
    s_mul_i32 s55, s55, 458752
    s_add_u32 s55, s55, s51
    v_mfma_f32_32x32x16_bf16 v[112:127], v[164:167], a[4:7], v[112:127]
    buffer_load_dwordx4 v5, s[40:43], s55 offen lds
    ds_read_b64_tr_b16 v[164:165], v9 offset:6208
    ds_read_b64_tr_b16 v[166:167], v9 offset:7744
    v_mfma_f32_32x32x16_bf16 v[128:143], v[168:171], a[4:7], v[128:143]
    ds_read_b64_tr_b16 v[168:169], v9 offset:6272
    ds_read_b64_tr_b16 v[170:171], v9 offset:7808
    s_waitcnt vmcnt(23) lgkmcnt(6)
    v_mfma_f32_32x32x16_bf16 v[32:47], v[144:147], a[104:107], v[32:47]
    ds_read_b64_tr_b16 v[144:145], v12 offset:45056
    ds_read_b64_tr_b16 v[146:147], v12 offset:47104
    s_add_u32 m0, s52, 115712
    v_mfma_f32_32x32x16_bf16 v[48:63], v[148:151], a[104:107], v[48:63]
    buffer_load_dwordx4 v6, s[40:43], s55 offen lds
    ds_read_b64_tr_b16 v[148:149], v13 offset:45056
    ds_read_b64_tr_b16 v[150:151], v13 offset:47104
    v_mfma_f32_32x32x16_bf16 v[64:79], v[152:155], a[104:107], v[64:79]
    ds_read_b64_tr_b16 v[152:153], v14 offset:45056
    ds_read_b64_tr_b16 v[154:155], v14 offset:47104
    s_add_u32 m0, s52, 116736
    v_mfma_f32_32x32x16_bf16 v[80:95], v[156:159], a[104:107], v[80:95]
    buffer_load_dwordx4 v7, s[40:43], s55 offen lds
    ds_read_b64_tr_b16 v[156:157], v15 offset:45056
    ds_read_b64_tr_b16 v[158:159], v15 offset:47104
    s_waitcnt lgkmcnt(8)
    v_mfma_f32_32x32x16_bf16 v[96:111], v[160:163], a[8:11], v[96:111]
    ds_read_b64_tr_b16 v[160:161], v9 offset:9216
    ds_read_b64_tr_b16 v[162:163], v9 offset:10752
    v_mfma_f32_32x32x16_bf16 v[112:127], v[164:167], a[8:11], v[112:127]
    buffer_load_dwordx4 a[140:143], v2, s[36:39], s49 offen offset:3072 sc1
    ds_read_b64_tr_b16 v[164:165], v9 offset:9280
    ds_read_b64_tr_b16 v[166:167], v9 offset:10816
    v_mfma_f32_32x32x16_bf16 v[128:143], v[168:171], a[8:11], v[128:143]
    ds_read_b64_tr_b16 v[168:169], v9 offset:9344
    ds_read_b64_tr_b16 v[170:171], v9 offset:10880
    s_waitcnt vmcnt(22) lgkmcnt(6)
    v_mfma_f32_32x32x16_bf16 v[32:47], v[144:147], a[108:111], v[32:47]
    ds_read_b64_tr_b16 v[144:145], v12 offset:49152
    ds_read_b64_tr_b16 v[146:147], v12 offset:51200
    s_add_u32 s49, s48, 1
    s_and_b32 s49, s49, 7
    s_add_u32 s49, s49, 8
    s_lshl_b32 s49, s49, 12
    v_mfma_f32_32x32x16_bf16 v[48:63], v[148:151], a[108:111], v[48:63]
    buffer_load_dwordx4 a[144:147], v2, s[36:39], s49 offen offset:0 sc1
    ds_read_b64_tr_b16 v[148:149], v13 offset:49152
    ds_read_b64_tr_b16 v[150:151], v13 offset:51200
    v_mfma_f32_32x32x16_bf16 v[64:79], v[152:155], a[108:111], v[64:79]
    ds_read_b64_tr_b16 v[152:153], v14 offset:49152
    ds_read_b64_tr_b16 v[154:155], v14 offset:51200
    v_mfma_f32_32x32x16_bf16 v[80:95], v[156:159], a[108:111], v[80:95]
    buffer_load_dwordx4 a[148:151], v2, s[36:39], s49 offen offset:1024 sc1
    ds_read_b64_tr_b16 v[156:157], v15 offset:49152
    ds_read_b64_tr_b16 v[158:159], v15 offset:51200
    s_waitcnt lgkmcnt(8)
    v_mfma_f32_32x32x16_bf16 v[96:111], v[160:163], a[12:15], v[96:111]
    ds_read_b64_tr_b16 v[160:161], v9 offset:12288
    ds_read_b64_tr_b16 v[162:163], v9 offset:13824
    v_mfma_f32_32x32x16_bf16 v[112:127], v[164:167], a[12:15], v[112:127]
    ds_read_b64_tr_b16 v[164:165], v9 offset:12352
    ds_read_b64_tr_b16 v[166:167], v9 offset:13888
    v_mfma_f32_32x32x16_bf16 v[128:143], v[168:171], a[12:15], v[128:143]
    ds_read_b64_tr_b16 v[168:169], v9 offset:12416
    ds_read_b64_tr_b16 v[170:171], v9 offset:13952
    s_waitcnt vmcnt(18)
    s_waitcnt vmcnt(25)
    s_barrier
    s_waitcnt vmcnt(23) lgkmcnt(6)
    v_mfma_f32_32x32x16_bf16 v[32:47], v[144:147], a[112:115], v[32:47]
    ds_read_b64_tr_b16 v[144:145], v12 offset:53248
    ds_read_b64_tr_b16 v[146:147], v12 offset:55296
    s_add_u32 m0, s53, 32768
    s_add_u32 s50, s48, 2
    s_and_b32 s50, s50, 7
    s_add_u32 s50, s50, 8
    s_mul_i32 s50, s50, 458752
    s_add_u32 s50, s50, s51
    v_mfma_f32_32x32x16_bf16 v[48:63], v[148:151], a[112:115], v[48:63]
    buffer_load_dwordx4 v4, s[40:43], s50 offen lds
    ds_read_b64_tr_b16 v[148:149], v13 offset:53248
    ds_read_b64_tr_b16 v[150:151], v13 offset:55296
    v_mfma_f32_32x32x16_bf16 v[64:79], v[152:155], a[112:115], v[64:79]
    ds_read_b64_tr_b16 v[152:153], v14 offset:53248
    ds_read_b64_tr_b16 v[154:155], v14 offset:55296
    s_add_u32 m0, s53, 33792
    s_add_u32 s50, s50, 28672
    v_mfma_f32_32x32x16_bf16 v[80:95], v[156:159], a[112:115], v[80:95]
    buffer_load_dwordx4 v4, s[40:43], s50 offen lds
    ds_read_b64_tr_b16 v[156:157], v15 offset:53248
    ds_read_b64_tr_b16 v[158:159], v15 offset:55296
    s_waitcnt lgkmcnt(8)
    v_mfma_f32_32x32x16_bf16 v[96:111], v[160:163], a[16:19], v[96:111]
    ds_read_b64_tr_b16 v[160:161], v9 offset:15360
    ds_read_b64_tr_b16 v[162:163], v9 offset:16896
    s_add_u32 m0, s53, 34816
    s_add_u32 s50, s50, 28672
    v_mfma_f32_32x32x16_bf16 v[112:127], v[164:167], a[16:19], v[112:127]
    buffer_load_dwordx4 v4, s[40:43], s50 offen lds
    ds_read_b64_tr_b16 v[164:165], v9 offset:15424
    ds_read_b64_tr_b16 v[166:167], v9 offset:16960
    v_mfma_f32_32x32x16_bf16 v[128:143], v[168:171], a[16:19], v[128:143]
    ds_read_b64_tr_b16 v[168:169], v9 offset:15488
    ds_read_b64_tr_b16 v[170:171], v9 offset:17024
    s_waitcnt vmcnt(25) lgkmcnt(6)
    v_mfma_f32_32x32x16_bf16 v[32:47], v[144:147], a[116:119], v[32:47]
    ds_read_b64_tr_b16 v[144:145], v12 offset:57344
    ds_read_b64_tr_b16 v[146:147], v12 offset:59392
    s_add_u32 m0, s53, 35840
    s_add_u32 s50, s50, 28672
    v_mfma_f32_32x32x16_bf16 v[48:63], v[148:151], a[116:119], v[48:63]
    buffer_load_dwordx4 v4, s[40:43], s50 offen lds
    ds_read_b64_tr_b16 v[148:149], v13 offset:57344
    ds_read_b64_tr_b16 v[150:151], v13 offset:59392
    v_mfma_f32_32x32x16_bf16 v[64:79], v[152:155], a[116:119], v[64:79]
    ds_read_b64_tr_b16 v[152:153], v14 offset:57344
    ds_read_b64_tr_b16 v[154:155], v14 offset:59392
    v_mfma_f32_32x32x16_bf16 v[80:95], v[156:159], a[116:119], v[80:95]
    buffer_load_dwordx4 a[152:155], v2, s[36:39], s49 offen offset:2048 sc1
    ds_read_b64_tr_b16 v[156:157], v15 offset:57344
    ds_read_b64_tr_b16 v[158:159], v15 offset:59392
    s_waitcnt lgkmcnt(8)
    v_mfma_f32_32x32x16_bf16 v[96:111], v[160:163], a[20:23], v[96:111]
    ds_read_b64_tr_b16 v[160:161], v9 offset:18432
    ds_read_b64_tr_b16 v[162:163], v9 offset:19968
    s_add_u32 m0, s52, 65536
    s_add_u32 s55, s48, 5
    s_and_b32 s55, s55, 7
    s_mul_i32 s55, s55, 458752
    s_add_u32 s55, s55, s51
    v_mfma_f32_32x32x16_bf16 v[112:127], v[164:167], a[20:23], v[112:127]
    buffer_load_dwordx4 v5, s[40:43], s55 offen lds
    ds_read_b64_tr_b16 v[164:165], v9 offset:18496
    ds_read_b64_tr_b16 v[166:167], v9 offset:20032
    v_mfma_f32_32x32x16_bf16 v[128:143], v[168:171], a[20:23], v[128:143]
    ds_read_b64_tr_b16 v[168:169], v9 offset:18560
    ds_read_b64_tr_b16 v[170:171], v9 offset:20096
    s_waitcnt vmcnt(23) lgkmcnt(6)
    v_mfma_f32_32x32x16_bf16 v[32:47], v[144:147], a[120:123], v[32:47]
    ds_read_b64_tr_b16 v[144:145], v12 offset:61440
    ds_read_b64_tr_b16 v[146:147], v12 offset:63488
    s_add_u32 m0, s52, 66560
    v_mfma_f32_32x32x16_bf16 v[48:63], v[148:151], a[120:123], v[48:63]
    buffer_load_dwordx4 v6, s[40:43], s55 offen lds
    ds_read_b64_tr_b16 v[148:149], v13 offset:61440
    ds_read_b64_tr_b16 v[150:151], v13 offset:63488
    v_mfma_f32_32x32x16_bf16 v[64:79], v[152:155], a[120:123], v[64:79]
    ds_read_b64_tr_b16 v[152:153], v14 offset:61440
    ds_read_b64_tr_b16 v[154:155], v14 offset:63488
    s_add_u32 m0, s52, 67584
    v_mfma_f32_32x32x16_bf16 v[80:95], v[156:159], a[120:123], v[80:95]
    buffer_load_dwordx4 v7, s[40:43], s55 offen lds
    ds_read_b64_tr_b16 v[156:157], v15 offset:61440
    ds_read_b64_tr_b16 v[158:159], v15 offset:63488
    s_waitcnt lgkmcnt(8)
    v_mfma_f32_32x32x16_bf16 v[96:111], v[160:163], a[24:27], v[96:111]
    ds_read_b64_tr_b16 v[160:161], v9 offset:21504
    ds_read_b64_tr_b16 v[162:163], v9 offset:23040
    v_mfma_f32_32x32x16_bf16 v[112:127], v[164:167], a[24:27], v[112:127]
    buffer_load_dwordx4 a[156:159], v2, s[36:39], s49 offen offset:3072 sc1
    ds_read_b64_tr_b16 v[164:165], v9 offset:21568
    ds_read_b64_tr_b16 v[166:167], v9 offset:23104
    v_mfma_f32_32x32x16_bf16 v[128:143], v[168:171], a[24:27], v[128:143]
    ds_read_b64_tr_b16 v[168:169], v9 offset:21632
    ds_read_b64_tr_b16 v[170:171], v9 offset:23168
    s_waitcnt vmcnt(22) lgkmcnt(6)
    v_mfma_f32_32x32x16_bf16 v[32:47], v[144:147], a[124:127], v[32:47]
    ds_read_b64_tr_b16 v[144:145], v12 offset:0
    ds_read_b64_tr_b16 v[146:147], v12 offset:2048
    s_add_u32 s49, s48, 2
    s_and_b32 s49, s49, 7
    s_add_u32 s49, s49, 8
    s_lshl_b32 s49, s49, 12
    v_mfma_f32_32x32x16_bf16 v[48:63], v[148:151], a[124:127], v[48:63]
    buffer_load_dwordx4 a[160:163], v2, s[36:39], s49 offen offset:0 sc1
    ds_read_b64_tr_b16 v[148:149], v13 offset:0
    ds_read_b64_tr_b16 v[150:151], v13 offset:2048
    v_mfma_f32_32x32x16_bf16 v[64:79], v[152:155], a[124:127], v[64:79]
    ds_read_b64_tr_b16 v[152:153], v14 offset:0
    ds_read_b64_tr_b16 v[154:155], v14 offset:2048
    v_mfma_f32_32x32x16_bf16 v[80:95], v[156:159], a[124:127], v[80:95]
    buffer_load_dwordx4 a[164:167], v2, s[36:39], s49 offen offset:1024 sc1
    ds_read_b64_tr_b16 v[156:157], v15 offset:0
    ds_read_b64_tr_b16 v[158:159], v15 offset:2048
    s_waitcnt lgkmcnt(8)
    v_mfma_f32_32x32x16_bf16 v[96:111], v[160:163], a[28:31], v[96:111]
    ds_read_b64_tr_b16 v[160:161], v9 offset:24576
    ds_read_b64_tr_b16 v[162:163], v9 offset:26112
    v_mfma_f32_32x32x16_bf16 v[112:127], v[164:167], a[28:31], v[112:127]
    ds_read_b64_tr_b16 v[164:165], v9 offset:24640
    ds_read_b64_tr_b16 v[166:167], v9 offset:26176
    v_mfma_f32_32x32x16_bf16 v[128:143], v[168:171], a[28:31], v[128:143]
    ds_read_b64_tr_b16 v[168:169], v9 offset:24704
    ds_read_b64_tr_b16 v[170:171], v9 offset:26240
    s_waitcnt vmcnt(18)
    s_waitcnt vmcnt(25)
    s_barrier
    s_waitcnt vmcnt(23) lgkmcnt(6)
    v_mfma_f32_32x32x16_bf16 v[32:47], v[144:147], a[128:131], v[32:47]
    ds_read_b64_tr_b16 v[144:145], v12 offset:4096
    ds_read_b64_tr_b16 v[146:147], v12 offset:6144
    s_add_u32 m0, s53, 49152
    s_add_u32 s50, s48, 3
    s_and_b32 s50, s50, 7
    s_add_u32 s50, s50, 8
    s_mul_i32 s50, s50, 458752
    s_add_u32 s50, s50, s51
    v_mfma_f32_32x32x16_bf16 v[48:63], v[148:151], a[128:131], v[48:63]
    buffer_load_dwordx4 v4, s[40:43], s50 offen lds
    ds_read_b64_tr_b16 v[148:149], v13 offset:4096
    ds_read_b64_tr_b16 v[150:151], v13 offset:6144
    v_mfma_f32_32x32x16_bf16 v[64:79], v[152:155], a[128:131], v[64:79]
    ds_read_b64_tr_b16 v[152:153], v14 offset:4096
    ds_read_b64_tr_b16 v[154:155], v14 offset:6144
    s_add_u32 m0, s53, 50176
    s_add_u32 s50, s50, 28672
    v_mfma_f32_32x32x16_bf16 v[80:95], v[156:159], a[128:131], v[80:95]
    buffer_load_dwordx4 v4, s[40:43], s50 offen lds
    ds_read_b64_tr_b16 v[156:157], v15 offset:4096
    ds_read_b64_tr_b16 v[158:159], v15 offset:6144
    s_waitcnt lgkmcnt(8)
    v_mfma_f32_32x32x16_bf16 v[96:111], v[160:163], a[32:35], v[96:111]
    ds_read_b64_tr_b16 v[160:161], v9 offset:27648
    ds_read_b64_tr_b16 v[162:163], v9 offset:29184
    s_add_u32 m0, s53, 51200
    s_add_u32 s50, s50, 28672
    v_mfma_f32_32x32x16_bf16 v[112:127], v[164:167], a[32:35], v[112:127]
    buffer_load_dwordx4 v4, s[40:43], s50 offen lds
    ds_read_b64_tr_b16 v[164:165], v9 offset:27712
    ds_read_b64_tr_b16 v[166:167], v9 offset:29248
    v_mfma_f32_32x32x16_bf16 v[128:143], v[168:171], a[32:35], v[128:143]
    ds_read_b64_tr_b16 v[168:169], v9 offset:27776
    ds_read_b64_tr_b16 v[170:171], v9 offset:29312
    s_waitcnt vmcnt(25) lgkmcnt(6)
    v_mfma_f32_32x32x16_bf16 v[32:47], v[144:147], a[132:135], v[32:47]
    ds_read_b64_tr_b16 v[144:145], v12 offset:8192
    ds_read_b64_tr_b16 v[146:147], v12 offset:10240
    s_add_u32 m0, s53, 52224
    s_add_u32 s50, s50, 28672
    v_mfma_f32_32x32x16_bf16 v[48:63], v[148:151], a[132:135], v[48:63]
    buffer_load_dwordx4 v4, s[40:43], s50 offen lds
    ds_read_b64_tr_b16 v[148:149], v13 offset:8192
    ds_read_b64_tr_b16 v[150:151], v13 offset:10240
    v_mfma_f32_32x32x16_bf16 v[64:79], v[152:155], a[132:135], v[64:79]
    ds_read_b64_tr_b16 v[152:153], v14 offset:8192
    ds_read_b64_tr_b16 v[154:155], v14 offset:10240
    v_mfma_f32_32x32x16_bf16 v[80:95], v[156:159], a[132:135], v[80:95]
    buffer_load_dwordx4 a[168:171], v2, s[36:39], s49 offen offset:2048 sc1
    ds_read_b64_tr_b16 v[156:157], v15 offset:8192
    ds_read_b64_tr_b16 v[158:159], v15 offset:10240
    s_waitcnt lgkmcnt(8)
    v_mfma_f32_32x32x16_bf16 v[96:111], v[160:163], a[36:39], v[96:111]
    ds_read_b64_tr_b16 v[160:161], v9 offset:30720
    ds_read_b64_tr_b16 v[162:163], v9 offset:32256
    s_add_u32 m0, s52, 77824
    s_add_u32 s55, s48, 6
    s_and_b32 s55, s55, 7
    s_mul_i32 s55, s55, 458752
    s_add_u32 s55, s55, s51
    v_mfma_f32_32x32x16_bf16 v[112:127], v[164:167], a[36:39], v[112:127]
    buffer_load_dwordx4 v5, s[40:43], s55 offen lds
    ds_read_b64_tr_b16 v[164:165], v9 offset:30784
    ds_read_b64_tr_b16 v[166:167], v9 offset:32320
    v_mfma_f32_32x32x16_bf16 v[128:143], v[168:171], a[36:39], v[128:143]
    ds_read_b64_tr_b16 v[168:169], v9 offset:30848
    ds_read_b64_tr_b16 v[170:171], v9 offset:32384
    s_waitcnt vmcnt(23) lgkmcnt(6)
    v_mfma_f32_32x32x16_bf16 v[32:47], v[144:147], a[136:139], v[32:47]
    ds_read_b64_tr_b16 v[144:145], v12 offset:12288
    ds_read_b64_tr_b16 v[146:147], v12 offset:14336
    s_add_u32 m0, s52, 78848
    v_mfma_f32_32x32x16_bf16 v[48:63], v[148:151], a[136:139], v[48:63]
    buffer_load_dwordx4 v6, s[40:43], s55 offen lds
    ds_read_b64_tr_b16 v[148:149], v13 offset:12288
    ds_read_b64_tr_b16 v[150:151], v13 offset:14336
    v_mfma_f32_32x32x16_bf16 v[64:79], v[152:155], a[136:139], v[64:79]
    ds_read_b64_tr_b16 v[152:153], v14 offset:12288
    ds_read_b64_tr_b16 v[154:155], v14 offset:14336
    s_add_u32 m0, s52, 79872
    v_mfma_f32_32x32x16_bf16 v[80:95], v[156:159], a[136:139], v[80:95]
    buffer_load_dwordx4 v7, s[40:43], s55 offen lds
    ds_read_b64_tr_b16 v[156:157], v15 offset:12288
    ds_read_b64_tr_b16 v[158:159], v15 offset:14336
    s_waitcnt lgkmcnt(8)
    v_mfma_f32_32x32x16_bf16 v[96:111], v[160:163], a[40:43], v[96:111]
    ds_read_b64_tr_b16 v[160:161], v9 offset:33792
    ds_read_b64_tr_b16 v[162:163], v9 offset:35328
    v_mfma_f32_32x32x16_bf16 v[112:127], v[164:167], a[40:43], v[112:127]
    buffer_load_dwordx4 a[172:175], v2, s[36:39], s49 offen offset:3072 sc1
    ds_read_b64_tr_b16 v[164:165], v9 offset:33856
    ds_read_b64_tr_b16 v[166:167], v9 offset:35392
    v_mfma_f32_32x32x16_bf16 v[128:143], v[168:171], a[40:43], v[128:143]
    ds_read_b64_tr_b16 v[168:169], v9 offset:33920
    ds_read_b64_tr_b16 v[170:171], v9 offset:35456
    s_waitcnt vmcnt(22) lgkmcnt(6)
    v_mfma_f32_32x32x16_bf16 v[32:47], v[144:147], a[140:143], v[32:47]
    ds_read_b64_tr_b16 v[144:145], v12 offset:16384
    ds_read_b64_tr_b16 v[146:147], v12 offset:18432
    s_add_u32 s49, s48, 3
    s_and_b32 s49, s49, 7
    s_add_u32 s49, s49, 8
    s_lshl_b32 s49, s49, 12
    v_mfma_f32_32x32x16_bf16 v[48:63], v[148:151], a[140:143], v[48:63]
    buffer_load_dwordx4 a[176:179], v2, s[36:39], s49 offen offset:0 sc1
    ds_read_b64_tr_b16 v[148:149], v13 offset:16384
    ds_read_b64_tr_b16 v[150:151], v13 offset:18432
    v_mfma_f32_32x32x16_bf16 v[64:79], v[152:155], a[140:143], v[64:79]
    ds_read_b64_tr_b16 v[152:153], v14 offset:16384
    ds_read_b64_tr_b16 v[154:155], v14 offset:18432
    v_mfma_f32_32x32x16_bf16 v[80:95], v[156:159], a[140:143], v[80:95]
    buffer_load_dwordx4 a[180:183], v2, s[36:39], s49 offen offset:1024 sc1
    ds_read_b64_tr_b16 v[156:157], v15 offset:16384
    ds_read_b64_tr_b16 v[158:159], v15 offset:18432
    s_waitcnt lgkmcnt(8)
    v_mfma_f32_32x32x16_bf16 v[96:111], v[160:163], a[44:47], v[96:111]
    ds_read_b64_tr_b16 v[160:161], v9 offset:36864
    ds_read_b64_tr_b16 v[162:163], v9 offset:38400
    v_mfma_f32_32x32x16_bf16 v[112:127], v[164:167], a[44:47], v[112:127]
    ds_read_b64_tr_b16 v[164:165], v9 offset:36928
    ds_read_b64_tr_b16 v[166:167], v9 offset:38464
    v_mfma_f32_32x32x16_bf16 v[128:143], v[168:171], a[44:47], v[128:143]
    ds_read_b64_tr_b16 v[168:169], v9 offset:36992
    ds_read_b64_tr_b16 v[170:171], v9 offset:38528
    s_waitcnt vmcnt(18)
    s_waitcnt vmcnt(25)
    s_barrier
    s_waitcnt vmcnt(23) lgkmcnt(6)
    v_mfma_f32_32x32x16_bf16 v[32:47], v[144:147], a[144:147], v[32:47]
    ds_read_b64_tr_b16 v[144:145], v12 offset:20480
    ds_read_b64_tr_b16 v[146:147], v12 offset:22528
    s_add_u32 m0, s53, 0
    s_add_u32 s50, s48, 4
    s_and_b32 s50, s50, 7
    s_add_u32 s50, s50, 8
    s_mul_i32 s50, s50, 458752
    s_add_u32 s50, s50, s51
    v_mfma_f32_32x32x16_bf16 v[48:63], v[148:151], a[144:147], v[48:63]
    buffer_load_dwordx4 v4, s[40:43], s50 offen lds
    ds_read_b64_tr_b16 v[148:149], v13 offset:20480
    ds_read_b64_tr_b16 v[150:151], v13 offset:22528
    v_mfma_f32_32x32x16_bf16 v[64:79], v[152:155], a[144:147], v[64:79]
    ds_read_b64_tr_b16 v[152:153], v14 offset:20480
    ds_read_b64_tr_b16 v[154:155], v14 offset:22528
    s_add_u32 m0, s53, 1024
    s_add_u32 s50, s50, 28672
    v_mfma_f32_32x32x16_bf16 v[80:95], v[156:159], a[144:147], v[80:95]
    buffer_load_dwordx4 v4, s[40:43], s50 offen lds
    ds_read_b64_tr_b16 v[156:157], v15 offset:20480
    ds_read_b64_tr_b16 v[158:159], v15 offset:22528
    s_waitcnt lgkmcnt(8)
    v_mfma_f32_32x32x16_bf16 v[96:111], v[160:163], a[48:51], v[96:111]
    ds_read_b64_tr_b16 v[160:161], v9 offset:39936
    ds_read_b64_tr_b16 v[162:163], v9 offset:41472
    s_add_u32 m0, s53, 2048
    s_add_u32 s50, s50, 28672
    v_mfma_f32_32x32x16_bf16 v[112:127], v[164:167], a[48:51], v[112:127]
    buffer_load_dwordx4 v4, s[40:43], s50 offen lds
    ds_read_b64_tr_b16 v[164:165], v9 offset:40000
    ds_read_b64_tr_b16 v[166:167], v9 offset:41536
    v_mfma_f32_32x32x16_bf16 v[128:143], v[168:171], a[48:51], v[128:143]
    ds_read_b64_tr_b16 v[168:169], v9 offset:40064
    ds_read_b64_tr_b16 v[170:171], v9 offset:41600
    s_waitcnt vmcnt(25) lgkmcnt(6)
    v_mfma_f32_32x32x16_bf16 v[32:47], v[144:147], a[148:151], v[32:47]
    ds_read_b64_tr_b16 v[144:145], v12 offset:24576
    ds_read_b64_tr_b16 v[146:147], v12 offset:26624
    s_add_u32 m0, s53, 3072
    s_add_u32 s50, s50, 28672
    v_mfma_f32_32x32x16_bf16 v[48:63], v[148:151], a[148:151], v[48:63]
    buffer_load_dwordx4 v4, s[40:43], s50 offen lds
    ds_read_b64_tr_b16 v[148:149], v13 offset:24576
    ds_read_b64_tr_b16 v[150:151], v13 offset:26624
    v_mfma_f32_32x32x16_bf16 v[64:79], v[152:155], a[148:151], v[64:79]
    ds_read_b64_tr_b16 v[152:153], v14 offset:24576
    ds_read_b64_tr_b16 v[154:155], v14 offset:26624
    v_mfma_f32_32x32x16_bf16 v[80:95], v[156:159], a[148:151], v[80:95]
    buffer_load_dwordx4 a[184:187], v2, s[36:39], s49 offen offset:2048 sc1
    ds_read_b64_tr_b16 v[156:157], v15 offset:24576
    ds_read_b64_tr_b16 v[158:159], v15 offset:26624
    s_waitcnt lgkmcnt(8)
    v_mfma_f32_32x32x16_bf16 v[96:111], v[160:163], a[52:55], v[96:111]
    ds_read_b64_tr_b16 v[160:161], v9 offset:43008
    ds_read_b64_tr_b16 v[162:163], v9 offset:44544
    s_add_u32 m0, s52, 90112
    s_add_u32 s55, s48, 7
    s_and_b32 s55, s55, 7
    s_mul_i32 s55, s55, 458752
    s_add_u32 s55, s55, s51
    v_mfma_f32_32x32x16_bf16 v[112:127], v[164:167], a[52:55], v[112:127]
    buffer_load_dwordx4 v5, s[40:43], s55 offen lds
    ds_read_b64_tr_b16 v[164:165], v9 offset:43072
    ds_read_b64_tr_b16 v[166:167], v9 offset:44608
    v_mfma_f32_32x32x16_bf16 v[128:143], v[168:171], a[52:55], v[128:143]
    ds_read_b64_tr_b16 v[168:169], v9 offset:43136
    ds_read_b64_tr_b16 v[170:171], v9 offset:44672
    s_waitcnt vmcnt(23) lgkmcnt(6)
    v_mfma_f32_32x32x16_bf16 v[32:47], v[144:147], a[152:155], v[32:47]
    ds_read_b64_tr_b16 v[144:145], v12 offset:28672
    ds_read_b64_tr_b16 v[146:147], v12 offset:30720
    s_add_u32 m0, s52, 91136
    v_mfma_f32_32x32x16_bf16 v[48:63], v[148:151], a[152:155], v[48:63]
    buffer_load_dwordx4 v6, s[40:43], s55 offen lds
    ds_read_b64_tr_b16 v[148:149], v13 offset:28672
    ds_read_b64_tr_b16 v[150:151], v13 offset:30720
    v_mfma_f32_32x32x16_bf16 v[64:79], v[152:155], a[152:155], v[64:79]
    ds_read_b64_tr_b16 v[152:153], v14 offset:28672
    ds_read_b64_tr_b16 v[154:155], v14 offset:30720
    s_add_u32 m0, s52, 92160
    v_mfma_f32_32x32x16_bf16 v[80:95], v[156:159], a[152:155], v[80:95]
    buffer_load_dwordx4 v7, s[40:43], s55 offen lds
    ds_read_b64_tr_b16 v[156:157], v15 offset:28672
    ds_read_b64_tr_b16 v[158:159], v15 offset:30720
    s_waitcnt lgkmcnt(8)
    v_mfma_f32_32x32x16_bf16 v[96:111], v[160:163], a[56:59], v[96:111]
    ds_read_b64_tr_b16 v[160:161], v9 offset:46080
    ds_read_b64_tr_b16 v[162:163], v9 offset:47616
    v_mfma_f32_32x32x16_bf16 v[112:127], v[164:167], a[56:59], v[112:127]
    buffer_load_dwordx4 a[188:191], v2, s[36:39], s49 offen offset:3072 sc1
    ds_read_b64_tr_b16 v[164:165], v9 offset:46144
    ds_read_b64_tr_b16 v[166:167], v9 offset:47680
    v_mfma_f32_32x32x16_bf16 v[128:143], v[168:171], a[56:59], v[128:143]
    ds_read_b64_tr_b16 v[168:169], v9 offset:46208
    ds_read_b64_tr_b16 v[170:171], v9 offset:47744
    s_waitcnt vmcnt(22) lgkmcnt(6)
    v_mfma_f32_32x32x16_bf16 v[32:47], v[144:147], a[156:159], v[32:47]
    ds_read_b64_tr_b16 v[144:145], v12 offset:32768
    ds_read_b64_tr_b16 v[146:147], v12 offset:34816
    s_add_u32 s49, s48, 4
    s_and_b32 s49, s49, 7
    s_add_u32 s49, s49, 8
    s_lshl_b32 s49, s49, 12
    v_mfma_f32_32x32x16_bf16 v[48:63], v[148:151], a[156:159], v[48:63]
    buffer_load_dwordx4 a[192:195], v2, s[36:39], s49 offen offset:0 sc1
    ds_read_b64_tr_b16 v[148:149], v13 offset:32768
    ds_read_b64_tr_b16 v[150:151], v13 offset:34816
    v_mfma_f32_32x32x16_bf16 v[64:79], v[152:155], a[156:159], v[64:79]
    ds_read_b64_tr_b16 v[152:153], v14 offset:32768
    ds_read_b64_tr_b16 v[154:155], v14 offset:34816
    v_mfma_f32_32x32x16_bf16 v[80:95], v[156:159], a[156:159], v[80:95]
    buffer_load_dwordx4 a[196:199], v2, s[36:39], s49 offen offset:1024 sc1
    ds_read_b64_tr_b16 v[156:157], v15 offset:32768
    ds_read_b64_tr_b16 v[158:159], v15 offset:34816
    s_waitcnt lgkmcnt(8)
    v_mfma_f32_32x32x16_bf16 v[96:111], v[160:163], a[60:63], v[96:111]
    ds_read_b64_tr_b16 v[160:161], v9 offset:49152
    ds_read_b64_tr_b16 v[162:163], v9 offset:50688
    v_mfma_f32_32x32x16_bf16 v[112:127], v[164:167], a[60:63], v[112:127]
    ds_read_b64_tr_b16 v[164:165], v9 offset:49216
    ds_read_b64_tr_b16 v[166:167], v9 offset:50752
    v_mfma_f32_32x32x16_bf16 v[128:143], v[168:171], a[60:63], v[128:143]
    ds_read_b64_tr_b16 v[168:169], v9 offset:49280
    ds_read_b64_tr_b16 v[170:171], v9 offset:50816
    s_waitcnt vmcnt(18)
    s_waitcnt vmcnt(25)
    s_barrier
    v_and_b32 v11, 15, v1
    v_lshlrev_b32 v11, 7, v11
    s_add_u32 s28, s24, 64
    s_lshl_b32 s28, s28, 11
    v_add_u32 v11, s28, v11
    v_lshrrev_b32 v20, 4, v1
    v_lshlrev_b32 v20, 2, v20
    v_add_u32 v11, v11, v20
    v_mov_b32 v20, 0x7ffffff0
    v_cmp_gt_u32 vcc, 64, v0
    s_nop 1
    v_cndmask_b32 v11, v20, v11, vcc
    s_mov_b32 s31, 26214400
    buffer_load_dword v16, v11, s[32:35], s31 offen sc1
    s_waitcnt vmcnt(24) lgkmcnt(6)
    v_mfma_f32_32x32x16_bf16 v[32:47], v[144:147], a[160:163], v[32:47]
    ds_read_b64_tr_b16 v[144:145], v12 offset:36864
    ds_read_b64_tr_b16 v[146:147], v12 offset:38912
    s_add_u32 m0, s53, 16384
    s_add_u32 s50, s48, 5
    s_and_b32 s50, s50, 7
    s_add_u32 s50, s50, 8
    s_mul_i32 s50, s50, 458752
    s_add_u32 s50, s50, s51
    v_mfma_f32_32x32x16_bf16 v[48:63], v[148:151], a[160:163], v[48:63]
    buffer_load_dwordx4 v4, s[40:43], s50 offen lds
    ds_read_b64_tr_b16 v[148:149], v13 offset:36864
    ds_read_b64_tr_b16 v[150:151], v13 offset:38912
    v_mfma_f32_32x32x16_bf16 v[64:79], v[152:155], a[160:163], v[64:79]
    ds_read_b64_tr_b16 v[152:153], v14 offset:36864
    ds_read_b64_tr_b16 v[154:155], v14 offset:38912
    s_add_u32 m0, s53, 17408
    s_add_u32 s50, s50, 28672
    v_mfma_f32_32x32x16_bf16 v[80:95], v[156:159], a[160:163], v[80:95]
    buffer_load_dwordx4 v4, s[40:43], s50 offen lds
    ds_read_b64_tr_b16 v[156:157], v15 offset:36864
    ds_read_b64_tr_b16 v[158:159], v15 offset:38912
    s_waitcnt lgkmcnt(8)
    v_mfma_f32_32x32x16_bf16 v[96:111], v[160:163], a[64:67], v[96:111]
    ds_read_b64_tr_b16 v[160:161], v9 offset:52224
    ds_read_b64_tr_b16 v[162:163], v9 offset:53760
    s_add_u32 m0, s53, 18432
    s_add_u32 s50, s50, 28672
    v_mfma_f32_32x32x16_bf16 v[112:127], v[164:167], a[64:67], v[112:127]
    buffer_load_dwordx4 v4, s[40:43], s50 offen lds
    ds_read_b64_tr_b16 v[164:165], v9 offset:52288
    ds_read_b64_tr_b16 v[166:167], v9 offset:53824
    v_mfma_f32_32x32x16_bf16 v[128:143], v[168:171], a[64:67], v[128:143]
    ds_read_b64_tr_b16 v[168:169], v9 offset:52352
    ds_read_b64_tr_b16 v[170:171], v9 offset:53888
    s_waitcnt vmcnt(26) lgkmcnt(6)
    v_mfma_f32_32x32x16_bf16 v[32:47], v[144:147], a[164:167], v[32:47]
    ds_read_b64_tr_b16 v[144:145], v12 offset:40960
    ds_read_b64_tr_b16 v[146:147], v12 offset:43008
    s_add_u32 m0, s53, 19456
    s_add_u32 s50, s50, 28672
    v_mfma_f32_32x32x16_bf16 v[48:63], v[148:151], a[164:167], v[48:63]
    buffer_load_dwordx4 v4, s[40:43], s50 offen lds
    ds_read_b64_tr_b16 v[148:149], v13 offset:40960
    ds_read_b64_tr_b16 v[150:151], v13 offset:43008
    v_mfma_f32_32x32x16_bf16 v[64:79], v[152:155], a[164:167], v[64:79]
    ds_read_b64_tr_b16 v[152:153], v14 offset:40960
    ds_read_b64_tr_b16 v[154:155], v14 offset:43008
    v_mfma_f32_32x32x16_bf16 v[80:95], v[156:159], a[164:167], v[80:95]
    buffer_load_dwordx4 a[200:203], v2, s[36:39], s49 offen offset:2048 sc1
    ds_read_b64_tr_b16 v[156:157], v15 offset:40960
    ds_read_b64_tr_b16 v[158:159], v15 offset:43008
    s_waitcnt lgkmcnt(8)
    v_mfma_f32_32x32x16_bf16 v[96:111], v[160:163], a[68:71], v[96:111]
    ds_read_b64_tr_b16 v[160:161], v9 offset:55296
    ds_read_b64_tr_b16 v[162:163], v9 offset:56832
    s_add_u32 m0, s52, 102400
    s_add_u32 s55, s48, 0
    s_and_b32 s55, s55, 7
    s_add_u32 s55, s55, 8
    s_mul_i32 s55, s55, 458752
    s_add_u32 s55, s55, s51
    v_mfma_f32_32x32x16_bf16 v[112:127], v[164:167], a[68:71], v[112:127]
    buffer_load_dwordx4 v5, s[40:43], s55 offen lds
    ds_read_b64_tr_b16 v[164:165], v9 offset:55360
    ds_read_b64_tr_b16 v[166:167], v9 offset:56896
    v_mfma_f32_32x32x16_bf16 v[128:143], v[168:171], a[68:71], v[128:143]
    ds_read_b64_tr_b16 v[168:169], v9 offset:55424
    ds_read_b64_tr_b16 v[170:171], v9 offset:56960
    s_waitcnt vmcnt(24) lgkmcnt(6)
    v_mfma_f32_32x32x16_bf16 v[32:47], v[144:147], a[168:171], v[32:47]
    ds_read_b64_tr_b16 v[144:145], v12 offset:45056
    ds_read_b64_tr_b16 v[146:147], v12 offset:47104
    s_add_u32 m0, s52, 103424
    v_mfma_f32_32x32x16_bf16 v[48:63], v[148:151], a[168:171], v[48:63]
    buffer_load_dwordx4 v6, s[40:43], s55 offen lds
    ds_read_b64_tr_b16 v[148:149], v13 offset:45056
    ds_read_b64_tr_b16 v[150:151], v13 offset:47104
    v_mfma_f32_32x32x16_bf16 v[64:79], v[152:155], a[168:171], v[64:79]
    ds_read_b64_tr_b16 v[152:153], v14 offset:45056
    ds_read_b64_tr_b16 v[154:155], v14 offset:47104
    s_add_u32 m0, s52, 104448
    v_mfma_f32_32x32x16_bf16 v[80:95], v[156:159], a[168:171], v[80:95]
    buffer_load_dwordx4 v7, s[40:43], s55 offen lds
    ds_read_b64_tr_b16 v[156:157], v15 offset:45056
    ds_read_b64_tr_b16 v[158:159], v15 offset:47104
    s_waitcnt lgkmcnt(8)
    v_mfma_f32_32x32x16_bf16 v[96:111], v[160:163], a[72:75], v[96:111]
    ds_read_b64_tr_b16 v[160:161], v9 offset:58368
    ds_read_b64_tr_b16 v[162:163], v9 offset:59904
    v_mfma_f32_32x32x16_bf16 v[112:127], v[164:167], a[72:75], v[112:127]
    buffer_load_dwordx4 a[204:207], v2, s[36:39], s49 offen offset:3072 sc1
    ds_read_b64_tr_b16 v[164:165], v9 offset:58432
    ds_read_b64_tr_b16 v[166:167], v9 offset:59968
    v_mfma_f32_32x32x16_bf16 v[128:143], v[168:171], a[72:75], v[128:143]
    ds_read_b64_tr_b16 v[168:169], v9 offset:58496
    ds_read_b64_tr_b16 v[170:171], v9 offset:60032
    s_waitcnt vmcnt(23) lgkmcnt(6)
    v_mfma_f32_32x32x16_bf16 v[32:47], v[144:147], a[172:175], v[32:47]
    ds_read_b64_tr_b16 v[144:145], v12 offset:49152
    ds_read_b64_tr_b16 v[146:147], v12 offset:51200
    s_add_u32 s49, s48, 5
    s_and_b32 s49, s49, 7
    s_add_u32 s49, s49, 8
    s_lshl_b32 s49, s49, 12
    v_mfma_f32_32x32x16_bf16 v[48:63], v[148:151], a[172:175], v[48:63]
    buffer_load_dwordx4 a[208:211], v2, s[36:39], s49 offen offset:0 sc1
    ds_read_b64_tr_b16 v[148:149], v13 offset:49152
    ds_read_b64_tr_b16 v[150:151], v13 offset:51200
    v_mfma_f32_32x32x16_bf16 v[64:79], v[152:155], a[172:175], v[64:79]
    ds_read_b64_tr_b16 v[152:153], v14 offset:49152
    ds_read_b64_tr_b16 v[154:155], v14 offset:51200
    v_mfma_f32_32x32x16_bf16 v[80:95], v[156:159], a[172:175], v[80:95]
    buffer_load_dwordx4 a[212:215], v2, s[36:39], s49 offen offset:1024 sc1
    ds_read_b64_tr_b16 v[156:157], v15 offset:49152
    ds_read_b64_tr_b16 v[158:159], v15 offset:51200
    s_waitcnt lgkmcnt(8)
    v_mfma_f32_32x32x16_bf16 v[96:111], v[160:163], a[76:79], v[96:111]
    ds_read_b64_tr_b16 v[160:161], v9 offset:0
    ds_read_b64_tr_b16 v[162:163], v9 offset:1536
    v_mfma_f32_32x32x16_bf16 v[112:127], v[164:167], a[76:79], v[112:127]
    ds_read_b64_tr_b16 v[164:165], v9 offset:64
    ds_read_b64_tr_b16 v[166:167], v9 offset:1600
    v_mfma_f32_32x32x16_bf16 v[128:143], v[168:171], a[76:79], v[128:143]
    ds_read_b64_tr_b16 v[168:169], v9 offset:128
    ds_read_b64_tr_b16 v[170:171], v9 offset:1664
    s_waitcnt vmcnt(19)
    s_waitcnt vmcnt(26)
    s_barrier
    s_waitcnt vmcnt(24) lgkmcnt(6)
    v_mfma_f32_32x32x16_bf16 v[32:47], v[144:147], a[176:179], v[32:47]
    ds_read_b64_tr_b16 v[144:145], v12 offset:53248
    ds_read_b64_tr_b16 v[146:147], v12 offset:55296
    s_add_u32 m0, s53, 32768
    s_add_u32 s50, s48, 6
    s_and_b32 s50, s50, 7
    s_add_u32 s50, s50, 8
    s_mul_i32 s50, s50, 458752
    s_add_u32 s50, s50, s51
    v_mfma_f32_32x32x16_bf16 v[48:63], v[148:151], a[176:179], v[48:63]
    buffer_load_dwordx4 v4, s[40:43], s50 offen lds
    ds_read_b64_tr_b16 v[148:149], v13 offset:53248
    ds_read_b64_tr_b16 v[150:151], v13 offset:55296
    v_mfma_f32_32x32x16_bf16 v[64:79], v[152:155], a[176:179], v[64:79]
    ds_read_b64_tr_b16 v[152:153], v14 offset:53248
    ds_read_b64_tr_b16 v[154:155], v14 offset:55296
    s_add_u32 m0, s53, 33792
    s_add_u32 s50, s50, 28672
    v_mfma_f32_32x32x16_bf16 v[80:95], v[156:159], a[176:179], v[80:95]
    buffer_load_dwordx4 v4, s[40:43], s50 offen lds
    ds_read_b64_tr_b16 v[156:157], v15 offset:53248
    ds_read_b64_tr_b16 v[158:159], v15 offset:55296
    s_waitcnt lgkmcnt(8)
    v_mfma_f32_32x32x16_bf16 v[96:111], v[160:163], a[80:83], v[96:111]
    ds_read_b64_tr_b16 v[160:161], v9 offset:3072
    ds_read_b64_tr_b16 v[162:163], v9 offset:4608
    s_add_u32 m0, s53, 34816
    s_add_u32 s50, s50, 28672
    v_mfma_f32_32x32x16_bf16 v[112:127], v[164:167], a[80:83], v[112:127]
    buffer_load_dwordx4 v4, s[40:43], s50 offen lds
    ds_read_b64_tr_b16 v[164:165], v9 offset:3136
    ds_read_b64_tr_b16 v[166:167], v9 offset:4672
    v_mfma_f32_32x32x16_bf16 v[128:143], v[168:171], a[80:83], v[128:143]
    ds_read_b64_tr_b16 v[168:169], v9 offset:3200
    ds_read_b64_tr_b16 v[170:171], v9 offset:4736
    s_waitcnt vmcnt(26) lgkmcnt(6)
    v_mfma_f32_32x32x16_bf16 v[32:47], v[144:147], a[180:183], v[32:47]
    ds_read_b64_tr_b16 v[144:145], v12 offset:57344
    ds_read_b64_tr_b16 v[146:147], v12 offset:59392
    s_add_u32 m0, s53, 35840
    s_add_u32 s50, s50, 28672
    v_mfma_f32_32x32x16_bf16 v[48:63], v[148:151], a[180:183], v[48:63]
    buffer_load_dwordx4 v4, s[40:43], s50 offen lds
    ds_read_b64_tr_b16 v[148:149], v13 offset:57344
    ds_read_b64_tr_b16 v[150:151], v13 offset:59392
    v_mfma_f32_32x32x16_bf16 v[64:79], v[152:155], a[180:183], v[64:79]
    ds_read_b64_tr_b16 v[152:153], v14 offset:57344
    ds_read_b64_tr_b16 v[154:155], v14 offset:59392
    v_mfma_f32_32x32x16_bf16 v[80:95], v[156:159], a[180:183], v[80:95]
    buffer_load_dwordx4 a[216:219], v2, s[36:39], s49 offen offset:2048 sc1
    ds_read_b64_tr_b16 v[156:157], v15 offset:57344
    ds_read_b64_tr_b16 v[158:159], v15 offset:59392
    s_waitcnt lgkmcnt(8)
    v_mfma_f32_32x32x16_bf16 v[96:111], v[160:163], a[84:87], v[96:111]
    ds_read_b64_tr_b16 v[160:161], v9 offset:6144
    ds_read_b64_tr_b16 v[162:163], v9 offset:7680
    s_add_u32 m0, s52, 114688
    s_add_u32 s55, s48, 1
    s_and_b32 s55, s55, 7
    s_add_u32 s55, s55, 8
    s_mul_i32 s55, s55, 458752
    s_add_u32 s55, s55, s51
    v_mfma_f32_32x32x16_bf16 v[112:127], v[164:167], a[84:87], v[112:127]
    buffer_load_dwordx4 v5, s[40:43], s55 offen lds
    ds_read_b64_tr_b16 v[164:165], v9 offset:6208
    ds_read_b64_tr_b16 v[166:167], v9 offset:7744
    v_mfma_f32_32x32x16_bf16 v[128:143], v[168:171], a[84:87], v[128:143]
    ds_read_b64_tr_b16 v[168:169], v9 offset:6272
    ds_read_b64_tr_b16 v[170:171], v9 offset:7808
    s_waitcnt vmcnt(24) lgkmcnt(6)
    v_mfma_f32_32x32x16_bf16 v[32:47], v[144:147], a[184:187], v[32:47]
    ds_read_b64_tr_b16 v[144:145], v12 offset:61440
    ds_read_b64_tr_b16 v[146:147], v12 offset:63488
    s_add_u32 m0, s52, 115712
    v_mfma_f32_32x32x16_bf16 v[48:63], v[148:151], a[184:187], v[48:63]
    buffer_load_dwordx4 v6, s[40:43], s55 offen lds
    ds_read_b64_tr_b16 v[148:149], v13 offset:61440
    ds_read_b64_tr_b16 v[150:151], v13 offset:63488
    v_mfma_f32_32x32x16_bf16 v[64:79], v[152:155], a[184:187], v[64:79]
    ds_read_b64_tr_b16 v[152:153], v14 offset:61440
    ds_read_b64_tr_b16 v[154:155], v14 offset:63488
    s_add_u32 m0, s52, 116736
    v_mfma_f32_32x32x16_bf16 v[80:95], v[156:159], a[184:187], v[80:95]
    buffer_load_dwordx4 v7, s[40:43], s55 offen lds
    ds_read_b64_tr_b16 v[156:157], v15 offset:61440
    ds_read_b64_tr_b16 v[158:159], v15 offset:63488
    s_waitcnt lgkmcnt(8)
    v_mfma_f32_32x32x16_bf16 v[96:111], v[160:163], a[88:91], v[96:111]
    ds_read_b64_tr_b16 v[160:161], v9 offset:9216
    ds_read_b64_tr_b16 v[162:163], v9 offset:10752
    v_mfma_f32_32x32x16_bf16 v[112:127], v[164:167], a[88:91], v[112:127]
    buffer_load_dwordx4 a[220:223], v2, s[36:39], s49 offen offset:3072 sc1
    ds_read_b64_tr_b16 v[164:165], v9 offset:9280
    ds_read_b64_tr_b16 v[166:167], v9 offset:10816
    v_mfma_f32_32x32x16_bf16 v[128:143], v[168:171], a[88:91], v[128:143]
    ds_read_b64_tr_b16 v[168:169], v9 offset:9344
    ds_read_b64_tr_b16 v[170:171], v9 offset:10880
    s_waitcnt vmcnt(23) lgkmcnt(6)
    v_mfma_f32_32x32x16_bf16 v[32:47], v[144:147], a[188:191], v[32:47]
    ds_read_b64_tr_b16 v[144:145], v12 offset:0
    ds_read_b64_tr_b16 v[146:147], v12 offset:2048
    s_add_u32 s49, s48, 6
    s_and_b32 s49, s49, 7
    s_add_u32 s49, s49, 8
    s_lshl_b32 s49, s49, 12
    v_mfma_f32_32x32x16_bf16 v[48:63], v[148:151], a[188:191], v[48:63]
    buffer_load_dwordx4 a[224:227], v2, s[36:39], s49 offen offset:0 sc1
    ds_read_b64_tr_b16 v[148:149], v13 offset:0
    ds_read_b64_tr_b16 v[150:151], v13 offset:2048
    v_mfma_f32_32x32x16_bf16 v[64:79], v[152:155], a[188:191], v[64:79]
    ds_read_b64_tr_b16 v[152:153], v14 offset:0
    ds_read_b64_tr_b16 v[154:155], v14 offset:2048
    v_mfma_f32_32x32x16_bf16 v[80:95], v[156:159], a[188:191], v[80:95]
    buffer_load_dwordx4 a[228:231], v2, s[36:39], s49 offen offset:1024 sc1
    ds_read_b64_tr_b16 v[156:157], v15 offset:0
    ds_read_b64_tr_b16 v[158:159], v15 offset:2048
    s_waitcnt lgkmcnt(8)
    v_mfma_f32_32x32x16_bf16 v[96:111], v[160:163], a[92:95], v[96:111]
    ds_read_b64_tr_b16 v[160:161], v9 offset:12288
    ds_read_b64_tr_b16 v[162:163], v9 offset:13824
    v_mfma_f32_32x32x16_bf16 v[112:127], v[164:167], a[92:95], v[112:127]
    ds_read_b64_tr_b16 v[164:165], v9 offset:12352
    ds_read_b64_tr_b16 v[166:167], v9 offset:13888
    v_mfma_f32_32x32x16_bf16 v[128:143], v[168:171], a[92:95], v[128:143]
    ds_read_b64_tr_b16 v[168:169], v9 offset:12416
    ds_read_b64_tr_b16 v[170:171], v9 offset:13952
    s_waitcnt vmcnt(18)
    s_waitcnt vmcnt(26)
    s_waitcnt vmcnt(22)
    s_cmp_lg_u32 s20, 0
    s_cbranch_scc1 L_w_16
    s_mov_b32 s30, 200000
    s_mov_b32 s31, 26214400
    v_cmp_eq_u32 vcc, s27, v16
    s_nop 0
    s_cmp_eq_u64 vcc, -1
    s_cbranch_scc1 L_pdone_18
L_poll_17:
    buffer_load_dword v16, v11, s[32:35], s31 offen sc1
    s_waitcnt vmcnt(0)
    v_cmp_eq_u32 vcc, s27, v16
    s_nop 0
    s_cmp_eq_u64 vcc, -1
    s_cbranch_scc1 L_pdone_18
    s_sleep 1
    s_sub_u32 s30, s30, 1
    s_cmp_lg_u32 s30, 0
    s_cbranch_scc1 L_poll_17
L_pdone_18:
L_w_16:
    s_barrier
    s_mul_i32 s83, s24, 896
    s_add_u32 s83, s83, 25755648
    s_waitcnt vmcnt(24) lgkmcnt(6)
    v_mfma_f32_32x32x16_bf16 v[32:47], v[144:147], a[192:195], v[32:47]
    ds_read_b64_tr_b16 v[144:145], v12 offset:4096
    ds_read_b64_tr_b16 v[146:147], v12 offset:6144
    v_mfma_f32_32x32x16_bf16 v[48:63], v[148:151], a[192:195], v[48:63]
    buffer_load_dword v216, v28, s[32:35], s83 offen sc1
    s_add_u32 s83, s83, 14336
    ds_read_b64_tr_b16 v[148:149], v13 offset:4096
    ds_read_b64_tr_b16 v[150:151], v13 offset:6144
    v_mfma_f32_32x32x16_bf16 v[64:79], v[152:155], a[192:195], v[64:79]
    ds_read_b64_tr_b16 v[152:153], v14 offset:4096
    ds_read_b64_tr_b16 v[154:155], v14 offset:6144
    v_mfma_f32_32x32x16_bf16 v[80:95], v[156:159], a[192:195], v[80:95]
    buffer_load_dword v217, v28, s[32:35], s83 offen sc1
    s_add_u32 s83, s83, 14336
    ds_read_b64_tr_b16 v[156:157], v15 offset:4096
    ds_read_b64_tr_b16 v[158:159], v15 offset:6144
    s_waitcnt lgkmcnt(8)
    v_mfma_f32_32x32x16_bf16 v[96:111], v[160:163], a[96:99], v[96:111]
    ds_read_b64_tr_b16 v[160:161], v9 offset:15360
    ds_read_b64_tr_b16 v[162:163], v9 offset:16896
    v_mfma_f32_32x32x16_bf16 v[112:127], v[164:167], a[96:99], v[112:127]
    buffer_load_dword v218, v28, s[32:35], s83 offen sc1
    s_add_u32 s83, s83, 14336
    ds_read_b64_tr_b16 v[164:165], v9 offset:15424
    ds_read_b64_tr_b16 v[166:167], v9 offset:16960
    v_mfma_f32_32x32x16_bf16 v[128:143], v[168:171], a[96:99], v[128:143]
    ds_read_b64_tr_b16 v[168:169], v9 offset:15488
    ds_read_b64_tr_b16 v[170:171], v9 offset:17024
    s_waitcnt vmcnt(26) lgkmcnt(6)
    v_mfma_f32_32x32x16_bf16 v[32:47], v[144:147], a[196:199], v[32:47]
    ds_read_b64_tr_b16 v[144:145], v12 offset:8192
    ds_read_b64_tr_b16 v[146:147], v12 offset:10240
    v_mfma_f32_32x32x16_bf16 v[48:63], v[148:151], a[196:199], v[48:63]
    buffer_load_dword v219, v28, s[32:35], s83 offen sc1
    s_add_u32 s83, s83, 14336
    ds_read_b64_tr_b16 v[148:149], v13 offset:8192
    ds_read_b64_tr_b16 v[150:151], v13 offset:10240
    v_mfma_f32_32x32x16_bf16 v[64:79], v[152:155], a[196:199], v[64:79]
    ds_read_b64_tr_b16 v[152:153], v14 offset:8192
    ds_read_b64_tr_b16 v[154:155], v14 offset:10240
    v_mfma_f32_32x32x16_bf16 v[80:95], v[156:159], a[196:199], v[80:95]
    buffer_load_dword v220, v28, s[32:35], s83 offen sc1
    s_add_u32 s83, s83, 14336
    ds_read_b64_tr_b16 v[156:157], v15 offset:8192
    ds_read_b64_tr_b16 v[158:159], v15 offset:10240
    s_waitcnt lgkmcnt(8)
    v_mfma_f32_32x32x16_bf16 v[96:111], v[160:163], a[100:103], v[96:111]
    ds_read_b64_tr_b16 v[160:161], v9 offset:18432
    ds_read_b64_tr_b16 v[162:163], v9 offset:19968
    v_mfma_f32_32x32x16_bf16 v[112:127], v[164:167], a[100:103], v[112:127]
    buffer_load_dword v221, v28, s[32:35], s83 offen sc1
    s_add_u32 s83, s83, 14336
    ds_read_b64_tr_b16 v[164:165], v9 offset:18496
    ds_read_b64_tr_b16 v[166:167], v9 offset:20032
    v_mfma_f32_32x32x16_bf16 v[128:143], v[168:171], a[100:103], v[128:143]
    ds_read_b64_tr_b16 v[168:169], v9 offset:18560
    ds_read_b64_tr_b16 v[170:171], v9 offset:20096
    s_waitcnt vmcnt(23) lgkmcnt(6)
    v_mfma_f32_32x32x16_bf16 v[32:47], v[144:147], a[200:203], v[32:47]
    ds_read_b64_tr_b16 v[144:145], v12 offset:12288
    ds_read_b64_tr_b16 v[146:147], v12 offset:14336
    v_mfma_f32_32x32x16_bf16 v[48:63], v[148:151], a[200:203], v[48:63]
    buffer_load_dword v222, v28, s[32:35], s83 offen sc1
    s_add_u32 s83, s83, 14336
    ds_read_b64_tr_b16 v[148:149], v13 offset:12288
    ds_read_b64_tr_b16 v[150:151], v13 offset:14336
    v_mfma_f32_32x32x16_bf16 v[64:79], v[152:155], a[200:203], v[64:79]
    ds_read_b64_tr_b16 v[152:153], v14 offset:12288
    ds_read_b64_tr_b16 v[154:155], v14 offset:14336
    v_mfma_f32_32x32x16_bf16 v[80:95], v[156:159], a[200:203], v[80:95]
    buffer_load_dword v223, v28, s[32:35], s83 offen sc1
    s_add_u32 s83, s83, 14336
    ds_read_b64_tr_b16 v[156:157], v15 offset:12288
    ds_read_b64_tr_b16 v[158:159], v15 offset:14336
    s_waitcnt lgkmcnt(8)
    v_mfma_f32_32x32x16_bf16 v[96:111], v[160:163], a[104:107], v[96:111]
    ds_read_b64_tr_b16 v[160:161], v9 offset:21504
    ds_read_b64_tr_b16 v[162:163], v9 offset:23040
    v_mfma_f32_32x32x16_bf16 v[112:127], v[164:167], a[104:107], v[112:127]
    buffer_load_dword v224, v28, s[32:35], s83 offen sc1
    s_add_u32 s83, s83, 14336
    ds_read_b64_tr_b16 v[164:165], v9 offset:21568
    ds_read_b64_tr_b16 v[166:167], v9 offset:23104
    v_mfma_f32_32x32x16_bf16 v[128:143], v[168:171], a[104:107], v[128:143]
    ds_read_b64_tr_b16 v[168:169], v9 offset:21632
    ds_read_b64_tr_b16 v[170:171], v9 offset:23168
    s_waitcnt vmcnt(22) lgkmcnt(6)
    v_mfma_f32_32x32x16_bf16 v[32:47], v[144:147], a[204:207], v[32:47]
    ds_read_b64_tr_b16 v[144:145], v12 offset:16384
    ds_read_b64_tr_b16 v[146:147], v12 offset:18432
    v_mfma_f32_32x32x16_bf16 v[48:63], v[148:151], a[204:207], v[48:63]
    buffer_load_dword v225, v28, s[32:35], s83 offen sc1
    s_add_u32 s83, s83, 14336
    ds_read_b64_tr_b16 v[148:149], v13 offset:16384
    ds_read_b64_tr_b16 v[150:151], v13 offset:18432
    v_mfma_f32_32x32x16_bf16 v[64:79], v[152:155], a[204:207], v[64:79]
    ds_read_b64_tr_b16 v[152:153], v14 offset:16384
    ds_read_b64_tr_b16 v[154:155], v14 offset:18432
    v_mfma_f32_32x32x16_bf16 v[80:95], v[156:159], a[204:207], v[80:95]
    buffer_load_dword v226, v28, s[32:35], s83 offen sc1
    s_add_u32 s83, s83, 14336
    ds_read_b64_tr_b16 v[156:157], v15 offset:16384
    ds_read_b64_tr_b16 v[158:159], v15 offset:18432
    s_waitcnt lgkmcnt(8)
    v_mfma_f32_32x32x16_bf16 v[96:111], v[160:163], a[108:111], v[96:111]
    ds_read_b64_tr_b16 v[160:161], v9 offset:24576
    ds_read_b64_tr_b16 v[162:163], v9 offset:26112
    v_mfma_f32_32x32x16_bf16 v[112:127], v[164:167], a[108:111], v[112:127]
    buffer_load_dword v227, v28, s[32:35], s83 offen sc1
    s_add_u32 s83, s83, 14336
    ds_read_b64_tr_b16 v[164:165], v9 offset:24640
    ds_read_b64_tr_b16 v[166:167], v9 offset:26176
    v_mfma_f32_32x32x16_bf16 v[128:143], v[168:171], a[108:111], v[128:143]
    ds_read_b64_tr_b16 v[168:169], v9 offset:24704
    ds_read_b64_tr_b16 v[170:171], v9 offset:26240
    s_waitcnt vmcnt(19)
    s_waitcnt vmcnt(26)
    s_barrier
    s_waitcnt vmcnt(24) lgkmcnt(6)
    v_mfma_f32_32x32x16_bf16 v[32:47], v[144:147], a[208:211], v[32:47]
    ds_read_b64_tr_b16 v[144:145], v12 offset:20480
    ds_read_b64_tr_b16 v[146:147], v12 offset:22528
    v_mfma_f32_32x32x16_bf16 v[48:63], v[148:151], a[208:211], v[48:63]
    buffer_load_dword v228, v28, s[32:35], s83 offen sc1
    s_add_u32 s83, s83, 14336
    ds_read_b64_tr_b16 v[148:149], v13 offset:20480
    ds_read_b64_tr_b16 v[150:151], v13 offset:22528
    v_mfma_f32_32x32x16_bf16 v[64:79], v[152:155], a[208:211], v[64:79]
    ds_read_b64_tr_b16 v[152:153], v14 offset:20480
    ds_read_b64_tr_b16 v[154:155], v14 offset:22528
    v_mfma_f32_32x32x16_bf16 v[80:95], v[156:159], a[208:211], v[80:95]
    buffer_load_dword v229, v28, s[32:35], s83 offen sc1
    s_add_u32 s83, s83, 14336
    ds_read_b64_tr_b16 v[156:157], v15 offset:20480
    ds_read_b64_tr_b16 v[158:159], v15 offset:22528
    s_waitcnt lgkmcnt(8)
    v_mfma_f32_32x32x16_bf16 v[96:111], v[160:163], a[112:115], v[96:111]
    ds_read_b64_tr_b16 v[160:161], v9 offset:27648
    ds_read_b64_tr_b16 v[162:163], v9 offset:29184
    v_mfma_f32_32x32x16_bf16 v[112:127], v[164:167], a[112:115], v[112:127]
    buffer_load_dword v230, v28, s[32:35], s83 offen sc1
    s_add_u32 s83, s83, 14336
    ds_read_b64_tr_b16 v[164:165], v9 offset:27712
    ds_read_b64_tr_b16 v[166:167], v9 offset:29248
    v_mfma_f32_32x32x16_bf16 v[128:143], v[168:171], a[112:115], v[128:143]
    ds_read_b64_tr_b16 v[168:169], v9 offset:27776
    ds_read_b64_tr_b16 v[170:171], v9 offset:29312
    s_waitcnt vmcnt(26) lgkmcnt(6)
    v_mfma_f32_32x32x16_bf16 v[32:47], v[144:147], a[212:215], v[32:47]
    ds_read_b64_tr_b16 v[144:145], v12 offset:24576
    ds_read_b64_tr_b16 v[146:147], v12 offset:26624
    v_mfma_f32_32x32x16_bf16 v[48:63], v[148:151], a[212:215], v[48:63]
    buffer_load_dword v231, v28, s[32:35], s83 offen sc1
    ds_read_b64_tr_b16 v[148:149], v13 offset:24576
    ds_read_b64_tr_b16 v[150:151], v13 offset:26624
    v_mfma_f32_32x32x16_bf16 v[64:79], v[152:155], a[212:215], v[64:79]
    ds_read_b64_tr_b16 v[152:153], v14 offset:24576
    ds_read_b64_tr_b16 v[154:155], v14 offset:26624
    s_add_u32 m0, s53, 49152
    s_add_u32 s50, s48, 7
    s_and_b32 s50, s50, 7
    s_add_u32 s50, s50, 8
    s_mul_i32 s50, s50, 458752
    s_add_u32 s50, s50, s51
    v_mfma_f32_32x32x16_bf16 v[80:95], v[156:159], a[212:215], v[80:95]
    buffer_load_dwordx4 v4, s[40:43], s50 offen lds
    ds_read_b64_tr_b16 v[156:157], v15 offset:24576
    ds_read_b64_tr_b16 v[158:159], v15 offset:26624
    s_waitcnt lgkmcnt(8)
    v_mfma_f32_32x32x16_bf16 v[96:111], v[160:163], a[116:119], v[96:111]
    ds_read_b64_tr_b16 v[160:161], v9 offset:30720
    ds_read_b64_tr_b16 v[162:163], v9 offset:32256
    s_add_u32 m0, s53, 50176
    s_add_u32 s50, s50, 28672
    v_mfma_f32_32x32x16_bf16 v[112:127], v[164:167], a[116:119], v[112:127]
    buffer_load_dwordx4 v4, s[40:43], s50 offen lds
    ds_read_b64_tr_b16 v[164:165], v9 offset:30784
    ds_read_b64_tr_b16 v[166:167], v9 offset:32320
    v_mfma_f32_32x32x16_bf16 v[128:143], v[168:171], a[116:119], v[128:143]
    ds_read_b64_tr_b16 v[168:169], v9 offset:30848
    ds_read_b64_tr_b16 v[170:171], v9 offset:32384
    s_waitcnt vmcnt(24) lgkmcnt(6)
    v_mfma_f32_32x32x16_bf16 v[32:47], v[144:147], a[216:219], v[32:47]
    ds_read_b64_tr_b16 v[144:145], v12 offset:28672
    ds_read_b64_tr_b16 v[146:147], v12 offset:30720
    s_add_u32 m0, s53, 51200
    s_add_u32 s50, s50, 28672
    v_mfma_f32_32x32x16_bf16 v[48:63], v[148:151], a[216:219], v[48:63]
    buffer_load_dwordx4 v4, s[40:43], s50 offen lds
    ds_read_b64_tr_b16 v[148:149], v13 offset:28672
    ds_read_b64_tr_b16 v[150:151], v13 offset:30720
    v_mfma_f32_32x32x16_bf16 v[64:79], v[152:155], a[216:219], v[64:79]
    ds_read_b64_tr_b16 v[152:153], v14 offset:28672
    ds_read_b64_tr_b16 v[154:155], v14 offset:30720
    s_add_u32 m0, s53, 52224
    s_add_u32 s50, s50, 28672
    v_mfma_f32_32x32x16_bf16 v[80:95], v[156:159], a[216:219], v[80:95]
    buffer_load_dwordx4 v4, s[40:43], s50 offen lds
    ds_read_b64_tr_b16 v[156:157], v15 offset:28672
    ds_read_b64_tr_b16 v[158:159], v15 offset:30720
    s_waitcnt lgkmcnt(8)
    v_mfma_f32_32x32x16_bf16 v[96:111], v[160:163], a[120:123], v[96:111]
    ds_read_b64_tr_b16 v[160:161], v9 offset:33792
    ds_read_b64_tr_b16 v[162:163], v9 offset:35328
    v_mfma_f32_32x32x16_bf16 v[112:127], v[164:167], a[120:123], v[112:127]
    buffer_load_dwordx4 a[232:235], v2, s[36:39], s49 offen offset:2048 sc1
    ds_read_b64_tr_b16 v[164:165], v9 offset:33856
    ds_read_b64_tr_b16 v[166:167], v9 offset:35392
    v_mfma_f32_32x32x16_bf16 v[128:143], v[168:171], a[120:123], v[128:143]
    ds_read_b64_tr_b16 v[168:169], v9 offset:33920
    ds_read_b64_tr_b16 v[170:171], v9 offset:35456
    s_waitcnt vmcnt(23) lgkmcnt(6)
    v_mfma_f32_32x32x16_bf16 v[32:47], v[144:147], a[220:223], v[32:47]
    ds_read_b64_tr_b16 v[144:145], v12 offset:32768
    ds_read_b64_tr_b16 v[146:147], v12 offset:34816
    s_add_u32 m0, s52, 65536
    s_add_u32 s55, s48, 2
    s_and_b32 s55, s55, 7
    s_add_u32 s55, s55, 8
    s_mul_i32 s55, s55, 458752
    s_add_u32 s55, s55, s51
    v_mfma_f32_32x32x16_bf16 v[48:63], v[148:151], a[220:223], v[48:63]
    buffer_load_dwordx4 v5, s[40:43], s55 offen lds
    ds_read_b64_tr_b16 v[148:149], v13 offset:32768
    ds_read_b64_tr_b16 v[150:151], v13 offset:34816
    v_mfma_f32_32x32x16_bf16 v[64:79], v[152:155], a[220:223], v[64:79]
    ds_read_b64_tr_b16 v[152:153], v14 offset:32768
    ds_read_b64_tr_b16 v[154:155], v14 offset:34816
    s_add_u32 m0, s52, 66560
    v_mfma_f32_32x32x16_bf16 v[80:95], v[156:159], a[220:223], v[80:95]
    buffer_load_dwordx4 v6, s[40:43], s55 offen lds
    ds_read_b64_tr_b16 v[156:157], v15 offset:32768
    ds_read_b64_tr_b16 v[158:159], v15 offset:34816
    s_waitcnt lgkmcnt(8)
    v_mfma_f32_32x32x16_bf16 v[96:111], v[160:163], a[124:127], v[96:111]
    ds_read_b64_tr_b16 v[160:161], v9 offset:36864
    ds_read_b64_tr_b16 v[162:163], v9 offset:38400
    s_add_u32 m0, s52, 67584
    v_mfma_f32_32x32x16_bf16 v[112:127], v[164:167], a[124:127], v[112:127]
    buffer_load_dwordx4 v7, s[40:43], s55 offen lds
    ds_read_b64_tr_b16 v[164:165], v9 offset:36928
    ds_read_b64_tr_b16 v[166:167], v9 offset:38464
    v_mfma_f32_32x32x16_bf16 v[128:143], v[168:171], a[124:127], v[128:143]
    ds_read_b64_tr_b16 v[168:169], v9 offset:36992
    ds_read_b64_tr_b16 v[170:171], v9 offset:38528
    s_waitcnt vmcnt(4)
    s_waitcnt vmcnt(27)
    s_barrier
    s_waitcnt vmcnt(25) lgkmcnt(6)
    v_mfma_f32_32x32x16_bf16 v[32:47], v[144:147], a[224:227], v[32:47]
    ds_read_b64_tr_b16 v[144:145], v12 offset:36864
    ds_read_b64_tr_b16 v[146:147], v12 offset:38912
    s_waitcnt vmcnt(8)
    v_add_f32 v216, v216, v217
    v_add_f32 v216, v216, v218
    v_mfma_f32_32x32x16_bf16 v[48:63], v[148:151], a[224:227], v[48:63]
    buffer_load_dwordx4 a[236:239], v2, s[36:39], s49 offen offset:3072 sc1
    ds_read_b64_tr_b16 v[148:149], v13 offset:36864
    ds_read_b64_tr_b16 v[150:151], v13 offset:38912
    v_add_f32 v216, v216, v219
    v_add_f32 v216, v216, v220
    v_add_f32 v216, v216, v221
    v_mfma_f32_32x32x16_bf16 v[64:79], v[152:155], a[224:227], v[64:79]
    ds_read_b64_tr_b16 v[152:153], v14 offset:36864
    ds_read_b64_tr_b16 v[154:155], v14 offset:38912
    s_add_u32 s49, s48, 7
    s_and_b32 s49, s49, 7
    s_add_u32 s49, s49, 8
    s_lshl_b32 s49, s49, 12
    v_add_f32 v216, v216, v222
    v_add_f32 v216, v216, v223
    v_add_f32 v216, v216, v224
    v_mfma_f32_32x32x16_bf16 v[80:95], v[156:159], a[224:227], v[80:95]
    buffer_load_dwordx4 a[240:243], v2, s[36:39], s49 offen offset:0 sc1
    ds_read_b64_tr_b16 v[156:157], v15 offset:36864
    ds_read_b64_tr_b16 v[158:159], v15 offset:38912
    v_add_f32 v216, v216, v225
    v_add_f32 v216, v216, v226
    v_add_f32 v216, v216, v227
    s_waitcnt lgkmcnt(8)
    v_mfma_f32_32x32x16_bf16 v[96:111], v[160:163], a[128:131], v[96:111]
    ds_read_b64_tr_b16 v[160:161], v9 offset:39936
    ds_read_b64_tr_b16 v[162:163], v9 offset:41472
    v_add_f32 v216, v216, v228
    v_add_f32 v216, v216, v229
    v_add_f32 v216, v216, v230
    v_mfma_f32_32x32x16_bf16 v[112:127], v[164:167], a[128:131], v[112:127]
    s_mul_i32 s30, s91, 7168
    s_add_u32 s30, s30, 0
    s_mov_b32 s92, s12
    s_and_b32 s93, s13, 0xffff
    s_add_u32 s94, s30, 7168
    s_mov_b32 s95, 0x20000
    buffer_load_dword v236, v235, s[92:95], s30 offen
    ds_read_b64_tr_b16 v[164:165], v9 offset:40000
    ds_read_b64_tr_b16 v[166:167], v9 offset:41536
    v_add_f32 v216, v216, v231
    v_lshlrev_b32 v24, 2, v0
    v_add_u32 v24, 159744, v24
    v_mfma_f32_32x32x16_bf16 v[128:143], v[168:171], a[128:131], v[128:143]
    ds_read_b64_tr_b16 v[168:169], v9 offset:40064
    ds_read_b64_tr_b16 v[170:171], v9 offset:41600
    ds_write_b32 v24, v216
    s_waitcnt vmcnt(27) lgkmcnt(7)
    v_mfma_f32_32x32x16_bf16 v[32:47], v[144:147], a[228:231], v[32:47]
    ds_read_b64_tr_b16 v[144:145], v12 offset:40960
    ds_read_b64_tr_b16 v[146:147], v12 offset:43008
    v_mfma_f32_32x32x16_bf16 v[48:63], v[148:151], a[228:231], v[48:63]
    buffer_load_dwordx4 a[244:247], v2, s[36:39], s49 offen offset:1024 sc1
    ds_read_b64_tr_b16 v[148:149], v13 offset:40960
    ds_read_b64_tr_b16 v[150:151], v13 offset:43008
    v_mfma_f32_32x32x16_bf16 v[64:79], v[152:155], a[228:231], v[64:79]
    ds_read_b64_tr_b16 v[152:153], v14 offset:40960
    ds_read_b64_tr_b16 v[154:155], v14 offset:43008
    v_mfma_f32_32x32x16_bf16 v[80:95], v[156:159], a[228:231], v[80:95]
    buffer_load_dwordx4 a[248:251], v2, s[36:39], s49 offen offset:2048 sc1
    ds_read_b64_tr_b16 v[156:157], v15 offset:40960
    ds_read_b64_tr_b16 v[158:159], v15 offset:43008
    s_waitcnt lgkmcnt(9)
    v_mfma_f32_32x32x16_bf16 v[96:111], v[160:163], a[132:135], v[96:111]
    ds_read_b64_tr_b16 v[160:161], v9 offset:43008
    ds_read_b64_tr_b16 v[162:163], v9 offset:44544
    s_add_u32 m0, s52, 77824
    s_add_u32 s55, s48, 3
    s_and_b32 s55, s55, 7
    s_add_u32 s55, s55, 8
    s_mul_i32 s55, s55, 458752
    s_add_u32 s55, s55, s51
    v_mfma_f32_32x32x16_bf16 v[112:127], v[164:167], a[132:135], v[112:127]
    buffer_load_dwordx4 v5, s[40:43], s55 offen lds
    ds_read_b64_tr_b16 v[164:165], v9 offset:43072
    ds_read_b64_tr_b16 v[166:167], v9 offset:44608
    v_mfma_f32_32x32x16_bf16 v[128:143], v[168:171], a[132:135], v[128:143]
    ds_read_b64_tr_b16 v[168:169], v9 offset:43136
    ds_read_b64_tr_b16 v[170:171], v9 offset:44672
    s_waitcnt vmcnt(9) lgkmcnt(6)
    v_mfma_f32_32x32x16_bf16 v[32:47], v[144:147], a[232:235], v[32:47]
    ds_read_b64_tr_b16 v[144:145], v12 offset:45056
    ds_read_b64_tr_b16 v[146:147], v12 offset:47104
    s_add_u32 m0, s52, 78848
    v_mfma_f32_32x32x16_bf16 v[48:63], v[148:151], a[232:235], v[48:63]
    buffer_load_dwordx4 v6, s[40:43], s55 offen lds
    ds_read_b64_tr_b16 v[148:149], v13 offset:45056
    ds_read_b64_tr_b16 v[150:151], v13 offset:47104
    v_mfma_f32_32x32x16_bf16 v[64:79], v[152:155], a[232:235], v[64:79]
    ds_read_b64_tr_b16 v[152:153], v14 offset:45056
    ds_read_b64_tr_b16 v[154:155], v14 offset:47104
    s_add_u32 m0, s52, 79872
    v_mfma_f32_32x32x16_bf16 v[80:95], v[156:159], a[232:235], v[80:95]
    buffer_load_dwordx4 v7, s[40:43], s55 offen lds
    ds_read_b64_tr_b16 v[156:157], v15 offset:45056
    ds_read_b64_tr_b16 v[158:159], v15 offset:47104
    s_waitcnt lgkmcnt(8)
    v_mfma_f32_32x32x16_bf16 v[96:111], v[160:163], a[136:139], v[96:111]
    ds_read_b64_tr_b16 v[160:161], v9 offset:46080
    ds_read_b64_tr_b16 v[162:163], v9 offset:47616
    v_mfma_f32_32x32x16_bf16 v[112:127], v[164:167], a[136:139], v[112:127]
    buffer_load_dwordx4 a[252:255], v2, s[36:39], s49 offen offset:3072 sc1
    ds_read_b64_tr_b16 v[164:165], v9 offset:46144
    ds_read_b64_tr_b16 v[166:167], v9 offset:47680
    v_mfma_f32_32x32x16_bf16 v[128:143], v[168:171], a[136:139], v[128:143]
    ds_read_b64_tr_b16 v[168:169], v9 offset:46208
    ds_read_b64_tr_b16 v[170:171], v9 offset:47744
    s_waitcnt vmcnt(8) lgkmcnt(6)
    v_mfma_f32_32x32x16_bf16 v[32:47], v[144:147], a[236:239], v[32:47]
    ds_read_b64_tr_b16 v[144:145], v12 offset:49152
    ds_read_b64_tr_b16 v[146:147], v12 offset:51200
    s_add_u32 m0, s52, 90112
    s_add_u32 s55, s48, 4
    s_and_b32 s55, s55, 7
    s_add_u32 s55, s55, 8
    s_mul_i32 s55, s55, 458752
    s_add_u32 s55, s55, s51
    v_mfma_f32_32x32x16_bf16 v[48:63], v[148:151], a[236:239], v[48:63]
    buffer_load_dwordx4 v5, s[40:43], s55 offen lds
    ds_read_b64_tr_b16 v[148:149], v13 offset:49152
    ds_read_b64_tr_b16 v[150:151], v13 offset:51200
    v_mfma_f32_32x32x16_bf16 v[64:79], v[152:155], a[236:239], v[64:79]
    ds_read_b64_tr_b16 v[152:153], v14 offset:49152
    ds_read_b64_tr_b16 v[154:155], v14 offset:51200
    s_add_u32 m0, s52, 91136
    v_mfma_f32_32x32x16_bf16 v[80:95], v[156:159], a[236:239], v[80:95]
    buffer_load_dwordx4 v6, s[40:43], s55 offen lds
    ds_read_b64_tr_b16 v[156:157], v15 offset:49152
    ds_read_b64_tr_b16 v[158:159], v15 offset:51200
    s_waitcnt lgkmcnt(8)
    v_mfma_f32_32x32x16_bf16 v[96:111], v[160:163], a[140:143], v[96:111]
    ds_read_b64_tr_b16 v[160:161], v9 offset:49152
    ds_read_b64_tr_b16 v[162:163], v9 offset:50688
    s_add_u32 m0, s52, 92160
    v_mfma_f32_32x32x16_bf16 v[112:127], v[164:167], a[140:143], v[112:127]
    buffer_load_dwordx4 v7, s[40:43], s55 offen lds
    ds_read_b64_tr_b16 v[164:165], v9 offset:49216
    ds_read_b64_tr_b16 v[166:167], v9 offset:50752
    v_mfma_f32_32x32x16_bf16 v[128:143], v[168:171], a[140:143], v[128:143]
    ds_read_b64_tr_b16 v[168:169], v9 offset:49280
    ds_read_b64_tr_b16 v[170:171], v9 offset:50816
    s_waitcnt vmcnt(12)
    s_waitcnt lgkmcnt(15)
    s_barrier
    s_waitcnt vmcnt(10) lgkmcnt(6)
    v_mfma_f32_32x32x16_bf16 v[32:47], v[144:147], a[240:243], v[32:47]
    ds_read_b64_tr_b16 v[144:145], v12 offset:53248
    ds_read_b64_tr_b16 v[146:147], v12 offset:55296
    s_add_u32 m0, s52, 102400
    s_add_u32 s55, s48, 5
    s_and_b32 s55, s55, 7
    s_add_u32 s55, s55, 8
    s_mul_i32 s55, s55, 458752
    s_add_u32 s55, s55, s51
    v_mfma_f32_32x32x16_bf16 v[48:63], v[148:151], a[240:243], v[48:63]
    buffer_load_dwordx4 v5, s[40:43], s55 offen lds
    ds_read_b64_tr_b16 v[148:149], v13 offset:53248
    ds_read_b64_tr_b16 v[150:151], v13 offset:55296
    v_mfma_f32_32x32x16_bf16 v[64:79], v[152:155], a[240:243], v[64:79]
    ds_read_b64_tr_b16 v[152:153], v14 offset:53248
    ds_read_b64_tr_b16 v[154:155], v14 offset:55296
    s_add_u32 m0, s52, 103424
    v_mfma_f32_32x32x16_bf16 v[80:95], v[156:159], a[240:243], v[80:95]
    buffer_load_dwordx4 v6, s[40:43], s55 offen lds
    ds_read_b64_tr_b16 v[156:157], v15 offset:53248
    ds_read_b64_tr_b16 v[158:159], v15 offset:55296
    s_waitcnt lgkmcnt(8)
    v_mfma_f32_32x32x16_bf16 v[96:111], v[160:163], a[144:147], v[96:111]
    ds_read_b64_tr_b16 v[160:161], v9 offset:52224
    ds_read_b64_tr_b16 v[162:163], v9 offset:53760
    s_add_u32 m0, s52, 104448
    v_mfma_f32_32x32x16_bf16 v[112:127], v[164:167], a[144:147], v[112:127]
    buffer_load_dwordx4 v7, s[40:43], s55 offen lds
    ds_read_b64_tr_b16 v[164:165], v9 offset:52288
    ds_read_b64_tr_b16 v[166:167], v9 offset:53824
    v_mfma_f32_32x32x16_bf16 v[128:143], v[168:171], a[144:147], v[128:143]
    ds_read_b64_tr_b16 v[168:169], v9 offset:52352
    ds_read_b64_tr_b16 v[170:171], v9 offset:53888
    s_waitcnt vmcnt(11) lgkmcnt(6)
    v_mfma_f32_32x32x16_bf16 v[32:47], v[144:147], a[244:247], v[32:47]
    ds_read_b64_tr_b16 v[144:145], v12 offset:57344
    ds_read_b64_tr_b16 v[146:147], v12 offset:59392
    v_mfma_f32_32x32x16_bf16 v[48:63], v[148:151], a[244:247], v[48:63]
    ds_read_b64_tr_b16 v[148:149], v13 offset:57344
    ds_read_b64_tr_b16 v[150:151], v13 offset:59392
    v_mfma_f32_32x32x16_bf16 v[64:79], v[152:155], a[244:247], v[64:79]
    ds_read_b64_tr_b16 v[152:153], v14 offset:57344
    ds_read_b64_tr_b16 v[154:155], v14 offset:59392
    v_mfma_f32_32x32x16_bf16 v[80:95], v[156:159], a[244:247], v[80:95]
    ds_read_b64_tr_b16 v[156:157], v15 offset:57344
    ds_read_b64_tr_b16 v[158:159], v15 offset:59392
    s_waitcnt lgkmcnt(8)
    v_mfma_f32_32x32x16_bf16 v[96:111], v[160:163], a[148:151], v[96:111]
    ds_read_b64_tr_b16 v[160:161], v9 offset:55296
    ds_read_b64_tr_b16 v[162:163], v9 offset:56832
    v_mfma_f32_32x32x16_bf16 v[112:127], v[164:167], a[148:151], v[112:127]
    ds_read_b64_tr_b16 v[164:165], v9 offset:55360
    ds_read_b64_tr_b16 v[166:167], v9 offset:56896
    v_mfma_f32_32x32x16_bf16 v[128:143], v[168:171], a[148:151], v[128:143]
    ds_read_b64_tr_b16 v[168:169], v9 offset:55424
    ds_read_b64_tr_b16 v[170:171], v9 offset:56960
    s_waitcnt vmcnt(10) lgkmcnt(6)
    v_mfma_f32_32x32x16_bf16 v[32:47], v[144:147], a[248:251], v[32:47]
    ds_read_b64_tr_b16 v[144:145], v12 offset:61440
    ds_read_b64_tr_b16 v[146:147], v12 offset:63488
    v_mfma_f32_32x32x16_bf16 v[48:63], v[148:151], a[248:251], v[48:63]
    ds_read_b64_tr_b16 v[148:149], v13 offset:61440
    ds_read_b64_tr_b16 v[150:151], v13 offset:63488
    v_mfma_f32_32x32x16_bf16 v[64:79], v[152:155], a[248:251], v[64:79]
    ds_read_b64_tr_b16 v[152:153], v14 offset:61440
    ds_read_b64_tr_b16 v[154:155], v14 offset:63488
    v_mfma_f32_32x32x16_bf16 v[80:95], v[156:159], a[248:251], v[80:95]
    ds_read_b64_tr_b16 v[156:157], v15 offset:61440
    ds_read_b64_tr_b16 v[158:159], v15 offset:63488
    s_waitcnt lgkmcnt(8)
    v_mfma_f32_32x32x16_bf16 v[96:111], v[160:163], a[152:155], v[96:111]
    ds_read_b64_tr_b16 v[160:161], v9 offset:58368
    ds_read_b64_tr_b16 v[162:163], v9 offset:59904
    v_mfma_f32_32x32x16_bf16 v[112:127], v[164:167], a[152:155], v[112:127]
    ds_read_b64_tr_b16 v[164:165], v9 offset:58432
    ds_read_b64_tr_b16 v[166:167], v9 offset:59968
    v_mfma_f32_32x32x16_bf16 v[128:143], v[168:171], a[152:155], v[128:143]
    ds_read_b64_tr_b16 v[168:169], v9 offset:58496
    ds_read_b64_tr_b16 v[170:171], v9 offset:60032
    s_waitcnt vmcnt(6) lgkmcnt(6)
    v_mfma_f32_32x32x16_bf16 v[32:47], v[144:147], a[252:255], v[32:47]
    v_mfma_f32_32x32x16_bf16 v[48:63], v[148:151], a[252:255], v[48:63]
    v_mfma_f32_32x32x16_bf16 v[64:79], v[152:155], a[252:255], v[64:79]
    v_mfma_f32_32x32x16_bf16 v[80:95], v[156:159], a[252:255], v[80:95]
    s_waitcnt lgkmcnt(0)
    v_mfma_f32_32x32x16_bf16 v[96:111], v[160:163], a[156:159], v[96:111]
    ds_read_b64_tr_b16 v[160:161], v9 offset:0
    ds_read_b64_tr_b16 v[162:163], v9 offset:1536
    v_mfma_f32_32x32x16_bf16 v[112:127], v[164:167], a[156:159], v[112:127]
    ds_read_b64_tr_b16 v[164:165], v9 offset:64
    ds_read_b64_tr_b16 v[166:167], v9 offset:1600
    v_mfma_f32_32x32x16_bf16 v[128:143], v[168:171], a[156:159], v[128:143]
    ds_read_b64_tr_b16 v[168:169], v9 offset:128
    ds_read_b64_tr_b16 v[170:171], v9 offset:1664
    s_waitcnt vmcnt(7)
    s_barrier
    s_waitcnt lgkmcnt(2)
    v_mfma_f32_32x32x16_bf16 v[96:111], v[160:163], a[160:163], v[96:111]
    ds_read_b64_tr_b16 v[160:161], v9 offset:3072
    ds_read_b64_tr_b16 v[162:163], v9 offset:4608
    s_add_u32 m0, s52, 114688
    s_add_u32 s55, s48, 6
    s_and_b32 s55, s55, 7
    s_add_u32 s55, s55, 8
    s_mul_i32 s55, s55, 458752
    s_add_u32 s55, s55, s51
    ds_read_b128 v[176:179], v17 offset:0
    ds_read_b128 v[180:183], v17 offset:32
    ds_read_b128 v[184:187], v17 offset:64
    ds_read_b128 v[188:191], v17 offset:96
    ds_read_b128 v[192:195], v17 offset:128
    ds_read_b128 v[196:199], v17 offset:160
    ds_read_b128 v[200:203], v17 offset:192
    ds_read_b128 v[204:207], v17 offset:224
    s_waitcnt lgkmcnt(4)
    v_fma_f32 v216, v176, v172, v32
    v_fma_f32 v217, v177, v172, v33
    v_fma_f32 v218, v178, v172, v34
    v_fma_f32 v219, v179, v172, v35
    v_mfma_f32_32x32x16_bf16 v[112:127], v[164:167], a[160:163], v[112:127]
    buffer_load_dwordx4 v5, s[40:43], s55 offen lds
    ds_read_b64_tr_b16 v[164:165], v9 offset:3136
    ds_read_b64_tr_b16 v[166:167], v9 offset:4672
    s_add_u32 m0, s52, 115712
    v_mul_f32 v216, v216, v174
    v_mul_f32 v217, v217, v174
    v_mul_f32 v218, v218, v174
    v_mul_f32 v219, v219, v174
    v_mul_f32 v220, v216, v216
    v_mul_f32 v221, v217, v217
    v_mul_f32 v222, v218, v218
    s_waitcnt lgkmcnt(12)
    v_mfma_f32_32x32x16_bf16 v[128:143], v[168:171], a[160:163], v[128:143]
    buffer_load_dwordx4 v6, s[40:43], s55 offen lds
    ds_read_b64_tr_b16 v[168:169], v9 offset:3200
    ds_read_b64_tr_b16 v[170:171], v9 offset:4736
    v_mul_f32 v223, v219, v219
    v_fma_f32 v220, v220, v210, v208
    v_fma_f32 v221, v221, v210, v208
    v_fma_f32 v222, v222, v210, v208
    v_fma_f32 v223, v223, v210, v208
    v_mul_f32 v220, v220, v216
    v_mul_f32 v221, v221, v217
    s_waitcnt lgkmcnt(2)
    v_mfma_f32_32x32x16_bf16 v[96:111], v[160:163], a[164:167], v[96:111]
    ds_read_b64_tr_b16 v[160:161], v9 offset:6144
    ds_read_b64_tr_b16 v[162:163], v9 offset:7680
    s_add_u32 m0, s52, 116736
    v_mul_f32 v222, v222, v218
    v_mul_f32 v223, v223, v219
    v_exp_f32 v220, v220
    v_exp_f32 v221, v221
    v_exp_f32 v222, v222
    v_exp_f32 v223, v223
    v_add_f32 v220, 1.0, v220
    v_mfma_f32_32x32x16_bf16 v[112:127], v[164:167], a[164:167], v[112:127]
    buffer_load_dwordx4 v7, s[40:43], s55 offen lds
    ds_read_b64_tr_b16 v[164:165], v9 offset:6208
    ds_read_b64_tr_b16 v[166:167], v9 offset:7744
    s_add_u32 m0, s81, 0
    s_bfe_u32 s85, s64, s72
    s_lshl_b32 s85, s85, 15
    s_add_u32 s85, s85, s84
    v_add_f32 v221, 1.0, v221
    v_add_f32 v222, 1.0, v222
    v_add_f32 v223, 1.0, v223
    v_rcp_f32 v220, v220
    v_rcp_f32 v221, v221
    v_rcp_f32 v222, v222
    v_rcp_f32 v223, v223
    s_waitcnt lgkmcnt(4)
    v_mfma_f32_32x32x16_bf16 v[128:143], v[168:171], a[164:167], v[128:143]
    buffer_load_dwordx4 v8, s[44:47], s85 offen lds
    ds_read_b64_tr_b16 v[168:169], v9 offset:6272
    ds_read_b64_tr_b16 v[170:171], v9 offset:7808
    v_mul_f32 v216, v216, v220
    v_mul_f32 v217, v217, v221
    v_mul_f32 v218, v218, v222
    v_mul_f32 v219, v219, v223
    v_cvt_pk_bf16_f32 v224, v216, v217
    v_cvt_pk_bf16_f32 v225, v218, v219
    v_fma_f32 v216, v180, v172, v36
    s_waitcnt lgkmcnt(2)
    v_mfma_f32_32x32x16_bf16 v[96:111], v[160:163], a[168:171], v[96:111]
    ds_read_b64_tr_b16 v[160:161], v9 offset:9216
    ds_read_b64_tr_b16 v[162:163], v9 offset:10752
    s_add_u32 m0, s81, 1024
    s_add_u32 s85, s85, 16384
    v_fma_f32 v217, v181, v172, v37
    v_fma_f32 v218, v182, v172, v38
    v_fma_f32 v219, v183, v172, v39
    v_mul_f32 v216, v216, v174
    v_mul_f32 v217, v217, v174
    v_mul_f32 v218, v218, v174
    v_mul_f32 v219, v219, v174
    v_mfma_f32_32x32x16_bf16 v[112:127], v[164:167], a[168:171], v[112:127]
    buffer_load_dwordx4 v8, s[44:47], s85 offen lds
    ds_read_b64_tr_b16 v[164:165], v9 offset:9280
    ds_read_b64_tr_b16 v[166:167], v9 offset:10816
    s_add_u32 m0, s81, 8192
    s_bfe_u32 s85, s64, s73
    s_lshl_b32 s85, s85, 15
    s_add_u32 s85, s85, s84
    v_mul_f32 v220, v216, v216
    v_mul_f32 v221, v217, v217
    v_mul_f32 v222, v218, v218
    v_mul_f32 v223, v219, v219
    v_fma_f32 v220, v220, v210, v208
    v_fma_f32 v221, v221, v210, v208
    v_fma_f32 v222, v222, v210, v208
    s_waitcnt lgkmcnt(4)
    v_mfma_f32_32x32x16_bf16 v[128:143], v[168:171], a[168:171], v[128:143]
    buffer_load_dwordx4 v8, s[44:47], s85 offen lds
    ds_read_b64_tr_b16 v[168:169], v9 offset:9344
    ds_read_b64_tr_b16 v[170:171], v9 offset:10880
    v_fma_f32 v223, v223, v210, v208
    v_mul_f32 v220, v220, v216
    v_mul_f32 v221, v221, v217
    v_mul_f32 v222, v222, v218
    v_mul_f32 v223, v223, v219
    v_exp_f32 v220, v220
    v_exp_f32 v221, v221
    s_waitcnt lgkmcnt(2)
    v_mfma_f32_32x32x16_bf16 v[96:111], v[160:163], a[172:175], v[96:111]
    ds_read_b64_tr_b16 v[160:161], v9 offset:12288
    ds_read_b64_tr_b16 v[162:163], v9 offset:13824
    s_add_u32 m0, s81, 9216
    s_add_u32 s85, s85, 16384
    v_exp_f32 v222, v222
    v_exp_f32 v223, v223
    v_add_f32 v220, 1.0, v220
    v_add_f32 v221, 1.0, v221
    v_add_f32 v222, 1.0, v222
    v_add_f32 v223, 1.0, v223
    v_rcp_f32 v220, v220
    v_mfma_f32_32x32x16_bf16 v[112:127], v[164:167], a[172:175], v[112:127]
    buffer_load_dwordx4 v8, s[44:47], s85 offen lds
    ds_read_b64_tr_b16 v[164:165], v9 offset:12352
    ds_read_b64_tr_b16 v[166:167], v9 offset:13888
    s_add_u32 m0, s81, 16384
    s_bfe_u32 s85, s64, s74
    s_lshl_b32 s85, s85, 15
    s_add_u32 s85, s85, s84
    v_rcp_f32 v221, v221
    v_rcp_f32 v222, v222
    v_rcp_f32 v223, v223
    v_mul_f32 v216, v216, v220
    v_mul_f32 v217, v217, v221
    v_mul_f32 v218, v218, v222
    v_mul_f32 v219, v219, v223
    s_waitcnt lgkmcnt(4)
    v_mfma_f32_32x32x16_bf16 v[128:143], v[168:171], a[172:175], v[128:143]
    buffer_load_dwordx4 v8, s[44:47], s85 offen lds
    ds_read_b64_tr_b16 v[168:169], v9 offset:12416
    ds_read_b64_tr_b16 v[170:171], v9 offset:13952
    v_cvt_pk_bf16_f32 v226, v216, v217
    v_cvt_pk_bf16_f32 v227, v218, v219
    s_add_u32 s87, s82, 0
    buffer_store_dwordx4 v[224:227], v2, s[32:35], s87 offen sc1
    v_fma_f32 v216, v184, v172, v40
    v_fma_f32 v217, v185, v172, v41
    v_fma_f32 v218, v186, v172, v42
    v_fma_f32 v219, v187, v172, v43
    s_waitcnt vmcnt(12)
    s_barrier
    s_waitcnt lgkmcnt(2)
    v_mfma_f32_32x32x16_bf16 v[96:111], v[160:163], a[176:179], v[96:111]
    ds_read_b64_tr_b16 v[160:161], v9 offset:15360
    ds_read_b64_tr_b16 v[162:163], v9 offset:16896
    s_add_u32 m0, s52, 65536
    s_add_u32 s55, s48, 7
    s_and_b32 s55, s55, 7
    s_add_u32 s55, s55, 8
    s_mul_i32 s55, s55, 458752
    s_add_u32 s55, s55, s51
    v_mul_f32 v216, v216, v174
    v_mul_f32 v217, v217, v174
    v_mul_f32 v218, v218, v174
    v_mul_f32 v219, v219, v174
    v_mul_f32 v220, v216, v216
    v_mul_f32 v221, v217, v217
    v_mul_f32 v222, v218, v218
    v_mfma_f32_32x32x16_bf16 v[112:127], v[164:167], a[176:179], v[112:127]
    buffer_load_dwordx4 v5, s[40:43], s55 offen lds
    ds_read_b64_tr_b16 v[164:165], v9 offset:15424
    ds_read_b64_tr_b16 v[166:167], v9 offset:16960
    s_add_u32 m0, s52, 66560
    v_mul_f32 v223, v219, v219
    v_fma_f32 v220, v220, v210, v208
    v_fma_f32 v221, v221, v210, v208
    v_fma_f32 v222, v222, v210, v208
    v_fma_f32 v223, v223, v210, v208
    v_mul_f32 v220, v220, v216
    v_mul_f32 v221, v221, v217
    s_waitcnt lgkmcnt(4)
    v_mfma_f32_32x32x16_bf16 v[128:143], v[168:171], a[176:179], v[128:143]
    buffer_load_dwordx4 v6, s[40:43], s55 offen lds
    ds_read_b64_tr_b16 v[168:169], v9 offset:15488
    ds_read_b64_tr_b16 v[170:171], v9 offset:17024
    v_mul_f32 v222, v222, v218
    v_mul_f32 v223, v223, v219
    v_exp_f32 v220, v220
    v_exp_f32 v221, v221
    v_exp_f32 v222, v222
    v_exp_f32 v223, v223
    v_add_f32 v220, 1.0, v220
    s_waitcnt lgkmcnt(2)
    v_mfma_f32_32x32x16_bf16 v[96:111], v[160:163], a[180:183], v[96:111]
    ds_read_b64_tr_b16 v[160:161], v9 offset:18432
    ds_read_b64_tr_b16 v[162:163], v9 offset:19968
    s_add_u32 m0, s52, 67584
    v_add_f32 v221, 1.0, v221
    v_add_f32 v222, 1.0, v222
    v_add_f32 v223, 1.0, v223
    v_rcp_f32 v220, v220
    v_rcp_f32 v221, v221
    v_rcp_f32 v222, v222
    v_rcp_f32 v223, v223
    v_mfma_f32_32x32x16_bf16 v[112:127], v[164:167], a[180:183], v[112:127]
    buffer_load_dwordx4 v7, s[40:43], s55 offen lds
    ds_read_b64_tr_b16 v[164:165], v9 offset:18496
    ds_read_b64_tr_b16 v[166:167], v9 offset:20032
    s_add_u32 m0, s81, 17408
    s_add_u32 s85, s85, 16384
    v_mul_f32 v216, v216, v220
    v_mul_f32 v217, v217, v221
    v_mul_f32 v218, v218, v222
    v_mul_f32 v219, v219, v223
    v_cvt_pk_bf16_f32 v228, v216, v217
    v_cvt_pk_bf16_f32 v229, v218, v219
    v_fma_f32 v216, v188, v172, v44
    s_waitcnt lgkmcnt(4)
    v_mfma_f32_32x32x16_bf16 v[128:143], v[168:171], a[180:183], v[128:143]
    buffer_load_dwordx4 v8, s[44:47], s85 offen lds
    ds_read_b64_tr_b16 v[168:169], v9 offset:18560
    ds_read_b64_tr_b16 v[170:171], v9 offset:20096
    v_fma_f32 v217, v189, v172, v45
    v_fma_f32 v218, v190, v172, v46
    v_fma_f32 v219, v191, v172, v47
    v_mul_f32 v216, v216, v174
    v_mul_f32 v217, v217, v174
    v_mul_f32 v218, v218, v174
    v_mul_f32 v219, v219, v174
    s_waitcnt lgkmcnt(2)
    v_mfma_f32_32x32x16_bf16 v[96:111], v[160:163], a[184:187], v[96:111]
    ds_read_b64_tr_b16 v[160:161], v9 offset:21504
    ds_read_b64_tr_b16 v[162:163], v9 offset:23040
    s_add_u32 m0, s81, 24576
    s_bfe_u32 s85, s64, s75
    s_lshl_b32 s85, s85, 15
    s_add_u32 s85, s85, s84
    v_mul_f32 v220, v216, v216
    v_mul_f32 v221, v217, v217
    v_mul_f32 v222, v218, v218
    v_mul_f32 v223, v219, v219
    v_fma_f32 v220, v220, v210, v208
    v_fma_f32 v221, v221, v210, v208
    v_fma_f32 v222, v222, v210, v208
    v_mfma_f32_32x32x16_bf16 v[112:127], v[164:167], a[184:187], v[112:127]
    buffer_load_dwordx4 v8, s[44:47], s85 offen lds
    ds_read_b64_tr_b16 v[164:165], v9 offset:21568
    ds_read_b64_tr_b16 v[166:167], v9 offset:23104
    s_add_u32 m0, s81, 25600
    s_add_u32 s85, s85, 16384
    v_fma_f32 v223, v223, v210, v208
    v_mul_f32 v220, v220, v216
    v_mul_f32 v221, v221, v217
    v_mul_f32 v222, v222, v218
    v_mul_f32 v223, v223, v219
    v_exp_f32 v220, v220
    v_exp_f32 v221, v221
    s_waitcnt lgkmcnt(4)
    v_mfma_f32_32x32x16_bf16 v[128:143], v[168:171], a[184:187], v[128:143]
    buffer_load_dwordx4 v8, s[44:47], s85 offen lds
    ds_read_b64_tr_b16 v[168:169], v9 offset:21632
    ds_read_b64_tr_b16 v[170:171], v9 offset:23168
    v_exp_f32 v222, v222
    v_exp_f32 v223, v223
    v_add_f32 v220, 1.0, v220
    v_add_f32 v221, 1.0, v221
    v_add_f32 v222, 1.0, v222
    v_add_f32 v223, 1.0, v223
    v_rcp_f32 v220, v220
    s_waitcnt lgkmcnt(2)
    v_mfma_f32_32x32x16_bf16 v[96:111], v[160:163], a[188:191], v[96:111]
    ds_read_b64_tr_b16 v[160:161], v9 offset:24576
    ds_read_b64_tr_b16 v[162:163], v9 offset:26112
    s_add_u32 m0, s81, 32768
    s_bfe_u32 s85, s65, s72
    s_lshl_b32 s85, s85, 15
    s_add_u32 s85, s85, s84
    v_rcp_f32 v221, v221
    v_rcp_f32 v222, v222
    v_rcp_f32 v223, v223
    v_mul_f32 v216, v216, v220
    v_mul_f32 v217, v217, v221
    v_mul_f32 v218, v218, v222
    v_mul_f32 v219, v219, v223
    v_mfma_f32_32x32x16_bf16 v[112:127], v[164:167], a[188:191], v[112:127]
    buffer_load_dwordx4 v8, s[44:47], s85 offen lds
    ds_read_b64_tr_b16 v[164:165], v9 offset:24640
    ds_read_b64_tr_b16 v[166:167], v9 offset:26176
    s_add_u32 m0, s81, 33792
    s_add_u32 s85, s85, 16384
    v_cvt_pk_bf16_f32 v230, v216, v217
    v_cvt_pk_bf16_f32 v231, v218, v219
    s_add_u32 s87, s82, 1024
    buffer_store_dwordx4 v[228:231], v2, s[32:35], s87 offen sc1
    ds_read_b128 v[176:179], v17 offset:256
    ds_read_b128 v[180:183], v17 offset:288
    ds_read_b128 v[184:187], v17 offset:320
    ds_read_b128 v[188:191], v17 offset:352
    s_waitcnt lgkmcnt(15)
    v_fma_f32 v216, v192, v172, v48
    v_fma_f32 v217, v193, v172, v49
    s_waitcnt lgkmcnt(8)
    v_mfma_f32_32x32x16_bf16 v[128:143], v[168:171], a[188:191], v[128:143]
    buffer_load_dwordx4 v8, s[44:47], s85 offen lds
    ds_read_b64_tr_b16 v[168:169], v9 offset:24704
    ds_read_b64_tr_b16 v[170:171], v9 offset:26240
    v_fma_f32 v218, v194, v172, v50
    v_fma_f32 v219, v195, v172, v51
    v_mul_f32 v216, v216, v174
    v_mul_f32 v217, v217, v174
    v_mul_f32 v218, v218, v174
    v_mul_f32 v219, v219, v174
    v_mul_f32 v220, v216, v216
    s_waitcnt vmcnt(18)
    s_barrier
    s_waitcnt lgkmcnt(6)
    v_mfma_f32_32x32x16_bf16 v[96:111], v[160:163], a[192:195], v[96:111]
    ds_read_b64_tr_b16 v[160:161], v9 offset:27648
    ds_read_b64_tr_b16 v[162:163], v9 offset:29184
    v_mul_f32 v221, v217, v217
    v_mul_f32 v222, v218, v218
    v_mul_f32 v223, v219, v219
    v_fma_f32 v220, v220, v210, v208
    v_fma_f32 v221, v221, v210, v208
    v_fma_f32 v222, v222, v210, v208
    v_fma_f32 v223, v223, v210, v208
    v_mfma_f32_32x32x16_bf16 v[112:127], v[164:167], a[192:195], v[112:127]
    ds_read_b64_tr_b16 v[164:165], v9 offset:27712
    ds_read_b64_tr_b16 v[166:167], v9 offset:29248
    v_mul_f32 v220, v220, v216
    v_mul_f32 v221, v221, v217
    v_mul_f32 v222, v222, v218
    v_mul_f32 v223, v223, v219
    v_exp_f32 v220, v220
    v_exp_f32 v221, v221
    v_exp_f32 v222, v222
    s_waitcnt lgkmcnt(4)
    v_mfma_f32_32x32x16_bf16 v[128:143], v[168:171], a[192:195], v[128:143]
    ds_read_b64_tr_b16 v[168:169], v9 offset:27776
    ds_read_b64_tr_b16 v[170:171], v9 offset:29312
    v_exp_f32 v223, v223
    v_add_f32 v220, 1.0, v220
    v_add_f32 v221, 1.0, v221
    v_add_f32 v222, 1.0, v222
    v_add_f32 v223, 1.0, v223
    v_rcp_f32 v220, v220
    v_rcp_f32 v221, v221
    s_waitcnt lgkmcnt(2)
    v_mfma_f32_32x32x16_bf16 v[96:111], v[160:163], a[196:199], v[96:111]
    ds_read_b64_tr_b16 v[160:161], v9 offset:30720
    ds_read_b64_tr_b16 v[162:163], v9 offset:32256
    v_rcp_f32 v222, v222
    v_rcp_f32 v223, v223
    v_mul_f32 v216, v216, v220
    v_mul_f32 v217, v217, v221
    v_mul_f32 v218, v218, v222
    v_mul_f32 v219, v219, v223
    v_cvt_pk_bf16_f32 v224, v216, v217
    v_mfma_f32_32x32x16_bf16 v[112:127], v[164:167], a[196:199], v[112:127]
    ds_read_b64_tr_b16 v[164:165], v9 offset:30784
    ds_read_b64_tr_b16 v[166:167], v9 offset:32320
    v_cvt_pk_bf16_f32 v225, v218, v219
    v_fma_f32 v216, v196, v172, v52
    v_fma_f32 v217, v197, v172, v53
    v_fma_f32 v218, v198, v172, v54
    v_fma_f32 v219, v199, v172, v55
    v_mul_f32 v216, v216, v174
    v_mul_f32 v217, v217, v174
    s_waitcnt lgkmcnt(4)
    v_mfma_f32_32x32x16_bf16 v[128:143], v[168:171], a[196:199], v[128:143]
    ds_read_b64_tr_b16 v[168:169], v9 offset:30848
    ds_read_b64_tr_b16 v[170:171], v9 offset:32384
    v_mul_f32 v218, v218, v174
    v_mul_f32 v219, v219, v174
    v_mul_f32 v220, v216, v216
    v_mul_f32 v221, v217, v217
    v_mul_f32 v222, v218, v218
    v_mul_f32 v223, v219, v219
    v_fma_f32 v220, v220, v210, v208
    s_waitcnt lgkmcnt(2)
    v_mfma_f32_32x32x16_bf16 v[96:111], v[160:163], a[200:203], v[96:111]
    ds_read_b64_tr_b16 v[160:161], v9 offset:33792
    ds_read_b64_tr_b16 v[162:163], v9 offset:35328
    v_fma_f32 v221, v221, v210, v208
    v_fma_f32 v222, v222, v210, v208
    v_fma_f32 v223, v223, v210, v208
    v_mul_f32 v220, v220, v216
    v_mul_f32 v221, v221, v217
    v_mul_f32 v222, v222, v218
    v_mul_f32 v223, v223, v219
    v_mfma_f32_32x32x16_bf16 v[112:127], v[164:167], a[200:203], v[112:127]
    ds_read_b64_tr_b16 v[164:165], v9 offset:33856
    ds_read_b64_tr_b16 v[166:167], v9 offset:35392
    v_exp_f32 v220, v220
    v_exp_f32 v221, v221
    v_exp_f32 v222, v222
    v_exp_f32 v223, v223
    v_add_f32 v220, 1.0, v220
    v_add_f32 v221, 1.0, v221
    v_add_f32 v222, 1.0, v222
    s_waitcnt lgkmcnt(4)
    v_mfma_f32_32x32x16_bf16 v[128:143], v[168:171], a[200:203], v[128:143]
    ds_read_b64_tr_b16 v[168:169], v9 offset:33920
    ds_read_b64_tr_b16 v[170:171], v9 offset:35456
    v_add_f32 v223, 1.0, v223
    v_rcp_f32 v220, v220
    v_rcp_f32 v221, v221
    v_rcp_f32 v222, v222
    v_rcp_f32 v223, v223
    v_mul_f32 v216, v216, v220
    v_mul_f32 v217, v217, v221
    s_waitcnt lgkmcnt(2)
    v_mfma_f32_32x32x16_bf16 v[96:111], v[160:163], a[204:207], v[96:111]
    ds_read_b64_tr_b16 v[160:161], v9 offset:36864
    ds_read_b64_tr_b16 v[162:163], v9 offset:38400
    v_mul_f32 v218, v218, v222
    v_mul_f32 v219, v219, v223
    v_cvt_pk_bf16_f32 v226, v216, v217
    v_cvt_pk_bf16_f32 v227, v218, v219
    s_add_u32 s87, s82, 2048
    buffer_store_dwordx4 v[224:227], v2, s[32:35], s87 offen sc1
    v_fma_f32 v216, v200, v172, v56
    v_fma_f32 v217, v201, v172, v57
    v_mfma_f32_32x32x16_bf16 v[112:127], v[164:167], a[204:207], v[112:127]
    ds_read_b64_tr_b16 v[164:165], v9 offset:36928
    ds_read_b64_tr_b16 v[166:167], v9 offset:38464
    v_fma_f32 v218, v202, v172, v58
    v_fma_f32 v219, v203, v172, v59
    v_mul_f32 v216, v216, v174
    v_mul_f32 v217, v217, v174
    v_mul_f32 v218, v218, v174
    v_mul_f32 v219, v219, v174
    v_mul_f32 v220, v216, v216
    s_waitcnt lgkmcnt(4)
    v_mfma_f32_32x32x16_bf16 v[128:143], v[168:171], a[204:207], v[128:143]
    ds_read_b64_tr_b16 v[168:169], v9 offset:36992
    ds_read_b64_tr_b16 v[170:171], v9 offset:38528
    v_mul_f32 v221, v217, v217
    v_mul_f32 v222, v218, v218
    v_mul_f32 v223, v219, v219
    v_fma_f32 v220, v220, v210, v208
    v_fma_f32 v221, v221, v210, v208
    v_fma_f32 v222, v222, v210, v208
    v_fma_f32 v223, v223, v210, v208
    s_waitcnt vmcnt(16)
    s_barrier
    s_waitcnt lgkmcnt(2)
    v_mfma_f32_32x32x16_bf16 v[96:111], v[160:163], a[208:211], v[96:111]
    ds_read_b64_tr_b16 v[160:161], v9 offset:39936
    ds_read_b64_tr_b16 v[162:163], v9 offset:41472
    v_mul_f32 v220, v220, v216
    v_mul_f32 v221, v221, v217
    v_mul_f32 v222, v222, v218
    v_mul_f32 v223, v223, v219
    v_exp_f32 v220, v220
    v_exp_f32 v221, v221
    v_exp_f32 v222, v222
    v_mfma_f32_32x32x16_bf16 v[112:127], v[164:167], a[208:211], v[112:127]
    ds_read_b64_tr_b16 v[164:165], v9 offset:40000
    ds_read_b64_tr_b16 v[166:167], v9 offset:41536
    v_exp_f32 v223, v223
    v_add_f32 v220, 1.0, v220
    v_add_f32 v221, 1.0, v221
    v_add_f32 v222, 1.0, v222
    v_add_f32 v223, 1.0, v223
    v_rcp_f32 v220, v220
    v_rcp_f32 v221, v221
    s_waitcnt lgkmcnt(4)
    v_mfma_f32_32x32x16_bf16 v[128:143], v[168:171], a[208:211], v[128:143]
    ds_read_b64_tr_b16 v[168:169], v9 offset:40064
    ds_read_b64_tr_b16 v[170:171], v9 offset:41600
    v_rcp_f32 v222, v222
    v_rcp_f32 v223, v223
    v_mul_f32 v216, v216, v220
    v_mul_f32 v217, v217, v221
    v_mul_f32 v218, v218, v222
    v_mul_f32 v219, v219, v223
    v_cvt_pk_bf16_f32 v228, v216, v217
    s_waitcnt lgkmcnt(2)
    v_mfma_f32_32x32x16_bf16 v[96:111], v[160:163], a[212:215], v[96:111]
    ds_read_b64_tr_b16 v[160:161], v9 offset:43008
    ds_read_b64_tr_b16 v[162:163], v9 offset:44544
    v_cvt_pk_bf16_f32 v229, v218, v219
    v_fma_f32 v216, v204, v172, v60
    v_fma_f32 v217, v205, v172, v61
    v_fma_f32 v218, v206, v172, v62
    v_fma_f32 v219, v207, v172, v63
    v_mul_f32 v216, v216, v174
    v_mul_f32 v217, v217, v174
    v_mfma_f32_32x32x16_bf16 v[112:127], v[164:167], a[212:215], v[112:127]
    ds_read_b64_tr_b16 v[164:165], v9 offset:43072
    ds_read_b64_tr_b16 v[166:167], v9 offset:44608
    v_mul_f32 v218, v218, v174
    v_mul_f32 v219, v219, v174
    v_mul_f32 v220, v216, v216
    v_mul_f32 v221, v217, v217
    v_mul_f32 v222, v218, v218
    v_mul_f32 v223, v219, v219
    v_fma_f32 v220, v220, v210, v208
    s_waitcnt lgkmcnt(4)
    v_mfma_f32_32x32x16_bf16 v[128:143], v[168:171], a[212:215], v[128:143]
    ds_read_b64_tr_b16 v[168:169], v9 offset:43136
    ds_read_b64_tr_b16 v[170:171], v9 offset:44672
    v_fma_f32 v221, v221, v210, v208
    v_fma_f32 v222, v222, v210, v208
    v_fma_f32 v223, v223, v210, v208
    v_mul_f32 v220, v220, v216
    v_mul_f32 v221, v221, v217
    v_mul_f32 v222, v222, v218
    v_mul_f32 v223, v223, v219
    s_waitcnt lgkmcnt(2)
    v_mfma_f32_32x32x16_bf16 v[96:111], v[160:163], a[216:219], v[96:111]
    ds_read_b64_tr_b16 v[160:161], v9 offset:46080
    ds_read_b64_tr_b16 v[162:163], v9 offset:47616
    v_exp_f32 v220, v220
    v_exp_f32 v221, v221
    v_exp_f32 v222, v222
    v_exp_f32 v223, v223
    v_add_f32 v220, 1.0, v220
    v_add_f32 v221, 1.0, v221
    v_add_f32 v222, 1.0, v222
    v_mfma_f32_32x32x16_bf16 v[112:127], v[164:167], a[216:219], v[112:127]
    ds_read_b64_tr_b16 v[164:165], v9 offset:46144
    ds_read_b64_tr_b16 v[166:167], v9 offset:47680
    v_add_f32 v223, 1.0, v223
    v_rcp_f32 v220, v220
    v_rcp_f32 v221, v221
    v_rcp_f32 v222, v222
    v_rcp_f32 v223, v223
    v_mul_f32 v216, v216, v220
    v_mul_f32 v217, v217, v221
    s_waitcnt lgkmcnt(4)
    v_mfma_f32_32x32x16_bf16 v[128:143], v[168:171], a[216:219], v[128:143]
    ds_read_b64_tr_b16 v[168:169], v9 offset:46208
    ds_read_b64_tr_b16 v[170:171], v9 offset:47744
    v_mul_f32 v218, v218, v222
    v_mul_f32 v219, v219, v223
    v_cvt_pk_bf16_f32 v230, v216, v217
    v_cvt_pk_bf16_f32 v231, v218, v219
    s_add_u32 s87, s82, 3072
    buffer_store_dwordx4 v[228:231], v2, s[32:35], s87 offen sc1
    s_waitcnt lgkmcnt(15)
    v_fma_f32 v216, v176, v172, v64
    s_waitcnt lgkmcnt(2)
    v_mfma_f32_32x32x16_bf16 v[96:111], v[160:163], a[220:223], v[96:111]
    ds_read_b64_tr_b16 v[160:161], v9 offset:49152
    ds_read_b64_tr_b16 v[162:163], v9 offset:50688
    v_fma_f32 v217, v177, v172, v65
    v_fma_f32 v218, v178, v172, v66
    v_fma_f32 v219, v179, v172, v67
    v_mul_f32 v216, v216, v174
    v_mul_f32 v217, v217, v174
    v_mul_f32 v218, v218, v174
    v_mul_f32 v219, v219, v174
    v_mfma_f32_32x32x16_bf16 v[112:127], v[164:167], a[220:223], v[112:127]
    ds_read_b64_tr_b16 v[164:165], v9 offset:49216
    ds_read_b64_tr_b16 v[166:167], v9 offset:50752
    v_mul_f32 v220, v216, v216
    v_mul_f32 v221, v217, v217
    v_mul_f32 v222, v218, v218
    v_mul_f32 v223, v219, v219
    v_fma_f32 v220, v220, v210, v208
    v_fma_f32 v221, v221, v210, v208
    v_fma_f32 v222, v222, v210, v208
    s_waitcnt lgkmcnt(4)
    v_mfma_f32_32x32x16_bf16 v[128:143], v[168:171], a[220:223], v[128:143]
    ds_read_b64_tr_b16 v[168:169], v9 offset:49280
    ds_read_b64_tr_b16 v[170:171], v9 offset:50816
    v_fma_f32 v223, v223, v210, v208
    v_mul_f32 v220, v220, v216
    v_mul_f32 v221, v221, v217
    v_mul_f32 v222, v222, v218
    v_mul_f32 v223, v223, v219
    v_exp_f32 v220, v220
    v_exp_f32 v221, v221
    s_waitcnt vmcnt(8)
    s_barrier
    s_waitcnt lgkmcnt(2)
    v_mfma_f32_32x32x16_bf16 v[96:111], v[160:163], a[224:227], v[96:111]
    ds_read_b64_tr_b16 v[160:161], v9 offset:52224
    ds_read_b64_tr_b16 v[162:163], v9 offset:53760
    v_exp_f32 v222, v222
    v_exp_f32 v223, v223
    v_add_f32 v220, 1.0, v220
    v_add_f32 v221, 1.0, v221
    v_add_f32 v222, 1.0, v222
    v_add_f32 v223, 1.0, v223
    v_rcp_f32 v220, v220
    v_mfma_f32_32x32x16_bf16 v[112:127], v[164:167], a[224:227], v[112:127]
    ds_read_b64_tr_b16 v[164:165], v9 offset:52288
    ds_read_b64_tr_b16 v[166:167], v9 offset:53824
    v_rcp_f32 v221, v221
    v_rcp_f32 v222, v222
    v_rcp_f32 v223, v223
    v_mul_f32 v216, v216, v220
    v_mul_f32 v217, v217, v221
    v_mul_f32 v218, v218, v222
    v_mul_f32 v219, v219, v223
    s_waitcnt lgkmcnt(4)
    v_mfma_f32_32x32x16_bf16 v[128:143], v[168:171], a[224:227], v[128:143]
    ds_read_b64_tr_b16 v[168:169], v9 offset:52352
    ds_read_b64_tr_b16 v[170:171], v9 offset:53888
    v_cvt_pk_bf16_f32 v224, v216, v217
    v_cvt_pk_bf16_f32 v225, v218, v219
    v_fma_f32 v216, v180, v172, v68
    v_fma_f32 v217, v181, v172, v69
    v_fma_f32 v218, v182, v172, v70
    v_fma_f32 v219, v183, v172, v71
    v_mul_f32 v216, v216, v174
    s_waitcnt lgkmcnt(2)
    v_mfma_f32_32x32x16_bf16 v[96:111], v[160:163], a[228:231], v[96:111]
    ds_read_b64_tr_b16 v[160:161], v9 offset:55296
    ds_read_b64_tr_b16 v[162:163], v9 offset:56832
    v_mul_f32 v217, v217, v174
    v_mul_f32 v218, v218, v174
    v_mul_f32 v219, v219, v174
    v_mul_f32 v220, v216, v216
    v_mul_f32 v221, v217, v217
    v_mul_f32 v222, v218, v218
    v_mul_f32 v223, v219, v219
    v_mfma_f32_32x32x16_bf16 v[112:127], v[164:167], a[228:231], v[112:127]
    ds_read_b64_tr_b16 v[164:165], v9 offset:55360
    ds_read_b64_tr_b16 v[166:167], v9 offset:56896
    v_fma_f32 v220, v220, v210, v208
    v_fma_f32 v221, v221, v210, v208
    v_fma_f32 v222, v222, v210, v208
    v_fma_f32 v223, v223, v210, v208
    v_mul_f32 v220, v220, v216
    v_mul_f32 v221, v221, v217
    v_mul_f32 v222, v222, v218
    s_waitcnt lgkmcnt(4)
    v_mfma_f32_32x32x16_bf16 v[128:143], v[168:171], a[228:231], v[128:143]
    ds_read_b64_tr_b16 v[168:169], v9 offset:55424
    ds_read_b64_tr_b16 v[170:171], v9 offset:56960
    v_mul_f32 v223, v223, v219
    v_exp_f32 v220, v220
    v_exp_f32 v221, v221
    v_exp_f32 v222, v222
    v_exp_f32 v223, v223
    v_add_f32 v220, 1.0, v220
    v_add_f32 v221, 1.0, v221
    s_waitcnt lgkmcnt(2)
    v_mfma_f32_32x32x16_bf16 v[96:111], v[160:163], a[232:235], v[96:111]
    ds_read_b64_tr_b16 v[160:161], v9 offset:58368
    ds_read_b64_tr_b16 v[162:163], v9 offset:59904
    v_add_f32 v222, 1.0, v222
    v_add_f32 v223, 1.0, v223
    v_rcp_f32 v220, v220
    v_rcp_f32 v221, v221
    v_rcp_f32 v222, v222
    v_rcp_f32 v223, v223
    v_mul_f32 v216, v216, v220
    v_mfma_f32_32x32x16_bf16 v[112:127], v[164:167], a[232:235], v[112:127]
    ds_read_b64_tr_b16 v[164:165], v9 offset:58432
    ds_read_b64_tr_b16 v[166:167], v9 offset:59968
    v_mul_f32 v217, v217, v221
    v_mul_f32 v218, v218, v222
    v_mul_f32 v219, v219, v223
    v_cvt_pk_bf16_f32 v226, v216, v217
    v_cvt_pk_bf16_f32 v227, v218, v219
    s_add_u32 s87, s82, 4096
    buffer_store_dwordx4 v[224:227], v2, s[32:35], s87 offen sc1
    v_fma_f32 v216, v184, v172, v72
    s_waitcnt lgkmcnt(4)
    v_mfma_f32_32x32x16_bf16 v[128:143], v[168:171], a[232:235], v[128:143]
    ds_read_b64_tr_b16 v[168:169], v9 offset:58496
    ds_read_b64_tr_b16 v[170:171], v9 offset:60032
    v_fma_f32 v217, v185, v172, v73
    v_fma_f32 v218, v186, v172, v74
    v_fma_f32 v219, v187, v172, v75
    v_mul_f32 v216, v216, v174
    v_mul_f32 v217, v217, v174
    v_mul_f32 v218, v218, v174
    v_mul_f32 v219, v219, v174
    s_waitcnt lgkmcnt(2)
    v_mfma_f32_32x32x16_bf16 v[96:111], v[160:163], a[236:239], v[96:111]
    ds_read_b64_tr_b16 v[160:161], v9 offset:0
    ds_read_b64_tr_b16 v[162:163], v9 offset:1536
    v_mul_f32 v220, v216, v216
    v_mul_f32 v221, v217, v217
    v_mul_f32 v222, v218, v218
    v_mul_f32 v223, v219, v219
    v_fma_f32 v220, v220, v210, v208
    v_fma_f32 v221, v221, v210, v208
    v_fma_f32 v222, v222, v210, v208
    v_mfma_f32_32x32x16_bf16 v[112:127], v[164:167], a[236:239], v[112:127]
    ds_read_b64_tr_b16 v[164:165], v9 offset:64
    ds_read_b64_tr_b16 v[166:167], v9 offset:1600
    v_fma_f32 v223, v223, v210, v208
    v_mul_f32 v220, v220, v216
    v_mul_f32 v221, v221, v217
    v_mul_f32 v222, v222, v218
    v_mul_f32 v223, v223, v219
    v_exp_f32 v220, v220
    v_exp_f32 v221, v221
    s_waitcnt lgkmcnt(4)
    v_mfma_f32_32x32x16_bf16 v[128:143], v[168:171], a[236:239], v[128:143]
    ds_read_b64_tr_b16 v[168:169], v9 offset:128
    ds_read_b64_tr_b16 v[170:171], v9 offset:1664
    v_exp_f32 v222, v222
    v_exp_f32 v223, v223
    v_add_f32 v220, 1.0, v220
    v_add_f32 v221, 1.0, v221
    v_add_f32 v222, 1.0, v222
    v_add_f32 v223, 1.0, v223
    v_rcp_f32 v220, v220
    s_waitcnt vmcnt(1)
    s_barrier
    s_add_u32 s28, s23, 80
    s_lshl_b32 s28, s28, 4
    s_add_u32 s28, s28, s24
    s_lshl_b32 s28, s28, 7
    s_add_u32 s28, s28, 26214400
    v_mov_b32 v20, s27
    buffer_store_dword v20, v234, s[32:35], s28 offen sc1
    s_waitcnt lgkmcnt(2)
    v_mfma_f32_32x32x16_bf16 v[96:111], v[160:163], a[240:243], v[96:111]
    ds_read_b64_tr_b16 v[160:161], v9 offset:3072
    ds_read_b64_tr_b16 v[162:163], v9 offset:4608
    v_rcp_f32 v221, v221
    v_rcp_f32 v222, v222
    v_rcp_f32 v223, v223
    v_mul_f32 v216, v216, v220
    v_mul_f32 v217, v217, v221
    v_mul_f32 v218, v218, v222
    v_mul_f32 v219, v219, v223
    v_mfma_f32_32x32x16_bf16 v[112:127], v[164:167], a[240:243], v[112:127]
    ds_read_b64_tr_b16 v[164:165], v9 offset:3136
    ds_read_b64_tr_b16 v[166:167], v9 offset:4672
    v_cvt_pk_bf16_f32 v228, v216, v217
    v_cvt_pk_bf16_f32 v229, v218, v219
    v_fma_f32 v216, v188, v172, v76
    v_fma_f32 v217, v189, v172, v77
    v_fma_f32 v218, v190, v172, v78
    v_fma_f32 v219, v191, v172, v79
    v_mul_f32 v216, v216, v174
    s_waitcnt lgkmcnt(4)
    v_mfma_f32_32x32x16_bf16 v[128:143], v[168:171], a[240:243], v[128:143]
    ds_read_b64_tr_b16 v[168:169], v9 offset:3200
    ds_read_b64_tr_b16 v[170:171], v9 offset:4736
    v_mul_f32 v217, v217, v174
    v_mul_f32 v218, v218, v174
    v_mul_f32 v219, v219, v174
    v_mul_f32 v220, v216, v216
    v_mul_f32 v221, v217, v217
    v_mul_f32 v222, v218, v218
    v_mul_f32 v223, v219, v219
    s_waitcnt lgkmcnt(2)
    v_mfma_f32_32x32x16_bf16 v[96:111], v[160:163], a[244:247], v[96:111]
    ds_read_b64_tr_b16 v[160:161], v9 offset:6144
    ds_read_b64_tr_b16 v[162:163], v9 offset:7680
    v_fma_f32 v220, v220, v210, v208
    v_fma_f32 v221, v221, v210, v208
    v_fma_f32 v222, v222, v210, v208
    v_fma_f32 v223, v223, v210, v208
    v_mul_f32 v220, v220, v216
    v_mul_f32 v221, v221, v217
    v_mul_f32 v222, v222, v218
    v_mfma_f32_32x32x16_bf16 v[112:127], v[164:167], a[244:247], v[112:127]
    ds_read_b64_tr_b16 v[164:165], v9 offset:6208
    ds_read_b64_tr_b16 v[166:167], v9 offset:7744
    v_mul_f32 v223, v223, v219
    v_exp_f32 v220, v220
    v_exp_f32 v221, v221
    v_exp_f32 v222, v222
    v_exp_f32 v223, v223
    v_add_f32 v220, 1.0, v220
    v_add_f32 v221, 1.0, v221
    s_waitcnt lgkmcnt(4)
    v_mfma_f32_32x32x16_bf16 v[128:143], v[168:171], a[244:247], v[128:143]
    ds_read_b64_tr_b16 v[168:169], v9 offset:6272
    ds_read_b64_tr_b16 v[170:171], v9 offset:7808
    v_add_f32 v222, 1.0, v222
    v_add_f32 v223, 1.0, v223
    v_rcp_f32 v220, v220
    v_rcp_f32 v221, v221
    v_rcp_f32 v222, v222
    v_rcp_f32 v223, v223
    v_mul_f32 v216, v216, v220
    s_waitcnt lgkmcnt(2)
    v_mfma_f32_32x32x16_bf16 v[96:111], v[160:163], a[248:251], v[96:111]
    ds_read_b64_tr_b16 v[160:161], v9 offset:9216
    ds_read_b64_tr_b16 v[162:163], v9 offset:10752
    v_mul_f32 v217, v217, v221
    v_mul_f32 v218, v218, v222
    v_mul_f32 v219, v219, v223
    v_cvt_pk_bf16_f32 v230, v216, v217
    v_cvt_pk_bf16_f32 v231, v218, v219
    s_add_u32 s87, s82, 5120
    buffer_store_dwordx4 v[228:231], v2, s[32:35], s87 offen sc1
    v_mfma_f32_32x32x16_bf16 v[112:127], v[164:167], a[248:251], v[112:127]
    ds_read_b64_tr_b16 v[164:165], v9 offset:9280
    ds_read_b64_tr_b16 v[166:167], v9 offset:10816
    s_waitcnt lgkmcnt(4)
    v_mfma_f32_32x32x16_bf16 v[128:143], v[168:171], a[248:251], v[128:143]
    ds_read_b64_tr_b16 v[168:169], v9 offset:9344
    ds_read_b64_tr_b16 v[170:171], v9 offset:10880
    s_waitcnt lgkmcnt(2)
    v_mfma_f32_32x32x16_bf16 v[96:111], v[160:163], a[252:255], v[96:111]
    v_mfma_f32_32x32x16_bf16 v[112:127], v[164:167], a[252:255], v[112:127]
    s_waitcnt lgkmcnt(0)
    v_mfma_f32_32x32x16_bf16 v[128:143], v[168:171], a[252:255], v[128:143]
    s_xor_b32 s31, s54, 1
    s_lshl_b32 s31, s31, 13
    s_add_u32 s87, s57, s31
    ds_read_b128 v[176:179], v17 offset:384
    ds_read_b128 v[180:183], v17 offset:416
    ds_read_b128 v[184:187], v17 offset:448
    ds_read_b128 v[188:191], v17 offset:480
    v_and_b32 v11, 15, v1
    v_lshlrev_b32 v11, 7, v11
    s_add_u32 s28, s21, 80
    s_lshl_b32 s28, s28, 11
    v_add_u32 v11, s28, v11
    v_lshrrev_b32 v20, 4, v1
    v_lshlrev_b32 v20, 2, v20
    v_add_u32 v11, v11, v20
    v_mov_b32 v20, 0x7ffffff0
    v_cmp_gt_u32 vcc, 64, v0
    s_nop 1
    v_cndmask_b32 v11, v20, v11, vcc
    ds_read_b128 v[192:195], v18 offset:0
    ds_read_b128 v[196:199], v18 offset:32
    ds_read_b128 v[200:203], v18 offset:64
    ds_read_b128 v[204:207], v18 offset:96
    s_waitcnt lgkmcnt(4)
    s_add_u32 s30, s82, 6144
    v_pk_fma_f32 v[144:145], v[176:177], v[172:173], v[80:81] op_sel_hi:[1,0,1]
    v_pk_fma_f32 v[148:149], v[178:179], v[172:173], v[82:83] op_sel_hi:[1,0,1]
    v_pk_fma_f32 v[152:153], v[180:181], v[172:173], v[84:85] op_sel_hi:[1,0,1]
    v_pk_fma_f32 v[156:157], v[182:183], v[172:173], v[86:87] op_sel_hi:[1,0,1]
    v_pk_mul_f32 v[144:145], v[144:145], v[174:175] op_sel_hi:[1,0]
    v_pk_mul_f32 v[148:149], v[148:149], v[174:175] op_sel_hi:[1,0]
    v_pk_mul_f32 v[152:153], v[152:153], v[174:175] op_sel_hi:[1,0]
    v_pk_mul_f32 v[156:157], v[156:157], v[174:175] op_sel_hi:[1,0]
    v_pk_mul_f32 v[146:147], v[144:145], v[144:145]
    v_pk_mul_f32 v[150:151], v[148:149], v[148:149]
    v_pk_mul_f32 v[154:155], v[152:153], v[152:153]
    v_pk_mul_f32 v[158:159], v[156:157], v[156:157]
    v_pk_fma_f32 v[146:147], v[146:147], v[210:211], v[208:209] op_sel_hi:[1,0,0]
    v_pk_fma_f32 v[150:151], v[150:151], v[210:211], v[208:209] op_sel_hi:[1,0,0]
    v_pk_fma_f32 v[154:155], v[154:155], v[210:211], v[208:209] op_sel_hi:[1,0,0]
    v_pk_fma_f32 v[158:159], v[158:159], v[210:211], v[208:209] op_sel_hi:[1,0,0]
    v_pk_mul_f32 v[146:147], v[146:147], v[144:145]
    v_pk_mul_f32 v[150:151], v[150:151], v[148:149]
    v_pk_mul_f32 v[154:155], v[154:155], v[152:153]
    v_pk_mul_f32 v[158:159], v[158:159], v[156:157]
    v_exp_f32 v146, v146
    v_exp_f32 v147, v147
    v_exp_f32 v150, v150
    v_exp_f32 v151, v151
    v_exp_f32 v154, v154
    v_exp_f32 v155, v155
    v_exp_f32 v158, v158
    v_exp_f32 v159, v159
    v_pk_add_f32 v[146:147], v[146:147], v[212:213] op_sel_hi:[1,0]
    v_pk_add_f32 v[150:151], v[150:151], v[212:213] op_sel_hi:[1,0]
    v_pk_add_f32 v[154:155], v[154:155], v[212:213] op_sel_hi:[1,0]
    v_pk_add_f32 v[158:159], v[158:159], v[212:213] op_sel_hi:[1,0]
    v_rcp_f32 v146, v146
    v_rcp_f32 v147, v147
    v_rcp_f32 v150, v150
    v_rcp_f32 v151, v151
    v_rcp_f32 v154, v154
    v_rcp_f32 v155, v155
    v_rcp_f32 v158, v158
    v_rcp_f32 v159, v159
    v_pk_mul_f32 v[144:145], v[144:145], v[146:147]
    v_pk_mul_f32 v[148:149], v[148:149], v[150:151]
    v_pk_mul_f32 v[152:153], v[152:153], v[154:155]
    v_pk_mul_f32 v[156:157], v[156:157], v[158:159]
    v_cvt_pk_bf16_f32 v216, v144, v145
    v_cvt_pk_bf16_f32 v217, v148, v149
    v_cvt_pk_bf16_f32 v218, v152, v153
    v_cvt_pk_bf16_f32 v219, v156, v157
    buffer_store_dwordx4 v[216:219], v2, s[32:35], s30 offen offset:0 sc1
    v_pk_fma_f32 v[144:145], v[184:185], v[172:173], v[88:89] op_sel_hi:[1,0,1]
    v_pk_fma_f32 v[148:149], v[186:187], v[172:173], v[90:91] op_sel_hi:[1,0,1]
    v_pk_fma_f32 v[152:153], v[188:189], v[172:173], v[92:93] op_sel_hi:[1,0,1]
    v_pk_fma_f32 v[156:157], v[190:191], v[172:173], v[94:95] op_sel_hi:[1,0,1]
    v_pk_mul_f32 v[144:145], v[144:145], v[174:175] op_sel_hi:[1,0]
    v_pk_mul_f32 v[148:149], v[148:149], v[174:175] op_sel_hi:[1,0]
    v_pk_mul_f32 v[152:153], v[152:153], v[174:175] op_sel_hi:[1,0]
    v_pk_mul_f32 v[156:157], v[156:157], v[174:175] op_sel_hi:[1,0]
    v_pk_mul_f32 v[146:147], v[144:145], v[144:145]
    v_pk_mul_f32 v[150:151], v[148:149], v[148:149]
    v_pk_mul_f32 v[154:155], v[152:153], v[152:153]
    v_pk_mul_f32 v[158:159], v[156:157], v[156:157]
    v_pk_fma_f32 v[146:147], v[146:147], v[210:211], v[208:209] op_sel_hi:[1,0,0]
    v_pk_fma_f32 v[150:151], v[150:151], v[210:211], v[208:209] op_sel_hi:[1,0,0]
    v_pk_fma_f32 v[154:155], v[154:155], v[210:211], v[208:209] op_sel_hi:[1,0,0]
    v_pk_fma_f32 v[158:159], v[158:159], v[210:211], v[208:209] op_sel_hi:[1,0,0]
    v_pk_mul_f32 v[146:147], v[146:147], v[144:145]
    v_pk_mul_f32 v[150:151], v[150:151], v[148:149]
    v_pk_mul_f32 v[154:155], v[154:155], v[152:153]
    v_pk_mul_f32 v[158:159], v[158:159], v[156:157]
    v_exp_f32 v146, v146
    v_exp_f32 v147, v147
    v_exp_f32 v150, v150
    v_exp_f32 v151, v151
    v_exp_f32 v154, v154
    v_exp_f32 v155, v155
    v_exp_f32 v158, v158
    v_exp_f32 v159, v159
    v_pk_add_f32 v[146:147], v[146:147], v[212:213] op_sel_hi:[1,0]
    v_pk_add_f32 v[150:151], v[150:151], v[212:213] op_sel_hi:[1,0]
    v_pk_add_f32 v[154:155], v[154:155], v[212:213] op_sel_hi:[1,0]
    v_pk_add_f32 v[158:159], v[158:159], v[212:213] op_sel_hi:[1,0]
    v_rcp_f32 v146, v146
    v_rcp_f32 v147, v147
    v_rcp_f32 v150, v150
    v_rcp_f32 v151, v151
    v_rcp_f32 v154, v154
    v_rcp_f32 v155, v155
    v_rcp_f32 v158, v158
    v_rcp_f32 v159, v159
    v_pk_mul_f32 v[144:145], v[144:145], v[146:147]
    v_pk_mul_f32 v[148:149], v[148:149], v[150:151]
    v_pk_mul_f32 v[152:153], v[152:153], v[154:155]
    v_pk_mul_f32 v[156:157], v[156:157], v[158:159]
    v_cvt_pk_bf16_f32 v220, v144, v145
    v_cvt_pk_bf16_f32 v221, v148, v149
    v_cvt_pk_bf16_f32 v222, v152, v153
    v_cvt_pk_bf16_f32 v223, v156, v157
    buffer_store_dwordx4 v[220:223], v2, s[32:35], s30 offen offset:1024 sc1
    ds_read_b128 v[176:179], v19 offset:0
    ds_read_b128 v[180:183], v19 offset:32
    ds_read_b128 v[184:187], v19 offset:64
    ds_read_b128 v[188:191], v19 offset:96
    s_waitcnt lgkmcnt(4)
    s_add_u32 s30, s87, 0
    v_pk_fma_f32 v[144:145], v[192:193], v[172:173], v[96:97] op_sel_hi:[1,0,1]
    v_pk_fma_f32 v[148:149], v[194:195], v[172:173], v[98:99] op_sel_hi:[1,0,1]
    v_pk_fma_f32 v[152:153], v[196:197], v[172:173], v[100:101] op_sel_hi:[1,0,1]
    v_pk_fma_f32 v[156:157], v[198:199], v[172:173], v[102:103] op_sel_hi:[1,0,1]
    v_pk_mul_f32 v[144:145], v[144:145], v[174:175] op_sel_hi:[1,0]
    v_pk_mul_f32 v[148:149], v[148:149], v[174:175] op_sel_hi:[1,0]
    v_pk_mul_f32 v[152:153], v[152:153], v[174:175] op_sel_hi:[1,0]
    v_pk_mul_f32 v[156:157], v[156:157], v[174:175] op_sel_hi:[1,0]
    v_pk_mul_f32 v[146:147], v[144:145], v[144:145]
    v_pk_mul_f32 v[150:151], v[148:149], v[148:149]
    v_pk_mul_f32 v[154:155], v[152:153], v[152:153]
    v_pk_mul_f32 v[158:159], v[156:157], v[156:157]
    v_pk_fma_f32 v[146:147], v[146:147], v[210:211], v[208:209] op_sel_hi:[1,0,0]
    v_pk_fma_f32 v[150:151], v[150:151], v[210:211], v[208:209] op_sel_hi:[1,0,0]
    v_pk_fma_f32 v[154:155], v[154:155], v[210:211], v[208:209] op_sel_hi:[1,0,0]
    v_pk_fma_f32 v[158:159], v[158:159], v[210:211], v[208:209] op_sel_hi:[1,0,0]
    v_pk_mul_f32 v[146:147], v[146:147], v[144:145]
    v_pk_mul_f32 v[150:151], v[150:151], v[148:149]
    v_pk_mul_f32 v[154:155], v[154:155], v[152:153]
    v_pk_mul_f32 v[158:159], v[158:159], v[156:157]
    v_exp_f32 v146, v146
    v_exp_f32 v147, v147
    v_exp_f32 v150, v150
    v_exp_f32 v151, v151
    v_exp_f32 v154, v154
    v_exp_f32 v155, v155
    v_exp_f32 v158, v158
    v_exp_f32 v159, v159
    v_pk_add_f32 v[146:147], v[146:147], v[212:213] op_sel_hi:[1,0]
    v_pk_add_f32 v[150:151], v[150:151], v[212:213] op_sel_hi:[1,0]
    v_pk_add_f32 v[154:155], v[154:155], v[212:213] op_sel_hi:[1,0]
    v_pk_add_f32 v[158:159], v[158:159], v[212:213] op_sel_hi:[1,0]
    v_rcp_f32 v146, v146
    v_rcp_f32 v147, v147
    v_rcp_f32 v150, v150
    v_rcp_f32 v151, v151
    v_rcp_f32 v154, v154
    v_rcp_f32 v155, v155
    v_rcp_f32 v158, v158
    v_rcp_f32 v159, v159
    v_pk_mul_f32 v[144:145], v[144:145], v[146:147]
    v_pk_mul_f32 v[148:149], v[148:149], v[150:151]
    v_pk_mul_f32 v[152:153], v[152:153], v[154:155]
    v_pk_mul_f32 v[156:157], v[156:157], v[158:159]
    v_cvt_pk_bf16_f32 v224, v144, v145
    v_cvt_pk_bf16_f32 v225, v148, v149
    v_cvt_pk_bf16_f32 v226, v152, v153
    v_cvt_pk_bf16_f32 v227, v156, v157
    buffer_store_dwordx4 v[224:227], v2, s[32:35], s30 offen offset:0 sc1
    v_pk_fma_f32 v[144:145], v[200:201], v[172:173], v[104:105] op_sel_hi:[1,0,1]
    v_pk_fma_f32 v[148:149], v[202:203], v[172:173], v[106:107] op_sel_hi:[1,0,1]
    v_pk_fma_f32 v[152:153], v[204:205], v[172:173], v[108:109] op_sel_hi:[1,0,1]
    v_pk_fma_f32 v[156:157], v[206:207], v[172:173], v[110:111] op_sel_hi:[1,0,1]
    v_pk_mul_f32 v[144:145], v[144:145], v[174:175] op_sel_hi:[1,0]
    v_pk_mul_f32 v[148:149], v[148:149], v[174:175] op_sel_hi:[1,0]
    v_pk_mul_f32 v[152:153], v[152:153], v[174:175] op_sel_hi:[1,0]
    v_pk_mul_f32 v[156:157], v[156:157], v[174:175] op_sel_hi:[1,0]
    v_pk_mul_f32 v[146:147], v[144:145], v[144:145]
    v_pk_mul_f32 v[150:151], v[148:149], v[148:149]
    v_pk_mul_f32 v[154:155], v[152:153], v[152:153]
    v_pk_mul_f32 v[158:159], v[156:157], v[156:157]
    v_pk_fma_f32 v[146:147], v[146:147], v[210:211], v[208:209] op_sel_hi:[1,0,0]
    v_pk_fma_f32 v[150:151], v[150:151], v[210:211], v[208:209] op_sel_hi:[1,0,0]
    v_pk_fma_f32 v[154:155], v[154:155], v[210:211], v[208:209] op_sel_hi:[1,0,0]
    v_pk_fma_f32 v[158:159], v[158:159], v[210:211], v[208:209] op_sel_hi:[1,0,0]
    v_pk_mul_f32 v[146:147], v[146:147], v[144:145]
    v_pk_mul_f32 v[150:151], v[150:151], v[148:149]
    v_pk_mul_f32 v[154:155], v[154:155], v[152:153]
    v_pk_mul_f32 v[158:159], v[158:159], v[156:157]
    v_exp_f32 v146, v146
    v_exp_f32 v147, v147
    v_exp_f32 v150, v150
    v_exp_f32 v151, v151
    v_exp_f32 v154, v154
    v_exp_f32 v155, v155
    v_exp_f32 v158, v158
    v_exp_f32 v159, v159
    v_pk_add_f32 v[146:147], v[146:147], v[212:213] op_sel_hi:[1,0]
    v_pk_add_f32 v[150:151], v[150:151], v[212:213] op_sel_hi:[1,0]
    v_pk_add_f32 v[154:155], v[154:155], v[212:213] op_sel_hi:[1,0]
    v_pk_add_f32 v[158:159], v[158:159], v[212:213] op_sel_hi:[1,0]
    v_rcp_f32 v146, v146
    v_rcp_f32 v147, v147
    v_rcp_f32 v150, v150
    v_rcp_f32 v151, v151
    v_rcp_f32 v154, v154
    v_rcp_f32 v155, v155
    v_rcp_f32 v158, v158
    v_rcp_f32 v159, v159
    v_pk_mul_f32 v[144:145], v[144:145], v[146:147]
    v_pk_mul_f32 v[148:149], v[148:149], v[150:151]
    v_pk_mul_f32 v[152:153], v[152:153], v[154:155]
    v_pk_mul_f32 v[156:157], v[156:157], v[158:159]
    v_cvt_pk_bf16_f32 v228, v144, v145
    v_cvt_pk_bf16_f32 v229, v148, v149
    v_cvt_pk_bf16_f32 v230, v152, v153
    v_cvt_pk_bf16_f32 v231, v156, v157
    buffer_store_dwordx4 v[228:231], v2, s[32:35], s30 offen offset:1024 sc1
    s_mov_b32 s31, 26214400
    buffer_load_dword v16, v11, s[32:35], s31 offen sc1
    ds_read_b128 v[192:195], v19 offset:128
    ds_read_b128 v[196:199], v19 offset:160
    ds_read_b128 v[200:203], v19 offset:192
    ds_read_b128 v[204:207], v19 offset:224
    s_waitcnt lgkmcnt(4)
    s_add_u32 s30, s57, 10240
    v_pk_fma_f32 v[144:145], v[176:177], v[172:173], v[112:113] op_sel_hi:[1,0,1]
    v_pk_fma_f32 v[148:149], v[178:179], v[172:173], v[114:115] op_sel_hi:[1,0,1]
    v_pk_fma_f32 v[152:153], v[180:181], v[172:173], v[116:117] op_sel_hi:[1,0,1]
    v_pk_fma_f32 v[156:157], v[182:183], v[172:173], v[118:119] op_sel_hi:[1,0,1]
    v_pk_mul_f32 v[144:145], v[144:145], v[174:175] op_sel_hi:[1,0]
    v_pk_mul_f32 v[148:149], v[148:149], v[174:175] op_sel_hi:[1,0]
    v_pk_mul_f32 v[152:153], v[152:153], v[174:175] op_sel_hi:[1,0]
    v_pk_mul_f32 v[156:157], v[156:157], v[174:175] op_sel_hi:[1,0]
    v_pk_mul_f32 v[146:147], v[144:145], v[144:145]
    v_pk_mul_f32 v[150:151], v[148:149], v[148:149]
    v_pk_mul_f32 v[154:155], v[152:153], v[152:153]
    v_pk_mul_f32 v[158:159], v[156:157], v[156:157]
    v_pk_fma_f32 v[146:147], v[146:147], v[210:211], v[208:209] op_sel_hi:[1,0,0]
    v_pk_fma_f32 v[150:151], v[150:151], v[210:211], v[208:209] op_sel_hi:[1,0,0]
    v_pk_fma_f32 v[154:155], v[154:155], v[210:211], v[208:209] op_sel_hi:[1,0,0]
    v_pk_fma_f32 v[158:159], v[158:159], v[210:211], v[208:209] op_sel_hi:[1,0,0]
    v_pk_mul_f32 v[146:147], v[146:147], v[144:145]
    v_pk_mul_f32 v[150:151], v[150:151], v[148:149]
    v_pk_mul_f32 v[154:155], v[154:155], v[152:153]
    v_pk_mul_f32 v[158:159], v[158:159], v[156:157]
    v_exp_f32 v146, v146
    v_exp_f32 v147, v147
    v_exp_f32 v150, v150
    v_exp_f32 v151, v151
    v_exp_f32 v154, v154
    v_exp_f32 v155, v155
    v_exp_f32 v158, v158
    v_exp_f32 v159, v159
    v_pk_add_f32 v[146:147], v[146:147], v[212:213] op_sel_hi:[1,0]
    v_pk_add_f32 v[150:151], v[150:151], v[212:213] op_sel_hi:[1,0]
    v_pk_add_f32 v[154:155], v[154:155], v[212:213] op_sel_hi:[1,0]
    v_pk_add_f32 v[158:159], v[158:159], v[212:213] op_sel_hi:[1,0]
    v_rcp_f32 v146, v146
    v_rcp_f32 v147, v147
    v_rcp_f32 v150, v150
    v_rcp_f32 v151, v151
    v_rcp_f32 v154, v154
    v_rcp_f32 v155, v155
    v_rcp_f32 v158, v158
    v_rcp_f32 v159, v159
    v_pk_mul_f32 v[144:145], v[144:145], v[146:147]
    v_pk_mul_f32 v[148:149], v[148:149], v[150:151]
    v_pk_mul_f32 v[152:153], v[152:153], v[154:155]
    v_pk_mul_f32 v[156:157], v[156:157], v[158:159]
    v_cvt_pk_bf16_f32 v216, v144, v145
    v_cvt_pk_bf16_f32 v217, v148, v149
    v_cvt_pk_bf16_f32 v218, v152, v153
    v_cvt_pk_bf16_f32 v219, v156, v157
    buffer_store_dwordx4 v[216:219], v2, s[32:35], s30 offen offset:0 sc1
    v_pk_fma_f32 v[144:145], v[184:185], v[172:173], v[120:121] op_sel_hi:[1,0,1]
    v_pk_fma_f32 v[148:149], v[186:187], v[172:173], v[122:123] op_sel_hi:[1,0,1]
    v_pk_fma_f32 v[152:153], v[188:189], v[172:173], v[124:125] op_sel_hi:[1,0,1]
    v_pk_fma_f32 v[156:157], v[190:191], v[172:173], v[126:127] op_sel_hi:[1,0,1]
    v_pk_mul_f32 v[144:145], v[144:145], v[174:175] op_sel_hi:[1,0]
    v_pk_mul_f32 v[148:149], v[148:149], v[174:175] op_sel_hi:[1,0]
    v_pk_mul_f32 v[152:153], v[152:153], v[174:175] op_sel_hi:[1,0]
    v_pk_mul_f32 v[156:157], v[156:157], v[174:175] op_sel_hi:[1,0]
    v_pk_mul_f32 v[146:147], v[144:145], v[144:145]
    v_pk_mul_f32 v[150:151], v[148:149], v[148:149]
    v_pk_mul_f32 v[154:155], v[152:153], v[152:153]
    v_pk_mul_f32 v[158:159], v[156:157], v[156:157]
    v_pk_fma_f32 v[146:147], v[146:147], v[210:211], v[208:209] op_sel_hi:[1,0,0]
    v_pk_fma_f32 v[150:151], v[150:151], v[210:211], v[208:209] op_sel_hi:[1,0,0]
    v_pk_fma_f32 v[154:155], v[154:155], v[210:211], v[208:209] op_sel_hi:[1,0,0]
    v_pk_fma_f32 v[158:159], v[158:159], v[210:211], v[208:209] op_sel_hi:[1,0,0]
    v_pk_mul_f32 v[146:147], v[146:147], v[144:145]
    v_pk_mul_f32 v[150:151], v[150:151], v[148:149]
    v_pk_mul_f32 v[154:155], v[154:155], v[152:153]
    v_pk_mul_f32 v[158:159], v[158:159], v[156:157]
    v_exp_f32 v146, v146
    v_exp_f32 v147, v147
    v_exp_f32 v150, v150
    v_exp_f32 v151, v151
    v_exp_f32 v154, v154
    v_exp_f32 v155, v155
    v_exp_f32 v158, v158
    v_exp_f32 v159, v159
    v_pk_add_f32 v[146:147], v[146:147], v[212:213] op_sel_hi:[1,0]
    v_pk_add_f32 v[150:151], v[150:151], v[212:213] op_sel_hi:[1,0]
    v_pk_add_f32 v[154:155], v[154:155], v[212:213] op_sel_hi:[1,0]
    v_pk_add_f32 v[158:159], v[158:159], v[212:213] op_sel_hi:[1,0]
    v_rcp_f32 v146, v146
    v_rcp_f32 v147, v147
    v_rcp_f32 v150, v150
    v_rcp_f32 v151, v151
    v_rcp_f32 v154, v154
    v_rcp_f32 v155, v155
    v_rcp_f32 v158, v158
    v_rcp_f32 v159, v159
    v_pk_mul_f32 v[144:145], v[144:145], v[146:147]
    v_pk_mul_f32 v[148:149], v[148:149], v[150:151]
    v_pk_mul_f32 v[152:153], v[152:153], v[154:155]
    v_pk_mul_f32 v[156:157], v[156:157], v[158:159]
    v_cvt_pk_bf16_f32 v220, v144, v145
    v_cvt_pk_bf16_f32 v221, v148, v149
    v_cvt_pk_bf16_f32 v222, v152, v153
    v_cvt_pk_bf16_f32 v223, v156, v157
    buffer_store_dwordx4 v[220:223], v2, s[32:35], s30 offen offset:1024 sc1
    s_waitcnt lgkmcnt(0)
    s_add_u32 s30, s57, 12288
    v_pk_fma_f32 v[144:145], v[192:193], v[172:173], v[128:129] op_sel_hi:[1,0,1]
    v_pk_fma_f32 v[148:149], v[194:195], v[172:173], v[130:131] op_sel_hi:[1,0,1]
    v_pk_fma_f32 v[152:153], v[196:197], v[172:173], v[132:133] op_sel_hi:[1,0,1]
    v_pk_fma_f32 v[156:157], v[198:199], v[172:173], v[134:135] op_sel_hi:[1,0,1]
    v_pk_mul_f32 v[144:145], v[144:145], v[174:175] op_sel_hi:[1,0]
    v_pk_mul_f32 v[148:149], v[148:149], v[174:175] op_sel_hi:[1,0]
    v_pk_mul_f32 v[152:153], v[152:153], v[174:175] op_sel_hi:[1,0]
    v_pk_mul_f32 v[156:157], v[156:157], v[174:175] op_sel_hi:[1,0]
    v_pk_mul_f32 v[146:147], v[144:145], v[144:145]
    v_pk_mul_f32 v[150:151], v[148:149], v[148:149]
    v_pk_mul_f32 v[154:155], v[152:153], v[152:153]
    v_pk_mul_f32 v[158:159], v[156:157], v[156:157]
    v_pk_fma_f32 v[146:147], v[146:147], v[210:211], v[208:209] op_sel_hi:[1,0,0]
    v_pk_fma_f32 v[150:151], v[150:151], v[210:211], v[208:209] op_sel_hi:[1,0,0]
    v_pk_fma_f32 v[154:155], v[154:155], v[210:211], v[208:209] op_sel_hi:[1,0,0]
    v_pk_fma_f32 v[158:159], v[158:159], v[210:211], v[208:209] op_sel_hi:[1,0,0]
    v_pk_mul_f32 v[146:147], v[146:147], v[144:145]
    v_pk_mul_f32 v[150:151], v[150:151], v[148:149]
    v_pk_mul_f32 v[154:155], v[154:155], v[152:153]
    v_pk_mul_f32 v[158:159], v[158:159], v[156:157]
    v_exp_f32 v146, v146
    v_exp_f32 v147, v147
    v_exp_f32 v150, v150
    v_exp_f32 v151, v151
    v_exp_f32 v154, v154
    v_exp_f32 v155, v155
    v_exp_f32 v158, v158
    v_exp_f32 v159, v159
    v_pk_add_f32 v[146:147], v[146:147], v[212:213] op_sel_hi:[1,0]
    v_pk_add_f32 v[150:151], v[150:151], v[212:213] op_sel_hi:[1,0]
    v_pk_add_f32 v[154:155], v[154:155], v[212:213] op_sel_hi:[1,0]
    v_pk_add_f32 v[158:159], v[158:159], v[212:213] op_sel_hi:[1,0]
    v_rcp_f32 v146, v146
    v_rcp_f32 v147, v147
    v_rcp_f32 v150, v150
    v_rcp_f32 v151, v151
    v_rcp_f32 v154, v154
    v_rcp_f32 v155, v155
    v_rcp_f32 v158, v158
    v_rcp_f32 v159, v159
    v_pk_mul_f32 v[144:145], v[144:145], v[146:147]
    v_pk_mul_f32 v[148:149], v[148:149], v[150:151]
    v_pk_mul_f32 v[152:153], v[152:153], v[154:155]
    v_pk_mul_f32 v[156:157], v[156:157], v[158:159]
    v_cvt_pk_bf16_f32 v224, v144, v145
    v_cvt_pk_bf16_f32 v225, v148, v149
    v_cvt_pk_bf16_f32 v226, v152, v153
    v_cvt_pk_bf16_f32 v227, v156, v157
    buffer_store_dwordx4 v[224:227], v2, s[32:35], s30 offen offset:0 sc1
    v_pk_fma_f32 v[144:145], v[200:201], v[172:173], v[136:137] op_sel_hi:[1,0,1]
    v_pk_fma_f32 v[148:149], v[202:203], v[172:173], v[138:139] op_sel_hi:[1,0,1]
    v_pk_fma_f32 v[152:153], v[204:205], v[172:173], v[140:141] op_sel_hi:[1,0,1]
    v_pk_fma_f32 v[156:157], v[206:207], v[172:173], v[142:143] op_sel_hi:[1,0,1]
    v_pk_mul_f32 v[144:145], v[144:145], v[174:175] op_sel_hi:[1,0]
    v_pk_mul_f32 v[148:149], v[148:149], v[174:175] op_sel_hi:[1,0]
    v_pk_mul_f32 v[152:153], v[152:153], v[174:175] op_sel_hi:[1,0]
    v_pk_mul_f32 v[156:157], v[156:157], v[174:175] op_sel_hi:[1,0]
    v_pk_mul_f32 v[146:147], v[144:145], v[144:145]
    v_pk_mul_f32 v[150:151], v[148:149], v[148:149]
    v_pk_mul_f32 v[154:155], v[152:153], v[152:153]
    v_pk_mul_f32 v[158:159], v[156:157], v[156:157]
    v_pk_fma_f32 v[146:147], v[146:147], v[210:211], v[208:209] op_sel_hi:[1,0,0]
    v_pk_fma_f32 v[150:151], v[150:151], v[210:211], v[208:209] op_sel_hi:[1,0,0]
    v_pk_fma_f32 v[154:155], v[154:155], v[210:211], v[208:209] op_sel_hi:[1,0,0]
    v_pk_fma_f32 v[158:159], v[158:159], v[210:211], v[208:209] op_sel_hi:[1,0,0]
    v_pk_mul_f32 v[146:147], v[146:147], v[144:145]
    v_pk_mul_f32 v[150:151], v[150:151], v[148:149]
    v_pk_mul_f32 v[154:155], v[154:155], v[152:153]
    v_pk_mul_f32 v[158:159], v[158:159], v[156:157]
    v_exp_f32 v146, v146
    v_exp_f32 v147, v147
    v_exp_f32 v150, v150
    v_exp_f32 v151, v151
    v_exp_f32 v154, v154
    v_exp_f32 v155, v155
    v_exp_f32 v158, v158
    v_exp_f32 v159, v159
    v_pk_add_f32 v[146:147], v[146:147], v[212:213] op_sel_hi:[1,0]
    v_pk_add_f32 v[150:151], v[150:151], v[212:213] op_sel_hi:[1,0]
    v_pk_add_f32 v[154:155], v[154:155], v[212:213] op_sel_hi:[1,0]
    v_pk_add_f32 v[158:159], v[158:159], v[212:213] op_sel_hi:[1,0]
    v_rcp_f32 v146, v146
    v_rcp_f32 v147, v147
    v_rcp_f32 v150, v150
    v_rcp_f32 v151, v151
    v_rcp_f32 v154, v154
    v_rcp_f32 v155, v155
    v_rcp_f32 v158, v158
    v_rcp_f32 v159, v159
    v_pk_mul_f32 v[144:145], v[144:145], v[146:147]
    v_pk_mul_f32 v[148:149], v[148:149], v[150:151]
    v_pk_mul_f32 v[152:153], v[152:153], v[154:155]
    v_pk_mul_f32 v[156:157], v[156:157], v[158:159]
    v_cvt_pk_bf16_f32 v228, v144, v145
    v_cvt_pk_bf16_f32 v229, v148, v149
    v_cvt_pk_bf16_f32 v230, v152, v153
    v_cvt_pk_bf16_f32 v231, v156, v157
    buffer_store_dwordx4 v[228:231], v2, s[32:35], s30 offen offset:1024 sc1
    v_lshrrev_b32 v20, 5, v1
    v_mul_u32_u24 v20, 4, v20
    v_bfe_u32 v21, v1, 2, 2
    v_add_u32 v20, v20, v21
    v_lshlrev_b32 v20, 7, v20
    v_bfe_u32 v21, v1, 4, 1
    v_lshlrev_b32 v21, 1, v21
    v_bfe_u32 v22, v1, 1, 1
    v_add_u32 v21, v21, v22
    v_bfe_u32 v22, v1, 3, 1
    v_lshlrev_b32 v22, 2, v22
    v_add_u32 v21, v21, v22
    v_lshlrev_b32 v21, 4, v21
    v_add_u32 v20, v20, v21
    v_and_b32 v21, 1, v1
    v_lshlrev_b32 v21, 3, v21
    v_add_u32 v12, v20, v21
    v_xor_b32 v13, 64, v12
    v_mov_b32 v32, 0
    v_mov_b32 v33, 0
    v_mov_b32 v34, 0
    v_mov_b32 v35, 0
    v_mov_b32 v36, 0
    v_mov_b32 v37, 0
    v_mov_b32 v38, 0
    v_mov_b32 v39, 0
    v_mov_b32 v40, 0
    v_mov_b32 v41, 0
    v_mov_b32 v42, 0
    v_mov_b32 v43, 0
    v_mov_b32 v44, 0
    v_mov_b32 v45, 0
    v_mov_b32 v46, 0
    v_mov_b32 v47, 0
    v_mov_b32 v48, 0
    v_mov_b32 v49, 0
    v_mov_b32 v50, 0
    v_mov_b32 v51, 0
    v_mov_b32 v52, 0
    v_mov_b32 v53, 0
    v_mov_b32 v54, 0
    v_mov_b32 v55, 0
    v_mov_b32 v56, 0
    v_mov_b32 v57, 0
    v_mov_b32 v58, 0
    v_mov_b32 v59, 0
    v_mov_b32 v60, 0
    v_mov_b32 v61, 0
    v_mov_b32 v62, 0
    v_mov_b32 v63, 0
    s_mul_i32 s30, s25, 229376
    s_add_u32 s30, s30, 8388608
    s_add_u32 s36, s18, s30
    s_addc_u32 s37, s19, 0
    s_and_b32 s37, s37, 0xffff
    s_mov_b32 s38, 229376
    s_mov_b32 s39, 0x20000
    s_waitcnt vmcnt(4)
    s_cmp_lg_u32 s20, 0
    s_cbranch_scc1 L_w_19
    s_mov_b32 s30, 200000
    s_mov_b32 s31, 26214400
    v_cmp_eq_u32 vcc, s27, v16
    s_nop 0
    s_cmp_eq_u64 vcc, -1
    s_cbranch_scc1 L_pdone_21
L_poll_20:
    buffer_load_dword v16, v11, s[32:35], s31 offen sc1
    s_waitcnt vmcnt(0)
    v_cmp_eq_u32 vcc, s27, v16
    s_nop 0
    s_cmp_eq_u64 vcc, -1
    s_cbranch_scc1 L_pdone_21
    s_sleep 1
    s_sub_u32 s30, s30, 1
    s_cmp_lg_u32 s30, 0
    s_cbranch_scc1 L_poll_20
L_pdone_21:
L_w_19:
    s_barrier
    s_bfe_u32 s49, s64, s72
    s_lshl_b32 s49, s49, 10
    buffer_load_dwordx4 a[0:3], v2, s[36:39], s49 offen offset:0 sc1
    buffer_load_dwordx4 a[4:7], v2, s[36:39], s49 offen offset:1024 sc1
    buffer_load_dwordx4 a[8:11], v2, s[36:39], s49 offen offset:2048 sc1
    buffer_load_dwordx4 a[12:15], v2, s[36:39], s49 offen offset:3072 sc1
    s_bfe_u32 s49, s64, s73
    s_lshl_b32 s49, s49, 10
    buffer_load_dwordx4 a[16:19], v2, s[36:39], s49 offen offset:0 sc1
    buffer_load_dwordx4 a[20:23], v2, s[36:39], s49 offen offset:1024 sc1
    buffer_load_dwordx4 a[24:27], v2, s[36:39], s49 offen offset:2048 sc1
    buffer_load_dwordx4 a[28:31], v2, s[36:39], s49 offen offset:3072 sc1
    s_bfe_u32 s49, s64, s74
    s_lshl_b32 s49, s49, 10
    buffer_load_dwordx4 a[32:35], v2, s[36:39], s49 offen offset:0 sc1
    buffer_load_dwordx4 a[36:39], v2, s[36:39], s49 offen offset:1024 sc1
    buffer_load_dwordx4 a[40:43], v2, s[36:39], s49 offen offset:2048 sc1
    buffer_load_dwordx4 a[44:47], v2, s[36:39], s49 offen offset:3072 sc1
    s_waitcnt vmcnt(12)
    s_barrier
    s_add_u32 s28, s23, 96
    s_lshl_b32 s28, s28, 4
    s_add_u32 s28, s28, s24
    s_lshl_b32 s28, s28, 7
    s_add_u32 s28, s28, 26214400
    v_mov_b32 v20, s27
    buffer_store_dword v20, v234, s[32:35], s28 offen sc1
    v_and_b32 v11, 15, v1
    v_lshlrev_b32 v11, 7, v11
    s_add_u32 s28, s21, 96
    s_lshl_b32 s28, s28, 11
    v_add_u32 v11, s28, v11
    v_lshrrev_b32 v20, 4, v1
    v_lshlrev_b32 v20, 2, v20
    v_add_u32 v11, v11, v20
    v_mov_b32 v20, 0x7ffffff0
    v_cmp_gt_u32 vcc, 64, v0
    s_nop 1
    v_cndmask_b32 v11, v20, v11, vcc
    v_add_u32 v14, 49152, v12
    v_add_u32 v15, 49152, v13
    v_mov_b32 v64, 0
    v_mov_b32 v65, 0
    v_mov_b32 v66, 0
    v_mov_b32 v67, 0
    v_mov_b32 v68, 0
    v_mov_b32 v69, 0
    v_mov_b32 v70, 0
    v_mov_b32 v71, 0
    v_mov_b32 v72, 0
    v_mov_b32 v73, 0
    v_mov_b32 v74, 0
    v_mov_b32 v75, 0
    v_mov_b32 v76, 0
    v_mov_b32 v77, 0
    v_mov_b32 v78, 0
    v_mov_b32 v79, 0
    v_mov_b32 v80, 0
    v_mov_b32 v81, 0
    v_mov_b32 v82, 0
    v_mov_b32 v83, 0
    v_mov_b32 v84, 0
    v_mov_b32 v85, 0
    v_mov_b32 v86, 0
    v_mov_b32 v87, 0
    v_mov_b32 v88, 0
    v_mov_b32 v89, 0
    v_mov_b32 v90, 0
    v_mov_b32 v91, 0
    v_mov_b32 v92, 0
    v_mov_b32 v93, 0
    v_mov_b32 v94, 0
    v_mov_b32 v95, 0
    ds_read_b64_tr_b16 v[96:97], v12 offset:0
    ds_read_b64_tr_b16 v[98:99], v12 offset:1024
    ds_read_b64_tr_b16 v[100:101], v13 offset:0
    ds_read_b64_tr_b16 v[102:103], v13 offset:1024
    ds_read_b64_tr_b16 v[104:105], v12 offset:2048
    ds_read_b64_tr_b16 v[106:107], v12 offset:3072
    ds_read_b64_tr_b16 v[108:109], v13 offset:2048
    ds_read_b64_tr_b16 v[110:111], v13 offset:3072
    s_bfe_u32 s49, s64, s75
    s_lshl_b32 s49, s49, 10
    buffer_load_dwordx4 a[48:51], v2, s[36:39], s49 offen offset:0 sc1
    buffer_load_dwordx4 a[52:55], v2, s[36:39], s49 offen offset:1024 sc1
    buffer_load_dwordx4 a[56:59], v2, s[36:39], s49 offen offset:2048 sc1
    s_add_u32 m0, s81, 40960
    s_bfe_u32 s85, s65, s73
    s_lshl_b32 s85, s85, 15
    s_add_u32 s85, s85, s84
    buffer_load_dwordx4 v8, s[44:47], s85 offen lds
    s_add_u32 m0, s81, 41984
    s_add_u32 s85, s85, 16384
    buffer_load_dwordx4 v8, s[44:47], s85 offen lds
    buffer_load_dwordx4 a[60:63], v2, s[36:39], s49 offen offset:3072 sc1
    s_xor_b32 s87, s22, 1
    s_lshl_b32 s88, s21, 4
    s_add_u32 s88, s88, s87
    s_lshl_b32 s88, s88, 2
    s_add_u32 s88, s88, s20
    s_lshl_b32 s88, s88, 13
    s_add_u32 s88, s88, 29360128
    s_waitcnt vmcnt(44)
    s_barrier
    s_waitcnt vmcnt(18) lgkmcnt(4)
    v_mfma_f32_32x32x16_bf16 v[64:79], v[96:99], a[0:3], v[64:79]
    ds_read_b64_tr_b16 v[96:97], v12 offset:4096
    ds_read_b64_tr_b16 v[98:99], v12 offset:5120
    s_bfe_u32 s49, s65, s72
    s_lshl_b32 s49, s49, 10
    v_mfma_f32_32x32x16_bf16 v[80:95], v[100:103], a[0:3], v[80:95]
    buffer_load_dwordx4 a[64:67], v2, s[36:39], s49 offen offset:0 sc1
    ds_read_b64_tr_b16 v[100:101], v13 offset:4096
    ds_read_b64_tr_b16 v[102:103], v13 offset:5120
    s_waitcnt vmcnt(18) lgkmcnt(4)
    v_mfma_f32_32x32x16_bf16 v[64:79], v[104:107], a[4:7], v[64:79]
    ds_read_b64_tr_b16 v[104:105], v12 offset:6144
    ds_read_b64_tr_b16 v[106:107], v12 offset:7168
    v_mfma_f32_32x32x16_bf16 v[80:95], v[108:111], a[4:7], v[80:95]
    buffer_load_dwordx4 a[68:71], v2, s[36:39], s49 offen offset:1024 sc1
    ds_read_b64_tr_b16 v[108:109], v13 offset:6144
    ds_read_b64_tr_b16 v[110:111], v13 offset:7168
    s_waitcnt vmcnt(18) lgkmcnt(4)
    v_mfma_f32_32x32x16_bf16 v[64:79], v[96:99], a[8:11], v[64:79]
    ds_read_b64_tr_b16 v[96:97], v12 offset:8192
    ds_read_b64_tr_b16 v[98:99], v12 offset:9216
    v_mfma_f32_32x32x16_bf16 v[80:95], v[100:103], a[8:11], v[80:95]
    buffer_load_dwordx4 a[72:75], v2, s[36:39], s49 offen offset:2048 sc1
    ds_read_b64_tr_b16 v[100:101], v13 offset:8192
    ds_read_b64_tr_b16 v[102:103], v13 offset:9216
    s_waitcnt vmcnt(18) lgkmcnt(4)
    v_mfma_f32_32x32x16_bf16 v[64:79], v[104:107], a[12:15], v[64:79]
    ds_read_b64_tr_b16 v[104:105], v12 offset:10240
    ds_read_b64_tr_b16 v[106:107], v12 offset:11264
    v_mfma_f32_32x32x16_bf16 v[80:95], v[108:111], a[12:15], v[80:95]
    buffer_load_dwordx4 a[76:79], v2, s[36:39], s49 offen offset:3072 sc1
    ds_read_b64_tr_b16 v[108:109], v13 offset:10240
    ds_read_b64_tr_b16 v[110:111], v13 offset:11264
    s_waitcnt vmcnt(42)
    s_barrier
    s_waitcnt vmcnt(18) lgkmcnt(4)
    v_mfma_f32_32x32x16_bf16 v[64:79], v[96:99], a[16:19], v[64:79]
    ds_read_b64_tr_b16 v[96:97], v12 offset:12288
    ds_read_b64_tr_b16 v[98:99], v12 offset:13312
    s_add_u32 m0, s81, 0
    s_bfe_u32 s85, s65, s74
    s_lshl_b32 s85, s85, 15
    s_add_u32 s85, s85, s84
    v_mfma_f32_32x32x16_bf16 v[80:95], v[100:103], a[16:19], v[80:95]
    buffer_load_dwordx4 v8, s[44:47], s85 offen lds
    ds_read_b64_tr_b16 v[100:101], v13 offset:12288
    ds_read_b64_tr_b16 v[102:103], v13 offset:13312
    s_add_u32 m0, s81, 1024
    s_add_u32 s85, s85, 16384
    s_waitcnt vmcnt(18) lgkmcnt(4)
    v_mfma_f32_32x32x16_bf16 v[64:79], v[104:107], a[20:23], v[64:79]
    buffer_load_dwordx4 v8, s[44:47], s85 offen lds
    ds_read_b64_tr_b16 v[104:105], v12 offset:14336
    ds_read_b64_tr_b16 v[106:107], v12 offset:15360
    s_bfe_u32 s49, s65, s73
    s_lshl_b32 s49, s49, 10
    v_mfma_f32_32x32x16_bf16 v[80:95], v[108:111], a[20:23], v[80:95]
    buffer_load_dwordx4 a[80:83], v2, s[36:39], s49 offen offset:0 sc1
    ds_read_b64_tr_b16 v[108:109], v13 offset:14336
    ds_read_b64_tr_b16 v[110:111], v13 offset:15360
    s_waitcnt vmcnt(19) lgkmcnt(4)
    v_mfma_f32_32x32x16_bf16 v[64:79], v[96:99], a[24:27], v[64:79]
    ds_read_b64_tr_b16 v[96:97], v12 offset:16384
    ds_read_b64_tr_b16 v[98:99], v12 offset:17408
    v_mfma_f32_32x32x16_bf16 v[80:95], v[100:103], a[24:27], v[80:95]
    buffer_load_dwordx4 a[84:87], v2, s[36:39], s49 offen offset:1024 sc1
    ds_read_b64_tr_b16 v[100:101], v13 offset:16384
    ds_read_b64_tr_b16 v[102:103], v13 offset:17408
    s_waitcnt vmcnt(19) lgkmcnt(4)
    v_mfma_f32_32x32x16_bf16 v[64:79], v[104:107], a[28:31], v[64:79]
    buffer_load_dwordx4 a[88:91], v2, s[36:39], s49 offen offset:2048 sc1
    ds_read_b64_tr_b16 v[104:105], v12 offset:18432
    ds_read_b64_tr_b16 v[106:107], v12 offset:19456
    v_mfma_f32_32x32x16_bf16 v[80:95], v[108:111], a[28:31], v[80:95]
    buffer_load_dwordx4 a[92:95], v2, s[36:39], s49 offen offset:3072 sc1
    ds_read_b64_tr_b16 v[108:109], v13 offset:18432
    ds_read_b64_tr_b16 v[110:111], v13 offset:19456
    s_waitcnt vmcnt(46)
    s_barrier
    s_waitcnt vmcnt(20) lgkmcnt(4)
    v_mfma_f32_32x32x16_bf16 v[64:79], v[96:99], a[32:35], v[64:79]
    ds_read_b64_tr_b16 v[96:97], v12 offset:20480
    ds_read_b64_tr_b16 v[98:99], v12 offset:21504
    s_add_u32 m0, s81, 8192
    s_bfe_u32 s85, s65, s75
    s_lshl_b32 s85, s85, 15
    s_add_u32 s85, s85, s84
    v_mfma_f32_32x32x16_bf16 v[80:95], v[100:103], a[32:35], v[80:95]
    buffer_load_dwordx4 v8, s[44:47], s85 offen lds
    ds_read_b64_tr_b16 v[100:101], v13 offset:20480
    ds_read_b64_tr_b16 v[102:103], v13 offset:21504
    s_add_u32 m0, s81, 9216
    s_add_u32 s85, s85, 16384
    s_waitcnt vmcnt(20) lgkmcnt(4)
    v_mfma_f32_32x32x16_bf16 v[64:79], v[104:107], a[36:39], v[64:79]
    buffer_load_dwordx4 v8, s[44:47], s85 offen lds
    ds_read_b64_tr_b16 v[104:105], v12 offset:22528
    ds_read_b64_tr_b16 v[106:107], v12 offset:23552
    s_bfe_u32 s49, s65, s74
    s_lshl_b32 s49, s49, 10
    v_mfma_f32_32x32x16_bf16 v[80:95], v[108:111], a[36:39], v[80:95]
    buffer_load_dwordx4 a[96:99], v2, s[36:39], s49 offen offset:0 sc1
    ds_read_b64_tr_b16 v[108:109], v13 offset:22528
    ds_read_b64_tr_b16 v[110:111], v13 offset:23552
    s_waitcnt vmcnt(21) lgkmcnt(4)
    v_mfma_f32_32x32x16_bf16 v[64:79], v[96:99], a[40:43], v[64:79]
    ds_read_b64_tr_b16 v[96:97], v12 offset:24576
    ds_read_b64_tr_b16 v[98:99], v12 offset:25600
    v_mfma_f32_32x32x16_bf16 v[80:95], v[100:103], a[40:43], v[80:95]
    buffer_load_dwordx4 a[100:103], v2, s[36:39], s49 offen offset:1024 sc1
    ds_read_b64_tr_b16 v[100:101], v13 offset:24576
    ds_read_b64_tr_b16 v[102:103], v13 offset:25600
    s_waitcnt vmcnt(21) lgkmcnt(4)
    v_mfma_f32_32x32x16_bf16 v[64:79], v[104:107], a[44:47], v[64:79]
    buffer_load_dwordx4 a[104:107], v2, s[36:39], s49 offen offset:2048 sc1
    ds_read_b64_tr_b16 v[104:105], v12 offset:26624
    ds_read_b64_tr_b16 v[106:107], v12 offset:27648
    v_mfma_f32_32x32x16_bf16 v[80:95], v[108:111], a[44:47], v[80:95]
    buffer_load_dwordx4 a[108:111], v2, s[36:39], s49 offen offset:3072 sc1
    ds_read_b64_tr_b16 v[108:109], v13 offset:26624
    ds_read_b64_tr_b16 v[110:111], v13 offset:27648
    s_waitcnt vmcnt(49)
    s_barrier
    s_waitcnt vmcnt(21) lgkmcnt(4)
    v_mfma_f32_32x32x16_bf16 v[64:79], v[96:99], a[48:51], v[64:79]
    ds_read_b64_tr_b16 v[96:97], v12 offset:28672
    ds_read_b64_tr_b16 v[98:99], v12 offset:29696
    s_add_u32 m0, s81, 16384
    s_bfe_u32 s85, s66, s72
    s_lshl_b32 s85, s85, 15
    s_add_u32 s85, s85, s84
    v_mfma_f32_32x32x16_bf16 v[80:95], v[100:103], a[48:51], v[80:95]
    buffer_load_dwordx4 v8, s[44:47], s85 offen lds
    ds_read_b64_tr_b16 v[100:101], v13 offset:28672
    ds_read_b64_tr_b16 v[102:103], v13 offset:29696
    s_add_u32 m0, s81, 17408
    s_add_u32 s85, s85, 16384
    s_waitcnt vmcnt(21) lgkmcnt(4)
    v_mfma_f32_32x32x16_bf16 v[64:79], v[104:107], a[52:55], v[64:79]
    buffer_load_dwordx4 v8, s[44:47], s85 offen lds
    ds_read_b64_tr_b16 v[104:105], v12 offset:30720
    ds_read_b64_tr_b16 v[106:107], v12 offset:31744
    s_bfe_u32 s49, s65, s75
    s_lshl_b32 s49, s49, 10
    v_mfma_f32_32x32x16_bf16 v[80:95], v[108:111], a[52:55], v[80:95]
    buffer_load_dwordx4 a[112:115], v2, s[36:39], s49 offen offset:0 sc1
    ds_read_b64_tr_b16 v[108:109], v13 offset:30720
    ds_read_b64_tr_b16 v[110:111], v13 offset:31744
    s_waitcnt vmcnt(22) lgkmcnt(4)
    v_mfma_f32_32x32x16_bf16 v[64:79], v[96:99], a[56:59], v[64:79]
    ds_read_b64_tr_b16 v[96:97], v12 offset:32768
    ds_read_b64_tr_b16 v[98:99], v12 offset:33792
    v_mfma_f32_32x32x16_bf16 v[80:95], v[100:103], a[56:59], v[80:95]
    buffer_load_dwordx4 a[116:119], v2, s[36:39], s49 offen offset:1024 sc1
    ds_read_b64_tr_b16 v[100:101], v13 offset:32768
    ds_read_b64_tr_b16 v[102:103], v13 offset:33792
    s_waitcnt vmcnt(20) lgkmcnt(4)
    v_mfma_f32_32x32x16_bf16 v[64:79], v[104:107], a[60:63], v[64:79]
    buffer_load_dwordx4 a[120:123], v2, s[36:39], s49 offen offset:2048 sc1
    ds_read_b64_tr_b16 v[104:105], v12 offset:34816
    ds_read_b64_tr_b16 v[106:107], v12 offset:35840
    v_mfma_f32_32x32x16_bf16 v[80:95], v[108:111], a[60:63], v[80:95]
    buffer_load_dwordx4 a[124:127], v2, s[36:39], s49 offen offset:3072 sc1
    ds_read_b64_tr_b16 v[108:109], v13 offset:34816
    ds_read_b64_tr_b16 v[110:111], v13 offset:35840
    s_waitcnt vmcnt(23)
    s_barrier
    s_mov_b32 s31, 26214400
    buffer_load_dword v16, v11, s[32:35], s31 offen sc1
    s_waitcnt vmcnt(22) lgkmcnt(4)
    v_mfma_f32_32x32x16_bf16 v[64:79], v[96:99], a[64:67], v[64:79]
    ds_read_b64_tr_b16 v[96:97], v12 offset:36864
    ds_read_b64_tr_b16 v[98:99], v12 offset:37888
    s_add_u32 m0, s81, 24576
    s_bfe_u32 s85, s66, s73
    s_lshl_b32 s85, s85, 15
    s_add_u32 s85, s85, s84
    v_mfma_f32_32x32x16_bf16 v[80:95], v[100:103], a[64:67], v[80:95]
    buffer_load_dwordx4 v8, s[44:47], s85 offen lds
    ds_read_b64_tr_b16 v[100:101], v13 offset:36864
    ds_read_b64_tr_b16 v[102:103], v13 offset:37888
    s_add_u32 m0, s81, 25600
    s_add_u32 s85, s85, 16384
    s_waitcnt vmcnt(22) lgkmcnt(4)
    v_mfma_f32_32x32x16_bf16 v[64:79], v[104:107], a[68:71], v[64:79]
    buffer_load_dwordx4 v8, s[44:47], s85 offen lds
    ds_read_b64_tr_b16 v[104:105], v12 offset:38912
    ds_read_b64_tr_b16 v[106:107], v12 offset:39936
    v_mfma_f32_32x32x16_bf16 v[80:95], v[108:111], a[68:71], v[80:95]
    ds_read_b64_tr_b16 v[108:109], v13 offset:38912
    ds_read_b64_tr_b16 v[110:111], v13 offset:39936
    s_waitcnt vmcnt(22) lgkmcnt(4)
    v_mfma_f32_32x32x16_bf16 v[64:79], v[96:99], a[72:75], v[64:79]
    ds_read_b64_tr_b16 v[96:97], v12 offset:40960
    ds_read_b64_tr_b16 v[98:99], v12 offset:41984
    s_add_u32 m0, s81, 49152
    s_bfe_u32 s86, s64, s72
    s_lshl_b32 s86, s86, 15
    s_add_u32 s86, s86, s80
    v_mfma_f32_32x32x16_bf16 v[80:95], v[100:103], a[72:75], v[80:95]
    buffer_load_dwordx4 v8, s[44:47], s86 offen lds
    ds_read_b64_tr_b16 v[100:101], v13 offset:40960
    ds_read_b64_tr_b16 v[102:103], v13 offset:41984
    s_add_u32 m0, s81, 50176
    s_add_u32 s86, s86, 16384
    s_waitcnt vmcnt(22) lgkmcnt(4)
    v_mfma_f32_32x32x16_bf16 v[64:79], v[104:107], a[76:79], v[64:79]
    buffer_load_dwordx4 v8, s[44:47], s86 offen lds
    ds_read_b64_tr_b16 v[104:105], v12 offset:43008
    ds_read_b64_tr_b16 v[106:107], v12 offset:44032
    v_mfma_f32_32x32x16_bf16 v[80:95], v[108:111], a[76:79], v[80:95]
    ds_read_b64_tr_b16 v[108:109], v13 offset:43008
    ds_read_b64_tr_b16 v[110:111], v13 offset:44032
    s_waitcnt vmcnt(21)
    s_barrier
    s_waitcnt vmcnt(20) lgkmcnt(4)
    v_mfma_f32_32x32x16_bf16 v[64:79], v[96:99], a[80:83], v[64:79]
    ds_read_b64_tr_b16 v[96:97], v12 offset:45056
    ds_read_b64_tr_b16 v[98:99], v12 offset:46080
    s_add_u32 m0, s81, 32768
    s_bfe_u32 s85, s66, s74
    s_lshl_b32 s85, s85, 15
    s_add_u32 s85, s85, s84
    v_mfma_f32_32x32x16_bf16 v[80:95], v[100:103], a[80:83], v[80:95]
    buffer_load_dwordx4 v8, s[44:47], s85 offen lds
    ds_read_b64_tr_b16 v[100:101], v13 offset:45056
    ds_read_b64_tr_b16 v[102:103], v13 offset:46080
    s_add_u32 m0, s81, 33792
    s_add_u32 s85, s85, 16384
    s_waitcnt vmcnt(20) lgkmcnt(4)
    v_mfma_f32_32x32x16_bf16 v[64:79], v[104:107], a[84:87], v[64:79]
    buffer_load_dwordx4 v8, s[44:47], s85 offen lds
    ds_read_b64_tr_b16 v[104:105], v12 offset:47104
    ds_read_b64_tr_b16 v[106:107], v12 offset:48128
    v_mfma_f32_32x32x16_bf16 v[80:95], v[108:111], a[84:87], v[80:95]
    ds_read_b64_tr_b16 v[108:109], v13 offset:47104
    ds_read_b64_tr_b16 v[110:111], v13 offset:48128
    s_waitcnt vmcnt(20) lgkmcnt(4)
    v_mfma_f32_32x32x16_bf16 v[64:79], v[96:99], a[88:91], v[64:79]
    ds_read_b64_tr_b16 v[96:97], v12 offset:0
    ds_read_b64_tr_b16 v[98:99], v12 offset:1024
    s_add_u32 m0, s81, 57344
    s_bfe_u32 s86, s64, s73
    s_lshl_b32 s86, s86, 15
    s_add_u32 s86, s86, s80
    v_mfma_f32_32x32x16_bf16 v[80:95], v[100:103], a[88:91], v[80:95]
    buffer_load_dwordx4 v8, s[44:47], s86 offen lds
    ds_read_b64_tr_b16 v[100:101], v13 offset:0
    ds_read_b64_tr_b16 v[102:103], v13 offset:1024
    s_add_u32 m0, s81, 58368
    s_add_u32 s86, s86, 16384
    s_waitcnt vmcnt(20) lgkmcnt(4)
    v_mfma_f32_32x32x16_bf16 v[64:79], v[104:107], a[92:95], v[64:79]
    buffer_load_dwordx4 v8, s[44:47], s86 offen lds
    ds_read_b64_tr_b16 v[104:105], v12 offset:2048
    ds_read_b64_tr_b16 v[106:107], v12 offset:3072
    v_mfma_f32_32x32x16_bf16 v[80:95], v[108:111], a[92:95], v[80:95]
    ds_read_b64_tr_b16 v[108:109], v13 offset:2048
    ds_read_b64_tr_b16 v[110:111], v13 offset:3072
    s_waitcnt vmcnt(19)
    s_waitcnt vmcnt(8)
    s_cmp_lg_u32 s20, 0
    s_cbranch_scc1 L_w_22
    s_mov_b32 s30, 200000
    s_mov_b32 s31, 26214400
    v_cmp_eq_u32 vcc, s27, v16
    s_nop 0
    s_cmp_eq_u64 vcc, -1
    s_cbranch_scc1 L_pdone_24
L_poll_23:
    buffer_load_dword v16, v11, s[32:35], s31 offen sc1
    s_waitcnt vmcnt(0)
    v_cmp_eq_u32 vcc, s27, v16
    s_nop 0
    s_cmp_eq_u64 vcc, -1
    s_cbranch_scc1 L_pdone_24
    s_sleep 1
    s_sub_u32 s30, s30, 1
    s_cmp_lg_u32 s30, 0
    s_cbranch_scc1 L_poll_23
L_pdone_24:
L_w_22:
    s_barrier
    s_waitcnt vmcnt(18) lgkmcnt(4)
    v_mfma_f32_32x32x16_bf16 v[64:79], v[96:99], a[96:99], v[64:79]
    ds_read_b64_tr_b16 v[96:97], v12 offset:4096
    ds_read_b64_tr_b16 v[98:99], v12 offset:5120
    s_bfe_u32 s49, s66, s72
    s_lshl_b32 s49, s49, 10
    v_mfma_f32_32x32x16_bf16 v[80:95], v[100:103], a[96:99], v[80:95]
    buffer_load_dwordx4 a[128:131], v2, s[36:39], s49 offen offset:0 sc1
    ds_read_b64_tr_b16 v[100:101], v13 offset:4096
    ds_read_b64_tr_b16 v[102:103], v13 offset:5120
    s_waitcnt vmcnt(18) lgkmcnt(4)
    v_mfma_f32_32x32x16_bf16 v[64:79], v[104:107], a[100:103], v[64:79]
    buffer_load_dwordx4 a[132:135], v2, s[36:39], s49 offen offset:1024 sc1
    ds_read_b64_tr_b16 v[104:105], v12 offset:6144
    ds_read_b64_tr_b16 v[106:107], v12 offset:7168
    v_mfma_f32_32x32x16_bf16 v[80:95], v[108:111], a[100:103], v[80:95]
    buffer_load_dwordx4 a[136:139], v2, s[36:39], s49 offen offset:2048 sc1
    ds_read_b64_tr_b16 v[108:109], v13 offset:6144
    ds_read_b64_tr_b16 v[110:111], v13 offset:7168
    s_waitcnt vmcnt(19) lgkmcnt(4)
    v_mfma_f32_32x32x16_bf16 v[64:79], v[96:99], a[104:107], v[64:79]
    ds_read_b64_tr_b16 v[96:97], v12 offset:8192
    ds_read_b64_tr_b16 v[98:99], v12 offset:9216
    v_mfma_f32_32x32x16_bf16 v[80:95], v[100:103], a[104:107], v[80:95]
    buffer_load_dwordx4 a[140:143], v2, s[36:39], s49 offen offset:3072 sc1
    ds_read_b64_tr_b16 v[100:101], v13 offset:8192
    ds_read_b64_tr_b16 v[102:103], v13 offset:9216
    s_bfe_u32 s49, s66, s73
    s_lshl_b32 s49, s49, 10
    s_waitcnt vmcnt(19) lgkmcnt(4)
    v_mfma_f32_32x32x16_bf16 v[64:79], v[104:107], a[108:111], v[64:79]
    buffer_load_dwordx4 a[144:147], v2, s[36:39], s49 offen offset:0 sc1
    ds_read_b64_tr_b16 v[104:105], v12 offset:10240
    ds_read_b64_tr_b16 v[106:107], v12 offset:11264
    v_mfma_f32_32x32x16_bf16 v[80:95], v[108:111], a[108:111], v[80:95]
    buffer_load_dwordx4 a[148:151], v2, s[36:39], s49 offen offset:1024 sc1
    ds_read_b64_tr_b16 v[108:109], v13 offset:10240
    ds_read_b64_tr_b16 v[110:111], v13 offset:11264
    s_waitcnt vmcnt(19)
    s_barrier
    s_waitcnt vmcnt(18) lgkmcnt(4)
    v_mfma_f32_32x32x16_bf16 v[64:79], v[96:99], a[112:115], v[64:79]
    ds_read_b64_tr_b16 v[96:97], v12 offset:12288
    ds_read_b64_tr_b16 v[98:99], v12 offset:13312
    v_mfma_f32_32x32x16_bf16 v[80:95], v[100:103], a[112:115], v[80:95]
    buffer_load_dwordx4 a[152:155], v2, s[36:39], s49 offen offset:2048 sc1
    ds_read_b64_tr_b16 v[100:101], v13 offset:12288
    ds_read_b64_tr_b16 v[102:103], v13 offset:13312
    s_add_u32 m0, s81, 40960
    s_bfe_u32 s85, s66, s75
    s_lshl_b32 s85, s85, 15
    s_add_u32 s85, s85, s84
    s_waitcnt vmcnt(18) lgkmcnt(4)
    v_mfma_f32_32x32x16_bf16 v[64:79], v[104:107], a[116:119], v[64:79]
    buffer_load_dwordx4 v8, s[44:47], s85 offen lds
    ds_read_b64_tr_b16 v[104:105], v12 offset:14336
    ds_read_b64_tr_b16 v[106:107], v12 offset:15360
    s_add_u32 m0, s81, 41984
    s_add_u32 s85, s85, 16384
    v_mfma_f32_32x32x16_bf16 v[80:95], v[108:111], a[116:119], v[80:95]
    buffer_load_dwordx4 v8, s[44:47], s85 offen lds
    ds_read_b64_tr_b16 v[108:109], v13 offset:14336
    ds_read_b64_tr_b16 v[110:111], v13 offset:15360
    s_waitcnt vmcnt(19) lgkmcnt(4)
    v_mfma_f32_32x32x16_bf16 v[64:79], v[96:99], a[120:123], v[64:79]
    ds_read_b64_tr_b16 v[96:97], v12 offset:16384
    ds_read_b64_tr_b16 v[98:99], v12 offset:17408
    v_mfma_f32_32x32x16_bf16 v[80:95], v[100:103], a[120:123], v[80:95]
    buffer_load_dwordx4 a[156:159], v2, s[36:39], s49 offen offset:3072 sc1
    ds_read_b64_tr_b16 v[100:101], v13 offset:16384
    ds_read_b64_tr_b16 v[102:103], v13 offset:17408
    s_bfe_u32 s49, s66, s74
    s_lshl_b32 s49, s49, 10
    s_waitcnt vmcnt(19) lgkmcnt(4)
    v_mfma_f32_32x32x16_bf16 v[64:79], v[104:107], a[124:127], v[64:79]
    buffer_load_dwordx4 a[160:163], v2, s[36:39], s49 offen offset:0 sc1
    ds_read_b64_tr_b16 v[104:105], v12 offset:18432
    ds_read_b64_tr_b16 v[106:107], v12 offset:19456
    v_mfma_f32_32x32x16_bf16 v[80:95], v[108:111], a[124:127], v[80:95]
    buffer_load_dwordx4 a[164:167], v2, s[36:39], s49 offen offset:1024 sc1
    ds_read_b64_tr_b16 v[108:109], v13 offset:18432
    ds_read_b64_tr_b16 v[110:111], v13 offset:19456
    s_waitcnt vmcnt(18)
    s_barrier
    s_waitcnt vmcnt(11) lgkmcnt(4)
    v_mfma_f32_32x32x16_bf16 v[64:79], v[96:99], a[128:131], v[64:79]
    ds_read_b64_tr_b16 v[96:97], v12 offset:20480
    ds_read_b64_tr_b16 v[98:99], v12 offset:21504
    v_mfma_f32_32x32x16_bf16 v[80:95], v[100:103], a[128:131], v[80:95]
    buffer_load_dwordx4 a[168:171], v2, s[36:39], s49 offen offset:2048 sc1
    ds_read_b64_tr_b16 v[100:101], v13 offset:20480
    ds_read_b64_tr_b16 v[102:103], v13 offset:21504
    s_add_u32 m0, s81, 0
    s_bfe_u32 s85, s67, s72
    s_lshl_b32 s85, s85, 15
    s_add_u32 s85, s85, s84
    s_waitcnt vmcnt(11) lgkmcnt(4)
    v_mfma_f32_32x32x16_bf16 v[64:79], v[104:107], a[132:135], v[64:79]
    buffer_load_dwordx4 v8, s[44:47], s85 offen lds
    ds_read_b64_tr_b16 v[104:105], v12 offset:22528
    ds_read_b64_tr_b16 v[106:107], v12 offset:23552
    s_add_u32 m0, s81, 1024
    s_add_u32 s85, s85, 16384
    v_mfma_f32_32x32x16_bf16 v[80:95], v[108:111], a[132:135], v[80:95]
    buffer_load_dwordx4 v8, s[44:47], s85 offen lds
    ds_read_b64_tr_b16 v[108:109], v13 offset:22528
    ds_read_b64_tr_b16 v[110:111], v13 offset:23552
    s_waitcnt vmcnt(12) lgkmcnt(4)
    v_mfma_f32_32x32x16_bf16 v[64:79], v[96:99], a[136:139], v[64:79]
    ds_read_b64_tr_b16 v[96:97], v12 offset:24576
    ds_read_b64_tr_b16 v[98:99], v12 offset:25600
    s_add_u32 m0, s81, 65536
    s_bfe_u32 s86, s64, s74
    s_lshl_b32 s86, s86, 15
    s_add_u32 s86, s86, s80
    v_mfma_f32_32x32x16_bf16 v[80:95], v[100:103], a[136:139], v[80:95]
    buffer_load_dwordx4 v8, s[44:47], s86 offen lds
    ds_read_b64_tr_b16 v[100:101], v13 offset:24576
    ds_read_b64_tr_b16 v[102:103], v13 offset:25600
    s_add_u32 m0, s81, 66560
    s_add_u32 s86, s86, 16384
    s_waitcnt vmcnt(12) lgkmcnt(4)
    v_mfma_f32_32x32x16_bf16 v[64:79], v[104:107], a[140:143], v[64:79]
    buffer_load_dwordx4 v8, s[44:47], s86 offen lds
    ds_read_b64_tr_b16 v[104:105], v12 offset:26624
    ds_read_b64_tr_b16 v[106:107], v12 offset:27648
    v_mfma_f32_32x32x16_bf16 v[80:95], v[108:111], a[140:143], v[80:95]
    buffer_load_dwordx4 a[172:175], v2, s[36:39], s49 offen offset:3072 sc1
    ds_read_b64_tr_b16 v[108:109], v13 offset:26624
    ds_read_b64_tr_b16 v[110:111], v13 offset:27648
    s_waitcnt vmcnt(20)
    s_waitcnt vmcnt(22)
    s_barrier
    s_waitcnt vmcnt(13) lgkmcnt(4)
    v_mfma_f32_32x32x16_bf16 v[64:79], v[96:99], a[144:147], v[64:79]
    ds_read_b64_tr_b16 v[96:97], v12 offset:28672
    ds_read_b64_tr_b16 v[98:99], v12 offset:29696
    s_bfe_u32 s49, s66, s75
    s_lshl_b32 s49, s49, 10
    v_mfma_f32_32x32x16_bf16 v[80:95], v[100:103], a[144:147], v[80:95]
    buffer_load_dwordx4 a[176:179], v2, s[36:39], s49 offen offset:0 sc1
    ds_read_b64_tr_b16 v[100:101], v13 offset:28672
    ds_read_b64_tr_b16 v[102:103], v13 offset:29696
    s_waitcnt vmcnt(13) lgkmcnt(4)
    v_mfma_f32_32x32x16_bf16 v[64:79], v[104:107], a[148:151], v[64:79]
    buffer_load_dwordx4 a[180:183], v2, s[36:39], s49 offen offset:1024 sc1
    ds_read_b64_tr_b16 v[104:105], v12 offset:30720
    ds_read_b64_tr_b16 v[106:107], v12 offset:31744
    v_mfma_f32_32x32x16_bf16 v[80:95], v[108:111], a[148:151], v[80:95]
    buffer_load_dwordx4 a[184:187], v2, s[36:39], s49 offen offset:2048 sc1
    ds_read_b64_tr_b16 v[108:109], v13 offset:30720
    ds_read_b64_tr_b16 v[110:111], v13 offset:31744
    s_waitcnt vmcnt(14) lgkmcnt(4)
    v_mfma_f32_32x32x16_bf16 v[64:79], v[96:99], a[152:155], v[64:79]
    ds_read_b64_tr_b16 v[96:97], v12 offset:32768
    ds_read_b64_tr_b16 v[98:99], v12 offset:33792
    ds_read_b64_tr_b16 v[112:113], v14 offset:0
    ds_read_b64_tr_b16 v[114:115], v14 offset:1024
    s_add_u32 m0, s81, 8192
    s_bfe_u32 s85, s67, s73
    s_lshl_b32 s85, s85, 15
    s_add_u32 s85, s85, s84
    v_mfma_f32_32x32x16_bf16 v[80:95], v[100:103], a[152:155], v[80:95]
    buffer_load_dwordx4 v8, s[44:47], s85 offen lds
    ds_read_b64_tr_b16 v[100:101], v13 offset:32768
    ds_read_b64_tr_b16 v[102:103], v13 offset:33792
    ds_read_b64_tr_b16 v[116:117], v15 offset:0
    ds_read_b64_tr_b16 v[118:119], v15 offset:1024
    s_add_u32 m0, s81, 9216
    s_add_u32 s85, s85, 16384
    s_waitcnt vmcnt(12) lgkmcnt(8)
    v_mfma_f32_32x32x16_bf16 v[64:79], v[104:107], a[156:159], v[64:79]
    buffer_load_dwordx4 v8, s[44:47], s85 offen lds
    ds_read_b64_tr_b16 v[104:105], v12 offset:34816
    ds_read_b64_tr_b16 v[106:107], v12 offset:35840
    ds_read_b64_tr_b16 v[120:121], v14 offset:2048
    ds_read_b64_tr_b16 v[122:123], v14 offset:3072
    s_add_u32 m0, s81, 73728
    s_bfe_u32 s86, s64, s75
    s_lshl_b32 s86, s86, 15
    s_add_u32 s86, s86, s80
    v_mfma_f32_32x32x16_bf16 v[80:95], v[108:111], a[156:159], v[80:95]
    buffer_load_dwordx4 v8, s[44:47], s86 offen lds
    ds_read_b64_tr_b16 v[108:109], v13 offset:34816
    ds_read_b64_tr_b16 v[110:111], v13 offset:35840
    ds_read_b64_tr_b16 v[124:125], v15 offset:2048
    ds_read_b64_tr_b16 v[126:127], v15 offset:3072
    s_waitcnt vmcnt(15)
    s_waitcnt vmcnt(24)
    s_barrier
    s_waitcnt vmcnt(13) lgkmcnt(10)
    v_mfma_f32_32x32x16_bf16 v[64:79], v[96:99], a[160:163], v[64:79]
    ds_read_b64_tr_b16 v[96:97], v12 offset:36864
    ds_read_b64_tr_b16 v[98:99], v12 offset:37888
    s_add_u32 m0, s81, 74752
    s_add_u32 s86, s86, 16384
    v_mfma_f32_32x32x16_bf16 v[80:95], v[100:103], a[160:163], v[80:95]
    buffer_load_dwordx4 v8, s[44:47], s86 offen lds
    ds_read_b64_tr_b16 v[100:101], v13 offset:36864
    ds_read_b64_tr_b16 v[102:103], v13 offset:37888
    s_waitcnt lgkmcnt(12)
    v_mfma_f32_32x32x16_bf16 v[32:47], v[112:115], a[0:3], v[32:47]
    ds_read_b64_tr_b16 v[112:113], v14 offset:4096
    ds_read_b64_tr_b16 v[114:115], v14 offset:5120
    v_mfma_f32_32x32x16_bf16 v[48:63], v[116:119], a[0:3], v[48:63]
    buffer_load_dwordx4 a[188:191], v2, s[36:39], s49 offen offset:3072 sc1
    ds_read_b64_tr_b16 v[116:117], v15 offset:4096
    ds_read_b64_tr_b16 v[118:119], v15 offset:5120
    s_waitcnt vmcnt(14) lgkmcnt(10)
    v_mfma_f32_32x32x16_bf16 v[64:79], v[104:107], a[164:167], v[64:79]
    ds_read_b64_tr_b16 v[104:105], v12 offset:38912
    ds_read_b64_tr_b16 v[106:107], v12 offset:39936
    s_bfe_u32 s49, s67, s72
    s_lshl_b32 s49, s49, 10
    v_mfma_f32_32x32x16_bf16 v[80:95], v[108:111], a[164:167], v[80:95]
    buffer_load_dwordx4 a[192:195], v2, s[36:39], s49 offen offset:0 sc1
    ds_read_b64_tr_b16 v[108:109], v13 offset:38912
    ds_read_b64_tr_b16 v[110:111], v13 offset:39936
    s_waitcnt lgkmcnt(12)
    v_mfma_f32_32x32x16_bf16 v[32:47], v[120:123], a[4:7], v[32:47]
    ds_read_b64_tr_b16 v[120:121], v14 offset:6144
    ds_read_b64_tr_b16 v[122:123], v14 offset:7168
    v_mfma_f32_32x32x16_bf16 v[48:63], v[124:127], a[4:7], v[48:63]
    buffer_load_dwordx4 a[196:199], v2, s[36:39], s49 offen offset:1024 sc1
    ds_read_b64_tr_b16 v[124:125], v15 offset:6144
    ds_read_b64_tr_b16 v[126:127], v15 offset:7168
    s_waitcnt vmcnt(15) lgkmcnt(12)
    v_mfma_f32_32x32x16_bf16 v[64:79], v[96:99], a[168:171], v[64:79]
    ds_read_b64_tr_b16 v[96:97], v12 offset:40960
    ds_read_b64_tr_b16 v[98:99], v12 offset:41984
    v_mfma_f32_32x32x16_bf16 v[80:95], v[100:103], a[168:171], v[80:95]
    buffer_load_dwordx4 a[200:203], v2, s[36:39], s49 offen offset:2048 sc1
    ds_read_b64_tr_b16 v[100:101], v13 offset:40960
    ds_read_b64_tr_b16 v[102:103], v13 offset:41984
    s_waitcnt lgkmcnt(12)
    v_mfma_f32_32x32x16_bf16 v[32:47], v[112:115], a[8:11], v[32:47]
    ds_read_b64_tr_b16 v[112:113], v14 offset:8192
    ds_read_b64_tr_b16 v[114:115], v14 offset:9216
    s_add_u32 m0, s81, 16384
    s_bfe_u32 s85, s67, s74
    s_lshl_b32 s85, s85, 15
    s_add_u32 s85, s85, s84
    v_mfma_f32_32x32x16_bf16 v[48:63], v[116:119], a[8:11], v[48:63]
    buffer_load_dwordx4 v8, s[44:47], s85 offen lds
    ds_read_b64_tr_b16 v[116:117], v15 offset:8192
    ds_read_b64_tr_b16 v[118:119], v15 offset:9216
    s_waitcnt vmcnt(12) lgkmcnt(12)
    v_mfma_f32_32x32x16_bf16 v[64:79], v[104:107], a[172:175], v[64:79]
    ds_read_b64_tr_b16 v[104:105], v12 offset:43008
    ds_read_b64_tr_b16 v[106:107], v12 offset:44032
    s_add_u32 m0, s81, 17408
    s_add_u32 s85, s85, 16384
    v_mfma_f32_32x32x16_bf16 v[80:95], v[108:111], a[172:175], v[80:95]
    buffer_load_dwordx4 v8, s[44:47], s85 offen lds
    ds_read_b64_tr_b16 v[108:109], v13 offset:43008
    ds_read_b64_tr_b16 v[110:111], v13 offset:44032
    s_waitcnt lgkmcnt(12)
    v_mfma_f32_32x32x16_bf16 v[32:47], v[120:123], a[12:15], v[32:47]
    ds_read_b64_tr_b16 v[120:121], v14 offset:10240
    ds_read_b64_tr_b16 v[122:123], v14 offset:11264
    s_add_u32 m0, s81, 81920
    s_bfe_u32 s86, s65, s72
    s_lshl_b32 s86, s86, 15
    s_add_u32 s86, s86, s80
    v_mfma_f32_32x32x16_bf16 v[48:63], v[124:127], a[12:15], v[48:63]
    buffer_load_dwordx4 v8, s[44:47], s86 offen lds
    ds_read_b64_tr_b16 v[124:125], v15 offset:10240
    ds_read_b64_tr_b16 v[126:127], v15 offset:11264
    s_waitcnt vmcnt(17)
    s_waitcnt vmcnt(15)
    s_barrier
    s_waitcnt vmcnt(13) lgkmcnt(12)
    v_mfma_f32_32x32x16_bf16 v[64:79], v[96:99], a[176:179], v[64:79]
    ds_read_b64_tr_b16 v[96:97], v12 offset:45056
    ds_read_b64_tr_b16 v[98:99], v12 offset:46080
    s_add_u32 m0, s81, 82944
    s_add_u32 s86, s86, 16384
    v_mfma_f32_32x32x16_bf16 v[80:95], v[100:103], a[176:179], v[80:95]
    buffer_load_dwordx4 v8, s[44:47], s86 offen lds
    ds_read_b64_tr_b16 v[100:101], v13 offset:45056
    ds_read_b64_tr_b16 v[102:103], v13 offset:46080
    s_waitcnt lgkmcnt(12)
    v_mfma_f32_32x32x16_bf16 v[32:47], v[112:115], a[16:19], v[32:47]
    ds_read_b64_tr_b16 v[112:113], v14 offset:12288
    ds_read_b64_tr_b16 v[114:115], v14 offset:13312
    v_mfma_f32_32x32x16_bf16 v[48:63], v[116:119], a[16:19], v[48:63]
    buffer_load_dwordx4 a[204:207], v2, s[36:39], s49 offen offset:3072 sc1
    ds_read_b64_tr_b16 v[116:117], v15 offset:12288
    ds_read_b64_tr_b16 v[118:119], v15 offset:13312
    s_waitcnt vmcnt(14) lgkmcnt(12)
    v_mfma_f32_32x32x16_bf16 v[64:79], v[104:107], a[180:183], v[64:79]
    ds_read_b64_tr_b16 v[104:105], v12 offset:47104
    ds_read_b64_tr_b16 v[106:107], v12 offset:48128
    s_bfe_u32 s49, s67, s73
    s_lshl_b32 s49, s49, 10
    v_mfma_f32_32x32x16_bf16 v[80:95], v[108:111], a[180:183], v[80:95]
    buffer_load_dwordx4 a[208:211], v2, s[36:39], s49 offen offset:0 sc1
    ds_read_b64_tr_b16 v[108:109], v13 offset:47104
    ds_read_b64_tr_b16 v[110:111], v13 offset:48128
    s_waitcnt lgkmcnt(12)
    v_mfma_f32_32x32x16_bf16 v[32:47], v[120:123], a[20:23], v[32:47]
    ds_read_b64_tr_b16 v[120:121], v14 offset:14336
    ds_read_b64_tr_b16 v[122:123], v14 offset:15360
    v_mfma_f32_32x32x16_bf16 v[48:63], v[124:127], a[20:23], v[48:63]
    buffer_load_dwordx4 a[212:215], v2, s[36:39], s49 offen offset:1024 sc1
    ds_read_b64_tr_b16 v[124:125], v15 offset:14336
    ds_read_b64_tr_b16 v[126:127], v15 offset:15360
    s_waitcnt vmcnt(15) lgkmcnt(12)
    v_mfma_f32_32x32x16_bf16 v[64:79], v[96:99], a[184:187], v[64:79]
    ds_read_b64_tr_b16 v[96:97], v12 offset:0
    ds_read_b64_tr_b16 v[98:99], v12 offset:1024
    v_mfma_f32_32x32x16_bf16 v[80:95], v[100:103], a[184:187], v[80:95]
    buffer_load_dwordx4 a[216:219], v2, s[36:39], s49 offen offset:2048 sc1
    ds_read_b64_tr_b16 v[100:101], v13 offset:0
    ds_read_b64_tr_b16 v[102:103], v13 offset:1024
    s_waitcnt lgkmcnt(12)
    v_mfma_f32_32x32x16_bf16 v[32:47], v[112:115], a[24:27], v[32:47]
    ds_read_b64_tr_b16 v[112:113], v14 offset:16384
    ds_read_b64_tr_b16 v[114:115], v14 offset:17408
    s_add_u32 m0, s81, 24576
    s_bfe_u32 s85, s67, s75
    s_lshl_b32 s85, s85, 15
    s_add_u32 s85, s85, s84
    v_mfma_f32_32x32x16_bf16 v[48:63], v[116:119], a[24:27], v[48:63]
    buffer_load_dwordx4 v8, s[44:47], s85 offen lds
    ds_read_b64_tr_b16 v[116:117], v15 offset:16384
    ds_read_b64_tr_b16 v[118:119], v15 offset:17408
    s_waitcnt vmcnt(12) lgkmcnt(12)
    v_mfma_f32_32x32x16_bf16 v[64:79], v[104:107], a[188:191], v[64:79]
    ds_read_b64_tr_b16 v[104:105], v12 offset:2048
    ds_read_b64_tr_b16 v[106:107], v12 offset:3072
    s_add_u32 m0, s81, 25600
    s_add_u32 s85, s85, 16384
    v_mfma_f32_32x32x16_bf16 v[80:95], v[108:111], a[188:191], v[80:95]
    buffer_load_dwordx4 v8, s[44:47], s85 offen lds
    ds_read_b64_tr_b16 v[108:109], v13 offset:2048
    ds_read_b64_tr_b16 v[110:111], v13 offset:3072
    s_waitcnt lgkmcnt(12)
    v_mfma_f32_32x32x16_bf16 v[32:47], v[120:123], a[28:31], v[32:47]
    ds_read_b64_tr_b16 v[120:121], v14 offset:18432
    ds_read_b64_tr_b16 v[122:123], v14 offset:19456
    s_add_u32 m0, s81, 90112
    s_bfe_u32 s86, s65, s73
    s_lshl_b32 s86, s86, 15
    s_add_u32 s86, s86, s80
    v_mfma_f32_32x32x16_bf16 v[48:63], v[124:127], a[28:31], v[48:63]
    buffer_load_dwordx4 v8, s[44:47], s86 offen lds
    ds_read_b64_tr_b16 v[124:125], v15 offset:18432
    ds_read_b64_tr_b16 v[126:127], v15 offset:19456
    s_waitcnt vmcnt(17)
    s_waitcnt vmcnt(15)
    s_barrier
    s_waitcnt vmcnt(13) lgkmcnt(12)
    v_mfma_f32_32x32x16_bf16 v[64:79], v[96:99], a[192:195], v[64:79]
    ds_read_b64_tr_b16 v[96:97], v12 offset:4096
    ds_read_b64_tr_b16 v[98:99], v12 offset:5120
    s_add_u32 m0, s81, 91136
    s_add_u32 s86, s86, 16384
    v_mfma_f32_32x32x16_bf16 v[80:95], v[100:103], a[192:195], v[80:95]
    buffer_load_dwordx4 v8, s[44:47], s86 offen lds
    ds_read_b64_tr_b16 v[100:101], v13 offset:4096
    ds_read_b64_tr_b16 v[102:103], v13 offset:5120
    s_waitcnt lgkmcnt(12)
    v_mfma_f32_32x32x16_bf16 v[32:47], v[112:115], a[32:35], v[32:47]
    ds_read_b64_tr_b16 v[112:113], v14 offset:20480
    ds_read_b64_tr_b16 v[114:115], v14 offset:21504
    v_mfma_f32_32x32x16_bf16 v[48:63], v[116:119], a[32:35], v[48:63]
    buffer_load_dwordx4 a[220:223], v2, s[36:39], s49 offen offset:3072 sc1
    ds_read_b64_tr_b16 v[116:117], v15 offset:20480
    ds_read_b64_tr_b16 v[118:119], v15 offset:21504
    s_waitcnt vmcnt(14) lgkmcnt(12)
    v_mfma_f32_32x32x16_bf16 v[64:79], v[104:107], a[196:199], v[64:79]
    ds_read_b64_tr_b16 v[104:105], v12 offset:6144
    ds_read_b64_tr_b16 v[106:107], v12 offset:7168
    s_bfe_u32 s49, s67, s74
    s_lshl_b32 s49, s49, 10
    v_mfma_f32_32x32x16_bf16 v[80:95], v[108:111], a[196:199], v[80:95]
    buffer_load_dwordx4 a[0:3], v2, s[36:39], s49 offen offset:0 sc1
    ds_read_b64_tr_b16 v[108:109], v13 offset:6144
    ds_read_b64_tr_b16 v[110:111], v13 offset:7168
    s_waitcnt lgkmcnt(12)
    v_mfma_f32_32x32x16_bf16 v[32:47], v[120:123], a[36:39], v[32:47]
    ds_read_b64_tr_b16 v[120:121], v14 offset:22528
    ds_read_b64_tr_b16 v[122:123], v14 offset:23552
    v_mfma_f32_32x32x16_bf16 v[48:63], v[124:127], a[36:39], v[48:63]
    buffer_load_dwordx4 a[4:7], v2, s[36:39], s49 offen offset:1024 sc1
    ds_read_b64_tr_b16 v[124:125], v15 offset:22528
    ds_read_b64_tr_b16 v[126:127], v15 offset:23552
    s_waitcnt vmcnt(15) lgkmcnt(12)
    v_mfma_f32_32x32x16_bf16 v[64:79], v[96:99], a[200:203], v[64:79]
    ds_read_b64_tr_b16 v[96:97], v12 offset:8192
    ds_read_b64_tr_b16 v[98:99], v12 offset:9216
    v_mfma_f32_32x32x16_bf16 v[80:95], v[100:103], a[200:203], v[80:95]
    buffer_load_dwordx4 a[8:11], v2, s[36:39], s49 offen offset:2048 sc1
    ds_read_b64_tr_b16 v[100:101], v13 offset:8192
    ds_read_b64_tr_b16 v[102:103], v13 offset:9216
    s_waitcnt lgkmcnt(12)
    v_mfma_f32_32x32x16_bf16 v[32:47], v[112:115], a[40:43], v[32:47]
    ds_read_b64_tr_b16 v[112:113], v14 offset:24576
    ds_read_b64_tr_b16 v[114:115], v14 offset:25600
    s_add_u32 m0, s81, 32768
    s_bfe_u32 s85, s68, s72
    s_lshl_b32 s85, s85, 15
    s_add_u32 s85, s85, s84
    v_mfma_f32_32x32x16_bf16 v[48:63], v[116:119], a[40:43], v[48:63]
    buffer_load_dwordx4 v8, s[44:47], s85 offen lds
    ds_read_b64_tr_b16 v[116:117], v15 offset:24576
    ds_read_b64_tr_b16 v[118:119], v15 offset:25600
    s_waitcnt vmcnt(12) lgkmcnt(12)
    v_mfma_f32_32x32x16_bf16 v[64:79], v[104:107], a[204:207], v[64:79]
    ds_read_b64_tr_b16 v[104:105], v12 offset:10240
    ds_read_b64_tr_b16 v[106:107], v12 offset:11264
    s_add_u32 m0, s81, 33792
    s_add_u32 s85, s85, 16384
    v_mfma_f32_32x32x16_bf16 v[80:95], v[108:111], a[204:207], v[80:95]
    buffer_load_dwordx4 v8, s[44:47], s85 offen lds
    ds_read_b64_tr_b16 v[108:109], v13 offset:10240
    ds_read_b64_tr_b16 v[110:111], v13 offset:11264
    s_waitcnt lgkmcnt(12)
    v_mfma_f32_32x32x16_bf16 v[32:47], v[120:123], a[44:47], v[32:47]
    ds_read_b64_tr_b16 v[120:121], v14 offset:26624
    ds_read_b64_tr_b16 v[122:123], v14 offset:27648
    s_add_u32 m0, s81, 49152
    s_bfe_u32 s86, s65, s74
    s_lshl_b32 s86, s86, 15
    s_add_u32 s86, s86, s80
    v_mfma_f32_32x32x16_bf16 v[48:63], v[124:127], a[44:47], v[48:63]
    buffer_load_dwordx4 v8, s[44:47], s86 offen lds
    ds_read_b64_tr_b16 v[124:125], v15 offset:26624
    ds_read_b64_tr_b16 v[126:127], v15 offset:27648
    s_waitcnt vmcnt(17)
    s_waitcnt vmcnt(15)
    s_barrier
    s_waitcnt vmcnt(13) lgkmcnt(12)
    v_mfma_f32_32x32x16_bf16 v[64:79], v[96:99], a[208:211], v[64:79]
    ds_read_b64_tr_b16 v[96:97], v12 offset:12288
    ds_read_b64_tr_b16 v[98:99], v12 offset:13312
    s_add_u32 m0, s81, 50176
    s_add_u32 s86, s86, 16384
    v_mfma_f32_32x32x16_bf16 v[80:95], v[100:103], a[208:211], v[80:95]
    buffer_load_dwordx4 v8, s[44:47], s86 offen lds
    ds_read_b64_tr_b16 v[100:101], v13 offset:12288
    ds_read_b64_tr_b16 v[102:103], v13 offset:13312
    s_waitcnt lgkmcnt(12)
    v_mfma_f32_32x32x16_bf16 v[32:47], v[112:115], a[48:51], v[32:47]
    ds_read_b64_tr_b16 v[112:113], v14 offset:28672
    ds_read_b64_tr_b16 v[114:115], v14 offset:29696
    v_mfma_f32_32x32x16_bf16 v[48:63], v[116:119], a[48:51], v[48:63]
    buffer_load_dwordx4 a[12:15], v2, s[36:39], s49 offen offset:3072 sc1
    ds_read_b64_tr_b16 v[116:117], v15 offset:28672
    ds_read_b64_tr_b16 v[118:119], v15 offset:29696
    s_waitcnt vmcnt(14) lgkmcnt(12)
    v_mfma_f32_32x32x16_bf16 v[64:79], v[104:107], a[212:215], v[64:79]
    ds_read_b64_tr_b16 v[104:105], v12 offset:14336
    ds_read_b64_tr_b16 v[106:107], v12 offset:15360
    s_bfe_u32 s49, s67, s75
    s_lshl_b32 s49, s49, 10
    v_mfma_f32_32x32x16_bf16 v[80:95], v[108:111], a[212:215], v[80:95]
    buffer_load_dwordx4 a[16:19], v2, s[36:39], s49 offen offset:0 sc1
    ds_read_b64_tr_b16 v[108:109], v13 offset:14336
    ds_read_b64_tr_b16 v[110:111], v13 offset:15360
    s_waitcnt lgkmcnt(12)
    v_mfma_f32_32x32x16_bf16 v[32:47], v[120:123], a[52:55], v[32:47]
    ds_read_b64_tr_b16 v[120:121], v14 offset:30720
    ds_read_b64_tr_b16 v[122:123], v14 offset:31744
    v_mfma_f32_32x32x16_bf16 v[48:63], v[124:127], a[52:55], v[48:63]
    buffer_load_dwordx4 a[20:23], v2, s[36:39], s49 offen offset:1024 sc1
    ds_read_b64_tr_b16 v[124:125], v15 offset:30720
    ds_read_b64_tr_b16 v[126:127], v15 offset:31744
    s_waitcnt vmcnt(15) lgkmcnt(12)
    v_mfma_f32_32x32x16_bf16 v[64:79], v[96:99], a[216:219], v[64:79]
    ds_read_b64_tr_b16 v[96:97], v12 offset:16384
    ds_read_b64_tr_b16 v[98:99], v12 offset:17408
    v_mfma_f32_32x32x16_bf16 v[80:95], v[100:103], a[216:219], v[80:95]
    buffer_load_dwordx4 a[24:27], v2, s[36:39], s49 offen offset:2048 sc1
    ds_read_b64_tr_b16 v[100:101], v13 offset:16384
    ds_read_b64_tr_b16 v[102:103], v13 offset:17408
    s_waitcnt lgkmcnt(12)
    v_mfma_f32_32x32x16_bf16 v[32:47], v[112:115], a[56:59], v[32:47]
    ds_read_b64_tr_b16 v[112:113], v14 offset:32768
    ds_read_b64_tr_b16 v[114:115], v14 offset:33792
    s_add_u32 m0, s81, 40960
    s_bfe_u32 s85, s68, s73
    s_lshl_b32 s85, s85, 15
    s_add_u32 s85, s85, s84
    v_mfma_f32_32x32x16_bf16 v[48:63], v[116:119], a[56:59], v[48:63]
    buffer_load_dwordx4 v8, s[44:47], s85 offen lds
    ds_read_b64_tr_b16 v[116:117], v15 offset:32768
    ds_read_b64_tr_b16 v[118:119], v15 offset:33792
    s_waitcnt vmcnt(12) lgkmcnt(12)
    v_mfma_f32_32x32x16_bf16 v[64:79], v[104:107], a[220:223], v[64:79]
    ds_read_b64_tr_b16 v[104:105], v12 offset:18432
    ds_read_b64_tr_b16 v[106:107], v12 offset:19456
    s_add_u32 m0, s81, 41984
    s_add_u32 s85, s85, 16384
    v_mfma_f32_32x32x16_bf16 v[80:95], v[108:111], a[220:223], v[80:95]
    buffer_load_dwordx4 v8, s[44:47], s85 offen lds
    ds_read_b64_tr_b16 v[108:109], v13 offset:18432
    ds_read_b64_tr_b16 v[110:111], v13 offset:19456
    s_waitcnt lgkmcnt(12)
    v_mfma_f32_32x32x16_bf16 v[32:47], v[120:123], a[60:63], v[32:47]
    ds_read_b64_tr_b16 v[120:121], v14 offset:34816
    ds_read_b64_tr_b16 v[122:123], v14 offset:35840
    s_add_u32 m0, s81, 57344
    s_bfe_u32 s86, s65, s75
    s_lshl_b32 s86, s86, 15
    s_add_u32 s86, s86, s80
    v_mfma_f32_32x32x16_bf16 v[48:63], v[124:127], a[60:63], v[48:63]
    buffer_load_dwordx4 v8, s[44:47], s86 offen lds
    ds_read_b64_tr_b16 v[124:125], v15 offset:34816
    ds_read_b64_tr_b16 v[126:127], v15 offset:35840
    s_waitcnt vmcnt(17)
    s_waitcnt vmcnt(15)
    s_barrier
    s_waitcnt vmcnt(13) lgkmcnt(12)
    v_mfma_f32_32x32x16_bf16 v[64:79], v[96:99], a[0:3], v[64:79]
    ds_read_b64_tr_b16 v[96:97], v12 offset:20480
    ds_read_b64_tr_b16 v[98:99], v12 offset:21504
    s_add_u32 m0, s81, 58368
    s_add_u32 s86, s86, 16384
    v_mfma_f32_32x32x16_bf16 v[80:95], v[100:103], a[0:3], v[80:95]
    buffer_load_dwordx4 v8, s[44:47], s86 offen lds
    ds_read_b64_tr_b16 v[100:101], v13 offset:20480
    ds_read_b64_tr_b16 v[102:103], v13 offset:21504
    s_waitcnt lgkmcnt(12)
    v_mfma_f32_32x32x16_bf16 v[32:47], v[112:115], a[64:67], v[32:47]
    ds_read_b64_tr_b16 v[112:113], v14 offset:36864
    ds_read_b64_tr_b16 v[114:115], v14 offset:37888
    v_mfma_f32_32x32x16_bf16 v[48:63], v[116:119], a[64:67], v[48:63]
    buffer_load_dwordx4 a[28:31], v2, s[36:39], s49 offen offset:3072 sc1
    ds_read_b64_tr_b16 v[116:117], v15 offset:36864
    ds_read_b64_tr_b16 v[118:119], v15 offset:37888
    s_waitcnt vmcnt(14) lgkmcnt(12)
    v_mfma_f32_32x32x16_bf16 v[64:79], v[104:107], a[4:7], v[64:79]
    ds_read_b64_tr_b16 v[104:105], v12 offset:22528
    ds_read_b64_tr_b16 v[106:107], v12 offset:23552
    s_bfe_u32 s49, s68, s72
    s_lshl_b32 s49, s49, 10
    v_mfma_f32_32x32x16_bf16 v[80:95], v[108:111], a[4:7], v[80:95]
    buffer_load_dwordx4 a[32:35], v2, s[36:39], s49 offen offset:0 sc1
    ds_read_b64_tr_b16 v[108:109], v13 offset:22528
    ds_read_b64_tr_b16 v[110:111], v13 offset:23552
    s_waitcnt lgkmcnt(12)
    v_mfma_f32_32x32x16_bf16 v[32:47], v[120:123], a[68:71], v[32:47]
    ds_read_b64_tr_b16 v[120:121], v14 offset:38912
    ds_read_b64_tr_b16 v[122:123], v14 offset:39936
    v_mfma_f32_32x32x16_bf16 v[48:63], v[124:127], a[68:71], v[48:63]
    buffer_load_dwordx4 a[36:39], v2, s[36:39], s49 offen offset:1024 sc1
    ds_read_b64_tr_b16 v[124:125], v15 offset:38912
    ds_read_b64_tr_b16 v[126:127], v15 offset:39936
    s_waitcnt vmcnt(15) lgkmcnt(12)
    v_mfma_f32_32x32x16_bf16 v[64:79], v[96:99], a[8:11], v[64:79]
    ds_read_b64_tr_b16 v[96:97], v12 offset:24576
    ds_read_b64_tr_b16 v[98:99], v12 offset:25600
    v_mfma_f32_32x32x16_bf16 v[80:95], v[100:103], a[8:11], v[80:95]
    buffer_load_dwordx4 a[40:43], v2, s[36:39], s49 offen offset:2048 sc1
    ds_read_b64_tr_b16 v[100:101], v13 offset:24576
    ds_read_b64_tr_b16 v[102:103], v13 offset:25600
    s_waitcnt lgkmcnt(12)
    v_mfma_f32_32x32x16_bf16 v[32:47], v[112:115], a[72:75], v[32:47]
    ds_read_b64_tr_b16 v[112:113], v14 offset:40960
    ds_read_b64_tr_b16 v[114:115], v14 offset:41984
    s_add_u32 m0, s81, 0
    s_bfe_u32 s85, s68, s74
    s_lshl_b32 s85, s85, 15
    s_add_u32 s85, s85, s84
    v_mfma_f32_32x32x16_bf16 v[48:63], v[116:119], a[72:75], v[48:63]
    buffer_load_dwordx4 v8, s[44:47], s85 offen lds
    ds_read_b64_tr_b16 v[116:117], v15 offset:40960
    ds_read_b64_tr_b16 v[118:119], v15 offset:41984
    s_waitcnt vmcnt(12) lgkmcnt(12)
    v_mfma_f32_32x32x16_bf16 v[64:79], v[104:107], a[12:15], v[64:79]
    ds_read_b64_tr_b16 v[104:105], v12 offset:26624
    ds_read_b64_tr_b16 v[106:107], v12 offset:27648
    s_add_u32 m0, s81, 1024
    s_add_u32 s85, s85, 16384
    v_mfma_f32_32x32x16_bf16 v[80:95], v[108:111], a[12:15], v[80:95]
    buffer_load_dwordx4 v8, s[44:47], s85 offen lds
    ds_read_b64_tr_b16 v[108:109], v13 offset:26624
    ds_read_b64_tr_b16 v[110:111], v13 offset:27648
    s_waitcnt lgkmcnt(12)
    v_mfma_f32_32x32x16_bf16 v[32:47], v[120:123], a[76:79], v[32:47]
    ds_read_b64_tr_b16 v[120:121], v14 offset:43008
    ds_read_b64_tr_b16 v[122:123], v14 offset:44032
    s_add_u32 m0, s81, 65536
    s_bfe_u32 s86, s66, s72
    s_lshl_b32 s86, s86, 15
    s_add_u32 s86, s86, s80
    v_mfma_f32_32x32x16_bf16 v[48:63], v[124:127], a[76:79], v[48:63]
    buffer_load_dwordx4 v8, s[44:47], s86 offen lds
    ds_read_b64_tr_b16 v[124:125], v15 offset:43008
    ds_read_b64_tr_b16 v[126:127], v15 offset:44032
    s_waitcnt vmcnt(17)
    s_waitcnt vmcnt(15)
    s_barrier
    s_waitcnt vmcnt(13) lgkmcnt(12)
    v_mfma_f32_32x32x16_bf16 v[64:79], v[96:99], a[16:19], v[64:79]
    ds_read_b64_tr_b16 v[96:97], v12 offset:28672
    ds_read_b64_tr_b16 v[98:99], v12 offset:29696
    s_add_u32 m0, s81, 66560
    s_add_u32 s86, s86, 16384
    v_mfma_f32_32x32x16_bf16 v[80:95], v[100:103], a[16:19], v[80:95]
    buffer_load_dwordx4 v8, s[44:47], s86 offen lds
    ds_read_b64_tr_b16 v[100:101], v13 offset:28672
    ds_read_b64_tr_b16 v[102:103], v13 offset:29696
    s_waitcnt lgkmcnt(12)
    v_mfma_f32_32x32x16_bf16 v[32:47], v[112:115], a[80:83], v[32:47]
    ds_read_b64_tr_b16 v[112:113], v14 offset:45056
    ds_read_b64_tr_b16 v[114:115], v14 offset:46080
    v_mfma_f32_32x32x16_bf16 v[48:63], v[116:119], a[80:83], v[48:63]
    buffer_load_dwordx4 a[44:47], v2, s[36:39], s49 offen offset:3072 sc1
    ds_read_b64_tr_b16 v[116:117], v15 offset:45056
    ds_read_b64_tr_b16 v[118:119], v15 offset:46080
    s_waitcnt vmcnt(14) lgkmcnt(12)
    v_mfma_f32_32x32x16_bf16 v[64:79], v[104:107], a[20:23], v[64:79]
    ds_read_b64_tr_b16 v[104:105], v12 offset:30720
    ds_read_b64_tr_b16 v[106:107], v12 offset:31744
    s_bfe_u32 s49, s68, s73
    s_lshl_b32 s49, s49, 10
    v_mfma_f32_32x32x16_bf16 v[80:95], v[108:111], a[20:23], v[80:95]
    buffer_load_dwordx4 a[48:51], v2, s[36:39], s49 offen offset:0 sc1
    ds_read_b64_tr_b16 v[108:109], v13 offset:30720
    ds_read_b64_tr_b16 v[110:111], v13 offset:31744
    s_waitcnt lgkmcnt(12)
    v_mfma_f32_32x32x16_bf16 v[32:47], v[120:123], a[84:87], v[32:47]
    ds_read_b64_tr_b16 v[120:121], v14 offset:47104
    ds_read_b64_tr_b16 v[122:123], v14 offset:48128
    v_mfma_f32_32x32x16_bf16 v[48:63], v[124:127], a[84:87], v[48:63]
    buffer_load_dwordx4 a[52:55], v2, s[36:39], s49 offen offset:1024 sc1
    ds_read_b64_tr_b16 v[124:125], v15 offset:47104
    ds_read_b64_tr_b16 v[126:127], v15 offset:48128
    s_waitcnt vmcnt(15) lgkmcnt(12)
    v_mfma_f32_32x32x16_bf16 v[64:79], v[96:99], a[24:27], v[64:79]
    ds_read_b64_tr_b16 v[96:97], v12 offset:32768
    ds_read_b64_tr_b16 v[98:99], v12 offset:33792
    v_mfma_f32_32x32x16_bf16 v[80:95], v[100:103], a[24:27], v[80:95]
    buffer_load_dwordx4 a[56:59], v2, s[36:39], s49 offen offset:2048 sc1
    ds_read_b64_tr_b16 v[100:101], v13 offset:32768
    ds_read_b64_tr_b16 v[102:103], v13 offset:33792
    s_waitcnt lgkmcnt(12)
    v_mfma_f32_32x32x16_bf16 v[32:47], v[112:115], a[88:91], v[32:47]
    ds_read_b64_tr_b16 v[112:113], v14 offset:0
    ds_read_b64_tr_b16 v[114:115], v14 offset:1024
    s_add_u32 m0, s81, 8192
    s_bfe_u32 s85, s68, s75
    s_lshl_b32 s85, s85, 15
    s_add_u32 s85, s85, s84
    v_mfma_f32_32x32x16_bf16 v[48:63], v[116:119], a[88:91], v[48:63]
    buffer_load_dwordx4 v8, s[44:47], s85 offen lds
    ds_read_b64_tr_b16 v[116:117], v15 offset:0
    ds_read_b64_tr_b16 v[118:119], v15 offset:1024
    s_waitcnt vmcnt(12) lgkmcnt(12)
    v_mfma_f32_32x32x16_bf16 v[64:79], v[104:107], a[28:31], v[64:79]
    ds_read_b64_tr_b16 v[104:105], v12 offset:34816
    ds_read_b64_tr_b16 v[106:107], v12 offset:35840
    s_add_u32 m0, s81, 9216
    s_add_u32 s85, s85, 16384
    v_mfma_f32_32x32x16_bf16 v[80:95], v[108:111], a[28:31], v[80:95]
    buffer_load_dwordx4 v8, s[44:47], s85 offen lds
    ds_read_b64_tr_b16 v[108:109], v13 offset:34816
    ds_read_b64_tr_b16 v[110:111], v13 offset:35840
    s_waitcnt lgkmcnt(12)
    v_mfma_f32_32x32x16_bf16 v[32:47], v[120:123], a[92:95], v[32:47]
    ds_read_b64_tr_b16 v[120:121], v14 offset:2048
    ds_read_b64_tr_b16 v[122:123], v14 offset:3072
    s_add_u32 m0, s81, 73728
    s_bfe_u32 s86, s66, s73
    s_lshl_b32 s86, s86, 15
    s_add_u32 s86, s86, s80
    v_mfma_f32_32x32x16_bf16 v[48:63], v[124:127], a[92:95], v[48:63]
    buffer_load_dwordx4 v8, s[44:47], s86 offen lds
    ds_read_b64_tr_b16 v[124:125], v15 offset:2048
    ds_read_b64_tr_b16 v[126:127], v15 offset:3072
    s_waitcnt vmcnt(17)
    s_waitcnt vmcnt(15)
    s_barrier
    s_waitcnt vmcnt(13) lgkmcnt(12)
    v_mfma_f32_32x32x16_bf16 v[64:79], v[96:99], a[32:35], v[64:79]
    ds_read_b64_tr_b16 v[96:97], v12 offset:36864
    ds_read_b64_tr_b16 v[98:99], v12 offset:37888
    s_add_u32 m0, s81, 74752
    s_add_u32 s86, s86, 16384
    v_mfma_f32_32x32x16_bf16 v[80:95], v[100:103], a[32:35], v[80:95]
    buffer_load_dwordx4 v8, s[44:47], s86 offen lds
    ds_read_b64_tr_b16 v[100:101], v13 offset:36864
    ds_read_b64_tr_b16 v[102:103], v13 offset:37888
    s_waitcnt lgkmcnt(12)
    v_mfma_f32_32x32x16_bf16 v[32:47], v[112:115], a[96:99], v[32:47]
    ds_read_b64_tr_b16 v[112:113], v14 offset:4096
    ds_read_b64_tr_b16 v[114:115], v14 offset:5120
    v_mfma_f32_32x32x16_bf16 v[48:63], v[116:119], a[96:99], v[48:63]
    buffer_load_dwordx4 a[60:63], v2, s[36:39], s49 offen offset:3072 sc1
    ds_read_b64_tr_b16 v[116:117], v15 offset:4096
    ds_read_b64_tr_b16 v[118:119], v15 offset:5120
    s_waitcnt vmcnt(14) lgkmcnt(12)
    v_mfma_f32_32x32x16_bf16 v[64:79], v[104:107], a[36:39], v[64:79]
    ds_read_b64_tr_b16 v[104:105], v12 offset:38912
    ds_read_b64_tr_b16 v[106:107], v12 offset:39936
    s_bfe_u32 s49, s68, s74
    s_lshl_b32 s49, s49, 10
    v_mfma_f32_32x32x16_bf16 v[80:95], v[108:111], a[36:39], v[80:95]
    buffer_load_dwordx4 a[64:67], v2, s[36:39], s49 offen offset:0 sc1
    ds_read_b64_tr_b16 v[108:109], v13 offset:38912
    ds_read_b64_tr_b16 v[110:111], v13 offset:39936
    s_waitcnt lgkmcnt(12)
    v_mfma_f32_32x32x16_bf16 v[32:47], v[120:123], a[100:103], v[32:47]
    ds_read_b64_tr_b16 v[120:121], v14 offset:6144
    ds_read_b64_tr_b16 v[122:123], v14 offset:7168
    v_mfma_f32_32x32x16_bf16 v[48:63], v[124:127], a[100:103], v[48:63]
    buffer_load_dwordx4 a[68:71], v2, s[36:39], s49 offen offset:1024 sc1
    ds_read_b64_tr_b16 v[124:125], v15 offset:6144
    ds_read_b64_tr_b16 v[126:127], v15 offset:7168
    s_waitcnt vmcnt(15) lgkmcnt(12)
    v_mfma_f32_32x32x16_bf16 v[64:79], v[96:99], a[40:43], v[64:79]
    ds_read_b64_tr_b16 v[96:97], v12 offset:40960
    ds_read_b64_tr_b16 v[98:99], v12 offset:41984
    v_mfma_f32_32x32x16_bf16 v[80:95], v[100:103], a[40:43], v[80:95]
    buffer_load_dwordx4 a[72:75], v2, s[36:39], s49 offen offset:2048 sc1
    ds_read_b64_tr_b16 v[100:101], v13 offset:40960
    ds_read_b64_tr_b16 v[102:103], v13 offset:41984
    s_waitcnt lgkmcnt(12)
    v_mfma_f32_32x32x16_bf16 v[32:47], v[112:115], a[104:107], v[32:47]
    ds_read_b64_tr_b16 v[112:113], v14 offset:8192
    ds_read_b64_tr_b16 v[114:115], v14 offset:9216
    s_add_u32 m0, s81, 16384
    s_bfe_u32 s85, s69, s72
    s_lshl_b32 s85, s85, 15
    s_add_u32 s85, s85, s84
    v_mfma_f32_32x32x16_bf16 v[48:63], v[116:119], a[104:107], v[48:63]
    buffer_load_dwordx4 v8, s[44:47], s85 offen lds
    ds_read_b64_tr_b16 v[116:117], v15 offset:8192
    ds_read_b64_tr_b16 v[118:119], v15 offset:9216
    s_waitcnt vmcnt(12) lgkmcnt(12)
    v_mfma_f32_32x32x16_bf16 v[64:79], v[104:107], a[44:47], v[64:79]
    ds_read_b64_tr_b16 v[104:105], v12 offset:43008
    ds_read_b64_tr_b16 v[106:107], v12 offset:44032
    s_add_u32 m0, s81, 17408
    s_add_u32 s85, s85, 16384
    v_mfma_f32_32x32x16_bf16 v[80:95], v[108:111], a[44:47], v[80:95]
    buffer_load_dwordx4 v8, s[44:47], s85 offen lds
    ds_read_b64_tr_b16 v[108:109], v13 offset:43008
    ds_read_b64_tr_b16 v[110:111], v13 offset:44032
    s_waitcnt lgkmcnt(12)
    v_mfma_f32_32x32x16_bf16 v[32:47], v[120:123], a[108:111], v[32:47]
    ds_read_b64_tr_b16 v[120:121], v14 offset:10240
    ds_read_b64_tr_b16 v[122:123], v14 offset:11264
    s_add_u32 m0, s81, 81920
    s_bfe_u32 s86, s66, s74
    s_lshl_b32 s86, s86, 15
    s_add_u32 s86, s86, s80
    v_mfma_f32_32x32x16_bf16 v[48:63], v[124:127], a[108:111], v[48:63]
    buffer_load_dwordx4 v8, s[44:47], s86 offen lds
    ds_read_b64_tr_b16 v[124:125], v15 offset:10240
    ds_read_b64_tr_b16 v[126:127], v15 offset:11264
    s_waitcnt vmcnt(17)
    s_waitcnt vmcnt(15)
    s_barrier
    s_waitcnt vmcnt(13) lgkmcnt(12)
    v_mfma_f32_32x32x16_bf16 v[64:79], v[96:99], a[48:51], v[64:79]
    ds_read_b64_tr_b16 v[96:97], v12 offset:45056
    ds_read_b64_tr_b16 v[98:99], v12 offset:46080
    s_add_u32 m0, s81, 82944
    s_add_u32 s86, s86, 16384
    v_mfma_f32_32x32x16_bf16 v[80:95], v[100:103], a[48:51], v[80:95]
    buffer_load_dwordx4 v8, s[44:47], s86 offen lds
    ds_read_b64_tr_b16 v[100:101], v13 offset:45056
    ds_read_b64_tr_b16 v[102:103], v13 offset:46080
    s_waitcnt lgkmcnt(12)
    v_mfma_f32_32x32x16_bf16 v[32:47], v[112:115], a[112:115], v[32:47]
    ds_read_b64_tr_b16 v[112:113], v14 offset:12288
    ds_read_b64_tr_b16 v[114:115], v14 offset:13312
    v_mfma_f32_32x32x16_bf16 v[48:63], v[116:119], a[112:115], v[48:63]
    buffer_load_dwordx4 a[76:79], v2, s[36:39], s49 offen offset:3072 sc1
    ds_read_b64_tr_b16 v[116:117], v15 offset:12288
    ds_read_b64_tr_b16 v[118:119], v15 offset:13312
    s_waitcnt vmcnt(14) lgkmcnt(12)
    v_mfma_f32_32x32x16_bf16 v[64:79], v[104:107], a[52:55], v[64:79]
    ds_read_b64_tr_b16 v[104:105], v12 offset:47104
    ds_read_b64_tr_b16 v[106:107], v12 offset:48128
    s_bfe_u32 s49, s68, s75
    s_lshl_b32 s49, s49, 10
    v_mfma_f32_32x32x16_bf16 v[80:95], v[108:111], a[52:55], v[80:95]
    buffer_load_dwordx4 a[80:83], v2, s[36:39], s49 offen offset:0 sc1
    ds_read_b64_tr_b16 v[108:109], v13 offset:47104
    ds_read_b64_tr_b16 v[110:111], v13 offset:48128
    s_waitcnt lgkmcnt(12)
    v_mfma_f32_32x32x16_bf16 v[32:47], v[120:123], a[116:119], v[32:47]
    ds_read_b64_tr_b16 v[120:121], v14 offset:14336
    ds_read_b64_tr_b16 v[122:123], v14 offset:15360
    v_mfma_f32_32x32x16_bf16 v[48:63], v[124:127], a[116:119], v[48:63]
    buffer_load_dwordx4 a[84:87], v2, s[36:39], s49 offen offset:1024 sc1
    ds_read_b64_tr_b16 v[124:125], v15 offset:14336
    ds_read_b64_tr_b16 v[126:127], v15 offset:15360
    s_waitcnt vmcnt(15) lgkmcnt(12)
    v_mfma_f32_32x32x16_bf16 v[64:79], v[96:99], a[56:59], v[64:79]
    ds_read_b64_tr_b16 v[96:97], v12 offset:0
    ds_read_b64_tr_b16 v[98:99], v12 offset:1024
    v_mfma_f32_32x32x16_bf16 v[80:95], v[100:103], a[56:59], v[80:95]
    buffer_load_dwordx4 a[88:91], v2, s[36:39], s49 offen offset:2048 sc1
    ds_read_b64_tr_b16 v[100:101], v13 offset:0
    ds_read_b64_tr_b16 v[102:103], v13 offset:1024
    s_waitcnt lgkmcnt(12)
    v_mfma_f32_32x32x16_bf16 v[32:47], v[112:115], a[120:123], v[32:47]
    ds_read_b64_tr_b16 v[112:113], v14 offset:16384
    ds_read_b64_tr_b16 v[114:115], v14 offset:17408
    s_add_u32 m0, s81, 24576
    s_bfe_u32 s85, s69, s73
    s_lshl_b32 s85, s85, 15
    s_add_u32 s85, s85, s84
    v_mfma_f32_32x32x16_bf16 v[48:63], v[116:119], a[120:123], v[48:63]
    buffer_load_dwordx4 v8, s[44:47], s85 offen lds
    ds_read_b64_tr_b16 v[116:117], v15 offset:16384
    ds_read_b64_tr_b16 v[118:119], v15 offset:17408
    s_waitcnt vmcnt(12) lgkmcnt(12)
    v_mfma_f32_32x32x16_bf16 v[64:79], v[104:107], a[60:63], v[64:79]
    ds_read_b64_tr_b16 v[104:105], v12 offset:2048
    ds_read_b64_tr_b16 v[106:107], v12 offset:3072
    s_add_u32 m0, s81, 25600
    s_add_u32 s85, s85, 16384
    v_mfma_f32_32x32x16_bf16 v[80:95], v[108:111], a[60:63], v[80:95]
    buffer_load_dwordx4 v8, s[44:47], s85 offen lds
    ds_read_b64_tr_b16 v[108:109], v13 offset:2048
    ds_read_b64_tr_b16 v[110:111], v13 offset:3072
    s_waitcnt lgkmcnt(12)
    v_mfma_f32_32x32x16_bf16 v[32:47], v[120:123], a[124:127], v[32:47]
    ds_read_b64_tr_b16 v[120:121], v14 offset:18432
    ds_read_b64_tr_b16 v[122:123], v14 offset:19456
    s_add_u32 m0, s81, 90112
    s_bfe_u32 s86, s66, s75
    s_lshl_b32 s86, s86, 15
    s_add_u32 s86, s86, s80
    v_mfma_f32_32x32x16_bf16 v[48:63], v[124:127], a[124:127], v[48:63]
    buffer_load_dwordx4 v8, s[44:47], s86 offen lds
    ds_read_b64_tr_b16 v[124:125], v15 offset:18432
    ds_read_b64_tr_b16 v[126:127], v15 offset:19456
    s_waitcnt vmcnt(17)
    s_waitcnt vmcnt(15)
    s_barrier
    s_waitcnt vmcnt(13) lgkmcnt(12)
    v_mfma_f32_32x32x16_bf16 v[64:79], v[96:99], a[64:67], v[64:79]
    ds_read_b64_tr_b16 v[96:97], v12 offset:4096
    ds_read_b64_tr_b16 v[98:99], v12 offset:5120
    s_add_u32 m0, s81, 91136
    s_add_u32 s86, s86, 16384
    v_mfma_f32_32x32x16_bf16 v[80:95], v[100:103], a[64:67], v[80:95]
    buffer_load_dwordx4 v8, s[44:47], s86 offen lds
    ds_read_b64_tr_b16 v[100:101], v13 offset:4096
    ds_read_b64_tr_b16 v[102:103], v13 offset:5120
    s_waitcnt lgkmcnt(12)
    v_mfma_f32_32x32x16_bf16 v[32:47], v[112:115], a[128:131], v[32:47]
    ds_read_b64_tr_b16 v[112:113], v14 offset:20480
    ds_read_b64_tr_b16 v[114:115], v14 offset:21504
    v_mfma_f32_32x32x16_bf16 v[48:63], v[116:119], a[128:131], v[48:63]
    buffer_load_dwordx4 a[92:95], v2, s[36:39], s49 offen offset:3072 sc1
    ds_read_b64_tr_b16 v[116:117], v15 offset:20480
    ds_read_b64_tr_b16 v[118:119], v15 offset:21504
    s_waitcnt vmcnt(14) lgkmcnt(12)
    v_mfma_f32_32x32x16_bf16 v[64:79], v[104:107], a[68:71], v[64:79]
    ds_read_b64_tr_b16 v[104:105], v12 offset:6144
    ds_read_b64_tr_b16 v[106:107], v12 offset:7168
    s_bfe_u32 s49, s69, s72
    s_lshl_b32 s49, s49, 10
    v_mfma_f32_32x32x16_bf16 v[80:95], v[108:111], a[68:71], v[80:95]
    buffer_load_dwordx4 a[96:99], v2, s[36:39], s49 offen offset:0 sc1
    ds_read_b64_tr_b16 v[108:109], v13 offset:6144
    ds_read_b64_tr_b16 v[110:111], v13 offset:7168
    s_waitcnt lgkmcnt(12)
    v_mfma_f32_32x32x16_bf16 v[32:47], v[120:123], a[132:135], v[32:47]
    ds_read_b64_tr_b16 v[120:121], v14 offset:22528
    ds_read_b64_tr_b16 v[122:123], v14 offset:23552
    v_mfma_f32_32x32x16_bf16 v[48:63], v[124:127], a[132:135], v[48:63]
    buffer_load_dwordx4 a[100:103], v2, s[36:39], s49 offen offset:1024 sc1
    ds_read_b64_tr_b16 v[124:125], v15 offset:22528
    ds_read_b64_tr_b16 v[126:127], v15 offset:23552
    s_waitcnt vmcnt(15) lgkmcnt(12)
    v_mfma_f32_32x32x16_bf16 v[64:79], v[96:99], a[72:75], v[64:79]
    ds_read_b64_tr_b16 v[96:97], v12 offset:8192
    ds_read_b64_tr_b16 v[98:99], v12 offset:9216
    v_mfma_f32_32x32x16_bf16 v[80:95], v[100:103], a[72:75], v[80:95]
    buffer_load_dwordx4 a[104:107], v2, s[36:39], s49 offen offset:2048 sc1
    ds_read_b64_tr_b16 v[100:101], v13 offset:8192
    ds_read_b64_tr_b16 v[102:103], v13 offset:9216
    s_waitcnt lgkmcnt(12)
    v_mfma_f32_32x32x16_bf16 v[32:47], v[112:115], a[136:139], v[32:47]
    ds_read_b64_tr_b16 v[112:113], v14 offset:24576
    ds_read_b64_tr_b16 v[114:115], v14 offset:25600
    s_add_u32 m0, s81, 32768
    s_bfe_u32 s85, s69, s74
    s_lshl_b32 s85, s85, 15
    s_add_u32 s85, s85, s84
    v_mfma_f32_32x32x16_bf16 v[48:63], v[116:119], a[136:139], v[48:63]
    buffer_load_dwordx4 v8, s[44:47], s85 offen lds
    ds_read_b64_tr_b16 v[116:117], v15 offset:24576
    ds_read_b64_tr_b16 v[118:119], v15 offset:25600
    s_waitcnt vmcnt(12) lgkmcnt(12)
    v_mfma_f32_32x32x16_bf16 v[64:79], v[104:107], a[76:79], v[64:79]
    ds_read_b64_tr_b16 v[104:105], v12 offset:10240
    ds_read_b64_tr_b16 v[106:107], v12 offset:11264
    s_add_u32 m0, s81, 33792
    s_add_u32 s85, s85, 16384
    v_mfma_f32_32x32x16_bf16 v[80:95], v[108:111], a[76:79], v[80:95]
    buffer_load_dwordx4 v8, s[44:47], s85 offen lds
    ds_read_b64_tr_b16 v[108:109], v13 offset:10240
    ds_read_b64_tr_b16 v[110:111], v13 offset:11264
    s_waitcnt lgkmcnt(12)
    v_mfma_f32_32x32x16_bf16 v[32:47], v[120:123], a[140:143], v[32:47]
    ds_read_b64_tr_b16 v[120:121], v14 offset:26624
    ds_read_b64_tr_b16 v[122:123], v14 offset:27648
    s_add_u32 m0, s81, 49152
    s_bfe_u32 s86, s67, s72
    s_lshl_b32 s86, s86, 15
    s_add_u32 s86, s86, s80
    v_mfma_f32_32x32x16_bf16 v[48:63], v[124:127], a[140:143], v[48:63]
    buffer_load_dwordx4 v8, s[44:47], s86 offen lds
    ds_read_b64_tr_b16 v[124:125], v15 offset:26624
    ds_read_b64_tr_b16 v[126:127], v15 offset:27648
    s_waitcnt vmcnt(17)
    s_waitcnt vmcnt(15)
    s_barrier
    s_waitcnt vmcnt(13) lgkmcnt(12)
    v_mfma_f32_32x32x16_bf16 v[64:79], v[96:99], a[80:83], v[64:79]
    ds_read_b64_tr_b16 v[96:97], v12 offset:12288
    ds_read_b64_tr_b16 v[98:99], v12 offset:13312
    s_add_u32 m0, s81, 50176
    s_add_u32 s86, s86, 16384
    v_mfma_f32_32x32x16_bf16 v[80:95], v[100:103], a[80:83], v[80:95]
    buffer_load_dwordx4 v8, s[44:47], s86 offen lds
    ds_read_b64_tr_b16 v[100:101], v13 offset:12288
    ds_read_b64_tr_b16 v[102:103], v13 offset:13312
    s_waitcnt lgkmcnt(12)
    v_mfma_f32_32x32x16_bf16 v[32:47], v[112:115], a[144:147], v[32:47]
    ds_read_b64_tr_b16 v[112:113], v14 offset:28672
    ds_read_b64_tr_b16 v[114:115], v14 offset:29696
    v_mfma_f32_32x32x16_bf16 v[48:63], v[116:119], a[144:147], v[48:63]
    buffer_load_dwordx4 a[108:111], v2, s[36:39], s49 offen offset:3072 sc1
    ds_read_b64_tr_b16 v[116:117], v15 offset:28672
    ds_read_b64_tr_b16 v[118:119], v15 offset:29696
    s_waitcnt vmcnt(14) lgkmcnt(12)
    v_mfma_f32_32x32x16_bf16 v[64:79], v[104:107], a[84:87], v[64:79]
    ds_read_b64_tr_b16 v[104:105], v12 offset:14336
    ds_read_b64_tr_b16 v[106:107], v12 offset:15360
    s_bfe_u32 s49, s69, s73
    s_lshl_b32 s49, s49, 10
    v_mfma_f32_32x32x16_bf16 v[80:95], v[108:111], a[84:87], v[80:95]
    buffer_load_dwordx4 a[112:115], v2, s[36:39], s49 offen offset:0 sc1
    ds_read_b64_tr_b16 v[108:109], v13 offset:14336
    ds_read_b64_tr_b16 v[110:111], v13 offset:15360
    s_waitcnt lgkmcnt(12)
    v_mfma_f32_32x32x16_bf16 v[32:47], v[120:123], a[148:151], v[32:47]
    ds_read_b64_tr_b16 v[120:121], v14 offset:30720
    ds_read_b64_tr_b16 v[122:123], v14 offset:31744
    v_mfma_f32_32x32x16_bf16 v[48:63], v[124:127], a[148:151], v[48:63]
    buffer_load_dwordx4 a[116:119], v2, s[36:39], s49 offen offset:1024 sc1
    ds_read_b64_tr_b16 v[124:125], v15 offset:30720
    ds_read_b64_tr_b16 v[126:127], v15 offset:31744
    s_waitcnt vmcnt(15) lgkmcnt(12)
    v_mfma_f32_32x32x16_bf16 v[64:79], v[96:99], a[88:91], v[64:79]
    ds_read_b64_tr_b16 v[96:97], v12 offset:16384
    ds_read_b64_tr_b16 v[98:99], v12 offset:17408
    v_mfma_f32_32x32x16_bf16 v[80:95], v[100:103], a[88:91], v[80:95]
    buffer_load_dwordx4 a[120:123], v2, s[36:39], s49 offen offset:2048 sc1
    ds_read_b64_tr_b16 v[100:101], v13 offset:16384
    ds_read_b64_tr_b16 v[102:103], v13 offset:17408
    s_waitcnt lgkmcnt(12)
    v_mfma_f32_32x32x16_bf16 v[32:47], v[112:115], a[152:155], v[32:47]
    ds_read_b64_tr_b16 v[112:113], v14 offset:32768
    ds_read_b64_tr_b16 v[114:115], v14 offset:33792
    s_add_u32 m0, s81, 40960
    s_bfe_u32 s85, s69, s75
    s_lshl_b32 s85, s85, 15
    s_add_u32 s85, s85, s84
    v_mfma_f32_32x32x16_bf16 v[48:63], v[116:119], a[152:155], v[48:63]
    buffer_load_dwordx4 v8, s[44:47], s85 offen lds
    ds_read_b64_tr_b16 v[116:117], v15 offset:32768
    ds_read_b64_tr_b16 v[118:119], v15 offset:33792
    s_waitcnt vmcnt(12) lgkmcnt(12)
    v_mfma_f32_32x32x16_bf16 v[64:79], v[104:107], a[92:95], v[64:79]
    ds_read_b64_tr_b16 v[104:105], v12 offset:18432
    ds_read_b64_tr_b16 v[106:107], v12 offset:19456
    s_add_u32 m0, s81, 41984
    s_add_u32 s85, s85, 16384
    v_mfma_f32_32x32x16_bf16 v[80:95], v[108:111], a[92:95], v[80:95]
    buffer_load_dwordx4 v8, s[44:47], s85 offen lds
    ds_read_b64_tr_b16 v[108:109], v13 offset:18432
    ds_read_b64_tr_b16 v[110:111], v13 offset:19456
    s_waitcnt lgkmcnt(12)
    v_mfma_f32_32x32x16_bf16 v[32:47], v[120:123], a[156:159], v[32:47]
    ds_read_b64_tr_b16 v[120:121], v14 offset:34816
    ds_read_b64_tr_b16 v[122:123], v14 offset:35840
    s_add_u32 m0, s81, 57344
    s_bfe_u32 s86, s67, s73
    s_lshl_b32 s86, s86, 15
    s_add_u32 s86, s86, s80
    v_mfma_f32_32x32x16_bf16 v[48:63], v[124:127], a[156:159], v[48:63]
    buffer_load_dwordx4 v8, s[44:47], s86 offen lds
    ds_read_b64_tr_b16 v[124:125], v15 offset:34816
    ds_read_b64_tr_b16 v[126:127], v15 offset:35840
    s_waitcnt vmcnt(17)
    s_waitcnt vmcnt(15)
    s_barrier
    s_waitcnt vmcnt(13) lgkmcnt(12)
    v_mfma_f32_32x32x16_bf16 v[64:79], v[96:99], a[96:99], v[64:79]
    ds_read_b64_tr_b16 v[96:97], v12 offset:20480
    ds_read_b64_tr_b16 v[98:99], v12 offset:21504
    s_add_u32 m0, s81, 58368
    s_add_u32 s86, s86, 16384
    v_mfma_f32_32x32x16_bf16 v[80:95], v[100:103], a[96:99], v[80:95]
    buffer_load_dwordx4 v8, s[44:47], s86 offen lds
    ds_read_b64_tr_b16 v[100:101], v13 offset:20480
    ds_read_b64_tr_b16 v[102:103], v13 offset:21504
    s_waitcnt lgkmcnt(12)
    v_mfma_f32_32x32x16_bf16 v[32:47], v[112:115], a[160:163], v[32:47]
    ds_read_b64_tr_b16 v[112:113], v14 offset:36864
    ds_read_b64_tr_b16 v[114:115], v14 offset:37888
    v_mfma_f32_32x32x16_bf16 v[48:63], v[116:119], a[160:163], v[48:63]
    buffer_load_dwordx4 a[124:127], v2, s[36:39], s49 offen offset:3072 sc1
    ds_read_b64_tr_b16 v[116:117], v15 offset:36864
    ds_read_b64_tr_b16 v[118:119], v15 offset:37888
    s_waitcnt vmcnt(14) lgkmcnt(12)
    v_mfma_f32_32x32x16_bf16 v[64:79], v[104:107], a[100:103], v[64:79]
    ds_read_b64_tr_b16 v[104:105], v12 offset:22528
    ds_read_b64_tr_b16 v[106:107], v12 offset:23552
    s_bfe_u32 s49, s69, s74
    s_lshl_b32 s49, s49, 10
    v_mfma_f32_32x32x16_bf16 v[80:95], v[108:111], a[100:103], v[80:95]
    buffer_load_dwordx4 a[128:131], v2, s[36:39], s49 offen offset:0 sc1
    ds_read_b64_tr_b16 v[108:109], v13 offset:22528
    ds_read_b64_tr_b16 v[110:111], v13 offset:23552
    s_waitcnt lgkmcnt(12)
    v_mfma_f32_32x32x16_bf16 v[32:47], v[120:123], a[164:167], v[32:47]
    ds_read_b64_tr_b16 v[120:121], v14 offset:38912
    ds_read_b64_tr_b16 v[122:123], v14 offset:39936
    v_mfma_f32_32x32x16_bf16 v[48:63], v[124:127], a[164:167], v[48:63]
    buffer_load_dwordx4 a[132:135], v2, s[36:39], s49 offen offset:1024 sc1
    ds_read_b64_tr_b16 v[124:125], v15 offset:38912
    ds_read_b64_tr_b16 v[126:127], v15 offset:39936
    s_waitcnt vmcnt(15) lgkmcnt(12)
    v_mfma_f32_32x32x16_bf16 v[64:79], v[96:99], a[104:107], v[64:79]
    ds_read_b64_tr_b16 v[96:97], v12 offset:24576
    ds_read_b64_tr_b16 v[98:99], v12 offset:25600
    v_mfma_f32_32x32x16_bf16 v[80:95], v[100:103], a[104:107], v[80:95]
    buffer_load_dwordx4 a[136:139], v2, s[36:39], s49 offen offset:2048 sc1
    ds_read_b64_tr_b16 v[100:101], v13 offset:24576
    ds_read_b64_tr_b16 v[102:103], v13 offset:25600
    s_waitcnt lgkmcnt(12)
    v_mfma_f32_32x32x16_bf16 v[32:47], v[112:115], a[168:171], v[32:47]
    ds_read_b64_tr_b16 v[112:113], v14 offset:40960
    ds_read_b64_tr_b16 v[114:115], v14 offset:41984
    s_add_u32 m0, s81, 0
    s_bfe_u32 s85, s70, s72
    s_lshl_b32 s85, s85, 15
    s_add_u32 s85, s85, s84
    v_mfma_f32_32x32x16_bf16 v[48:63], v[116:119], a[168:171], v[48:63]
    buffer_load_dwordx4 v8, s[44:47], s85 offen lds
    ds_read_b64_tr_b16 v[116:117], v15 offset:40960
    ds_read_b64_tr_b16 v[118:119], v15 offset:41984
    s_waitcnt vmcnt(12) lgkmcnt(12)
    v_mfma_f32_32x32x16_bf16 v[64:79], v[104:107], a[108:111], v[64:79]
    ds_read_b64_tr_b16 v[104:105], v12 offset:26624
    ds_read_b64_tr_b16 v[106:107], v12 offset:27648
    s_add_u32 m0, s81, 1024
    s_add_u32 s85, s85, 16384
    v_mfma_f32_32x32x16_bf16 v[80:95], v[108:111], a[108:111], v[80:95]
    buffer_load_dwordx4 v8, s[44:47], s85 offen lds
    ds_read_b64_tr_b16 v[108:109], v13 offset:26624
    ds_read_b64_tr_b16 v[110:111], v13 offset:27648
    s_waitcnt lgkmcnt(12)
    v_mfma_f32_32x32x16_bf16 v[32:47], v[120:123], a[172:175], v[32:47]
    ds_read_b64_tr_b16 v[120:121], v14 offset:43008
    ds_read_b64_tr_b16 v[122:123], v14 offset:44032
    s_add_u32 m0, s81, 65536
    s_bfe_u32 s86, s67, s74
    s_lshl_b32 s86, s86, 15
    s_add_u32 s86, s86, s80
    v_mfma_f32_32x32x16_bf16 v[48:63], v[124:127], a[172:175], v[48:63]
    buffer_load_dwordx4 v8, s[44:47], s86 offen lds
    ds_read_b64_tr_b16 v[124:125], v15 offset:43008
    ds_read_b64_tr_b16 v[126:127], v15 offset:44032
    s_waitcnt vmcnt(17)
    s_waitcnt vmcnt(15)
    s_barrier
    s_waitcnt vmcnt(13) lgkmcnt(12)
    v_mfma_f32_32x32x16_bf16 v[64:79], v[96:99], a[112:115], v[64:79]
    ds_read_b64_tr_b16 v[96:97], v12 offset:28672
    ds_read_b64_tr_b16 v[98:99], v12 offset:29696
    s_add_u32 m0, s81, 66560
    s_add_u32 s86, s86, 16384
    v_mfma_f32_32x32x16_bf16 v[80:95], v[100:103], a[112:115], v[80:95]
    buffer_load_dwordx4 v8, s[44:47], s86 offen lds
    ds_read_b64_tr_b16 v[100:101], v13 offset:28672
    ds_read_b64_tr_b16 v[102:103], v13 offset:29696
    s_waitcnt lgkmcnt(12)
    v_mfma_f32_32x32x16_bf16 v[32:47], v[112:115], a[176:179], v[32:47]
    ds_read_b64_tr_b16 v[112:113], v14 offset:45056
    ds_read_b64_tr_b16 v[114:115], v14 offset:46080
    v_mfma_f32_32x32x16_bf16 v[48:63], v[116:119], a[176:179], v[48:63]
    buffer_load_dwordx4 a[140:143], v2, s[36:39], s49 offen offset:3072 sc1
    ds_read_b64_tr_b16 v[116:117], v15 offset:45056
    ds_read_b64_tr_b16 v[118:119], v15 offset:46080
    s_waitcnt vmcnt(14) lgkmcnt(12)
    v_mfma_f32_32x32x16_bf16 v[64:79], v[104:107], a[116:119], v[64:79]
    ds_read_b64_tr_b16 v[104:105], v12 offset:30720
    ds_read_b64_tr_b16 v[106:107], v12 offset:31744
    s_bfe_u32 s49, s69, s75
    s_lshl_b32 s49, s49, 10
    v_mfma_f32_32x32x16_bf16 v[80:95], v[108:111], a[116:119], v[80:95]
    buffer_load_dwordx4 a[144:147], v2, s[36:39], s49 offen offset:0 sc1
    ds_read_b64_tr_b16 v[108:109], v13 offset:30720
    ds_read_b64_tr_b16 v[110:111], v13 offset:31744
    s_waitcnt lgkmcnt(12)
    v_mfma_f32_32x32x16_bf16 v[32:47], v[120:123], a[180:183], v[32:47]
    ds_read_b64_tr_b16 v[120:121], v14 offset:47104
    ds_read_b64_tr_b16 v[122:123], v14 offset:48128
    v_mfma_f32_32x32x16_bf16 v[48:63], v[124:127], a[180:183], v[48:63]
    buffer_load_dwordx4 a[148:151], v2, s[36:39], s49 offen offset:1024 sc1
    ds_read_b64_tr_b16 v[124:125], v15 offset:47104
    ds_read_b64_tr_b16 v[126:127], v15 offset:48128
    s_waitcnt vmcnt(15) lgkmcnt(12)
    v_mfma_f32_32x32x16_bf16 v[64:79], v[96:99], a[120:123], v[64:79]
    ds_read_b64_tr_b16 v[96:97], v12 offset:32768
    ds_read_b64_tr_b16 v[98:99], v12 offset:33792
    v_mfma_f32_32x32x16_bf16 v[80:95], v[100:103], a[120:123], v[80:95]
    buffer_load_dwordx4 a[152:155], v2, s[36:39], s49 offen offset:2048 sc1
    ds_read_b64_tr_b16 v[100:101], v13 offset:32768
    ds_read_b64_tr_b16 v[102:103], v13 offset:33792
    s_waitcnt lgkmcnt(12)
    v_mfma_f32_32x32x16_bf16 v[32:47], v[112:115], a[184:187], v[32:47]
    ds_read_b64_tr_b16 v[112:113], v14 offset:0
    ds_read_b64_tr_b16 v[114:115], v14 offset:1024
    s_add_u32 m0, s81, 8192
    s_bfe_u32 s85, s70, s73
    s_lshl_b32 s85, s85, 15
    s_add_u32 s85, s85, s84
    v_mfma_f32_32x32x16_bf16 v[48:63], v[116:119], a[184:187], v[48:63]
    buffer_load_dwordx4 v8, s[44:47], s85 offen lds
    ds_read_b64_tr_b16 v[116:117], v15 offset:0
    ds_read_b64_tr_b16 v[118:119], v15 offset:1024
    s_waitcnt vmcnt(12) lgkmcnt(12)
    v_mfma_f32_32x32x16_bf16 v[64:79], v[104:107], a[124:127], v[64:79]
    ds_read_b64_tr_b16 v[104:105], v12 offset:34816
    ds_read_b64_tr_b16 v[106:107], v12 offset:35840
    s_add_u32 m0, s81, 9216
    s_add_u32 s85, s85, 16384
    v_mfma_f32_32x32x16_bf16 v[80:95], v[108:111], a[124:127], v[80:95]
    buffer_load_dwordx4 v8, s[44:47], s85 offen lds
    ds_read_b64_tr_b16 v[108:109], v13 offset:34816
    ds_read_b64_tr_b16 v[110:111], v13 offset:35840
    s_waitcnt lgkmcnt(12)
    v_mfma_f32_32x32x16_bf16 v[32:47], v[120:123], a[188:191], v[32:47]
    ds_read_b64_tr_b16 v[120:121], v14 offset:2048
    ds_read_b64_tr_b16 v[122:123], v14 offset:3072
    s_add_u32 m0, s81, 73728
    s_bfe_u32 s86, s67, s75
    s_lshl_b32 s86, s86, 15
    s_add_u32 s86, s86, s80
    v_mfma_f32_32x32x16_bf16 v[48:63], v[124:127], a[188:191], v[48:63]
    buffer_load_dwordx4 v8, s[44:47], s86 offen lds
    ds_read_b64_tr_b16 v[124:125], v15 offset:2048
    ds_read_b64_tr_b16 v[126:127], v15 offset:3072
    s_waitcnt vmcnt(17)
    s_waitcnt vmcnt(15)
    s_barrier
    s_waitcnt vmcnt(13) lgkmcnt(12)
    v_mfma_f32_32x32x16_bf16 v[64:79], v[96:99], a[128:131], v[64:79]
    ds_read_b64_tr_b16 v[96:97], v12 offset:36864
    ds_read_b64_tr_b16 v[98:99], v12 offset:37888
    s_add_u32 m0, s81, 74752
    s_add_u32 s86, s86, 16384
    v_mfma_f32_32x32x16_bf16 v[80:95], v[100:103], a[128:131], v[80:95]
    buffer_load_dwordx4 v8, s[44:47], s86 offen lds
    ds_read_b64_tr_b16 v[100:101], v13 offset:36864
    ds_read_b64_tr_b16 v[102:103], v13 offset:37888
    s_waitcnt lgkmcnt(12)
    v_mfma_f32_32x32x16_bf16 v[32:47], v[112:115], a[192:195], v[32:47]
    ds_read_b64_tr_b16 v[112:113], v14 offset:4096
    ds_read_b64_tr_b16 v[114:115], v14 offset:5120
    v_mfma_f32_32x32x16_bf16 v[48:63], v[116:119], a[192:195], v[48:63]
    buffer_load_dwordx4 a[156:159], v2, s[36:39], s49 offen offset:3072 sc1
    ds_read_b64_tr_b16 v[116:117], v15 offset:4096
    ds_read_b64_tr_b16 v[118:119], v15 offset:5120
    s_waitcnt vmcnt(14) lgkmcnt(12)
    v_mfma_f32_32x32x16_bf16 v[64:79], v[104:107], a[132:135], v[64:79]
    ds_read_b64_tr_b16 v[104:105], v12 offset:38912
    ds_read_b64_tr_b16 v[106:107], v12 offset:39936
    s_bfe_u32 s49, s70, s72
    s_lshl_b32 s49, s49, 10
    v_mfma_f32_32x32x16_bf16 v[80:95], v[108:111], a[132:135], v[80:95]
    buffer_load_dwordx4 a[160:163], v2, s[36:39], s49 offen offset:0 sc1
    ds_read_b64_tr_b16 v[108:109], v13 offset:38912
    ds_read_b64_tr_b16 v[110:111], v13 offset:39936
    s_waitcnt lgkmcnt(12)
    v_mfma_f32_32x32x16_bf16 v[32:47], v[120:123], a[196:199], v[32:47]
    ds_read_b64_tr_b16 v[120:121], v14 offset:6144
    ds_read_b64_tr_b16 v[122:123], v14 offset:7168
    v_mfma_f32_32x32x16_bf16 v[48:63], v[124:127], a[196:199], v[48:63]
    buffer_load_dwordx4 a[164:167], v2, s[36:39], s49 offen offset:1024 sc1
    ds_read_b64_tr_b16 v[124:125], v15 offset:6144
    ds_read_b64_tr_b16 v[126:127], v15 offset:7168
    s_waitcnt vmcnt(15) lgkmcnt(12)
    v_mfma_f32_32x32x16_bf16 v[64:79], v[96:99], a[136:139], v[64:79]
    ds_read_b64_tr_b16 v[96:97], v12 offset:40960
    ds_read_b64_tr_b16 v[98:99], v12 offset:41984
    v_mfma_f32_32x32x16_bf16 v[80:95], v[100:103], a[136:139], v[80:95]
    buffer_load_dwordx4 a[168:171], v2, s[36:39], s49 offen offset:2048 sc1
    ds_read_b64_tr_b16 v[100:101], v13 offset:40960
    ds_read_b64_tr_b16 v[102:103], v13 offset:41984
    s_waitcnt lgkmcnt(12)
    v_mfma_f32_32x32x16_bf16 v[32:47], v[112:115], a[200:203], v[32:47]
    ds_read_b64_tr_b16 v[112:113], v14 offset:8192
    ds_read_b64_tr_b16 v[114:115], v14 offset:9216
    s_add_u32 m0, s81, 16384
    s_bfe_u32 s85, s70, s74
    s_lshl_b32 s85, s85, 15
    s_add_u32 s85, s85, s84
    v_mfma_f32_32x32x16_bf16 v[48:63], v[116:119], a[200:203], v[48:63]
    buffer_load_dwordx4 v8, s[44:47], s85 offen lds
    ds_read_b64_tr_b16 v[116:117], v15 offset:8192
    ds_read_b64_tr_b16 v[118:119], v15 offset:9216
    s_waitcnt vmcnt(12) lgkmcnt(12)
    v_mfma_f32_32x32x16_bf16 v[64:79], v[104:107], a[140:143], v[64:79]
    ds_read_b64_tr_b16 v[104:105], v12 offset:43008
    ds_read_b64_tr_b16 v[106:107], v12 offset:44032
    s_add_u32 m0, s81, 17408
    s_add_u32 s85, s85, 16384
    v_mfma_f32_32x32x16_bf16 v[80:95], v[108:111], a[140:143], v[80:95]
    buffer_load_dwordx4 v8, s[44:47], s85 offen lds
    ds_read_b64_tr_b16 v[108:109], v13 offset:43008
    ds_read_b64_tr_b16 v[110:111], v13 offset:44032
    s_waitcnt lgkmcnt(12)
    v_mfma_f32_32x32x16_bf16 v[32:47], v[120:123], a[204:207], v[32:47]
    ds_read_b64_tr_b16 v[120:121], v14 offset:10240
    ds_read_b64_tr_b16 v[122:123], v14 offset:11264
    s_add_u32 m0, s81, 81920
    s_bfe_u32 s86, s68, s72
    s_lshl_b32 s86, s86, 15
    s_add_u32 s86, s86, s80
    v_mfma_f32_32x32x16_bf16 v[48:63], v[124:127], a[204:207], v[48:63]
    buffer_load_dwordx4 v8, s[44:47], s86 offen lds
    ds_read_b64_tr_b16 v[124:125], v15 offset:10240
    ds_read_b64_tr_b16 v[126:127], v15 offset:11264
    s_waitcnt vmcnt(17)
    s_waitcnt vmcnt(15)
    s_barrier
    s_waitcnt vmcnt(13) lgkmcnt(12)
    v_mfma_f32_32x32x16_bf16 v[64:79], v[96:99], a[144:147], v[64:79]
    ds_read_b64_tr_b16 v[96:97], v12 offset:45056
    ds_read_b64_tr_b16 v[98:99], v12 offset:46080
    s_add_u32 m0, s81, 82944
    s_add_u32 s86, s86, 16384
    v_mfma_f32_32x32x16_bf16 v[80:95], v[100:103], a[144:147], v[80:95]
    buffer_load_dwordx4 v8, s[44:47], s86 offen lds
    ds_read_b64_tr_b16 v[100:101], v13 offset:45056
    ds_read_b64_tr_b16 v[102:103], v13 offset:46080
    s_waitcnt lgkmcnt(12)
    v_mfma_f32_32x32x16_bf16 v[32:47], v[112:115], a[208:211], v[32:47]
    ds_read_b64_tr_b16 v[112:113], v14 offset:12288
    ds_read_b64_tr_b16 v[114:115], v14 offset:13312
    v_mfma_f32_32x32x16_bf16 v[48:63], v[116:119], a[208:211], v[48:63]
    buffer_load_dwordx4 a[172:175], v2, s[36:39], s49 offen offset:3072 sc1
    ds_read_b64_tr_b16 v[116:117], v15 offset:12288
    ds_read_b64_tr_b16 v[118:119], v15 offset:13312
    s_waitcnt vmcnt(14) lgkmcnt(12)
    v_mfma_f32_32x32x16_bf16 v[64:79], v[104:107], a[148:151], v[64:79]
    ds_read_b64_tr_b16 v[104:105], v12 offset:47104
    ds_read_b64_tr_b16 v[106:107], v12 offset:48128
    s_bfe_u32 s49, s70, s73
    s_lshl_b32 s49, s49, 10
    v_mfma_f32_32x32x16_bf16 v[80:95], v[108:111], a[148:151], v[80:95]
    buffer_load_dwordx4 a[176:179], v2, s[36:39], s49 offen offset:0 sc1
    ds_read_b64_tr_b16 v[108:109], v13 offset:47104
    ds_read_b64_tr_b16 v[110:111], v13 offset:48128
    s_waitcnt lgkmcnt(12)
    v_mfma_f32_32x32x16_bf16 v[32:47], v[120:123], a[212:215], v[32:47]
    ds_read_b64_tr_b16 v[120:121], v14 offset:14336
    ds_read_b64_tr_b16 v[122:123], v14 offset:15360
    v_mfma_f32_32x32x16_bf16 v[48:63], v[124:127], a[212:215], v[48:63]
    buffer_load_dwordx4 a[180:183], v2, s[36:39], s49 offen offset:1024 sc1
    ds_read_b64_tr_b16 v[124:125], v15 offset:14336
    ds_read_b64_tr_b16 v[126:127], v15 offset:15360
    s_waitcnt vmcnt(15) lgkmcnt(12)
    v_mfma_f32_32x32x16_bf16 v[64:79], v[96:99], a[152:155], v[64:79]
    ds_read_b64_tr_b16 v[96:97], v12 offset:0
    ds_read_b64_tr_b16 v[98:99], v12 offset:1024
    v_mfma_f32_32x32x16_bf16 v[80:95], v[100:103], a[152:155], v[80:95]
    buffer_load_dwordx4 a[184:187], v2, s[36:39], s49 offen offset:2048 sc1
    ds_read_b64_tr_b16 v[100:101], v13 offset:0
    ds_read_b64_tr_b16 v[102:103], v13 offset:1024
    s_waitcnt lgkmcnt(12)
    v_mfma_f32_32x32x16_bf16 v[32:47], v[112:115], a[216:219], v[32:47]
    ds_read_b64_tr_b16 v[112:113], v14 offset:16384
    ds_read_b64_tr_b16 v[114:115], v14 offset:17408
    s_add_u32 m0, s81, 24576
    s_bfe_u32 s85, s70, s75
    s_lshl_b32 s85, s85, 15
    s_add_u32 s85, s85, s84
    v_mfma_f32_32x32x16_bf16 v[48:63], v[116:119], a[216:219], v[48:63]
    buffer_load_dwordx4 v8, s[44:47], s85 offen lds
    ds_read_b64_tr_b16 v[116:117], v15 offset:16384
    ds_read_b64_tr_b16 v[118:119], v15 offset:17408
    s_waitcnt vmcnt(12) lgkmcnt(12)
    v_mfma_f32_32x32x16_bf16 v[64:79], v[104:107], a[156:159], v[64:79]
    ds_read_b64_tr_b16 v[104:105], v12 offset:2048
    ds_read_b64_tr_b16 v[106:107], v12 offset:3072
    s_add_u32 m0, s81, 25600
    s_add_u32 s85, s85, 16384
    v_mfma_f32_32x32x16_bf16 v[80:95], v[108:111], a[156:159], v[80:95]
    buffer_load_dwordx4 v8, s[44:47], s85 offen lds
    ds_read_b64_tr_b16 v[108:109], v13 offset:2048
    ds_read_b64_tr_b16 v[110:111], v13 offset:3072
    s_waitcnt lgkmcnt(12)
    v_mfma_f32_32x32x16_bf16 v[32:47], v[120:123], a[220:223], v[32:47]
    ds_read_b64_tr_b16 v[120:121], v14 offset:18432
    ds_read_b64_tr_b16 v[122:123], v14 offset:19456
    s_add_u32 m0, s81, 90112
    s_bfe_u32 s86, s68, s73
    s_lshl_b32 s86, s86, 15
    s_add_u32 s86, s86, s80
    v_mfma_f32_32x32x16_bf16 v[48:63], v[124:127], a[220:223], v[48:63]
    buffer_load_dwordx4 v8, s[44:47], s86 offen lds
    ds_read_b64_tr_b16 v[124:125], v15 offset:18432
    ds_read_b64_tr_b16 v[126:127], v15 offset:19456
    s_waitcnt vmcnt(17)
    s_waitcnt vmcnt(15)
    s_barrier
    s_waitcnt vmcnt(13) lgkmcnt(12)
    v_mfma_f32_32x32x16_bf16 v[64:79], v[96:99], a[160:163], v[64:79]
    ds_read_b64_tr_b16 v[96:97], v12 offset:4096
    ds_read_b64_tr_b16 v[98:99], v12 offset:5120
    s_add_u32 m0, s81, 91136
    s_add_u32 s86, s86, 16384
    v_mfma_f32_32x32x16_bf16 v[80:95], v[100:103], a[160:163], v[80:95]
    buffer_load_dwordx4 v8, s[44:47], s86 offen lds
    ds_read_b64_tr_b16 v[100:101], v13 offset:4096
    ds_read_b64_tr_b16 v[102:103], v13 offset:5120
    s_waitcnt lgkmcnt(12)
    v_mfma_f32_32x32x16_bf16 v[32:47], v[112:115], a[0:3], v[32:47]
    ds_read_b64_tr_b16 v[112:113], v14 offset:20480
    ds_read_b64_tr_b16 v[114:115], v14 offset:21504
    v_mfma_f32_32x32x16_bf16 v[48:63], v[116:119], a[0:3], v[48:63]
    buffer_load_dwordx4 a[188:191], v2, s[36:39], s49 offen offset:3072 sc1
    ds_read_b64_tr_b16 v[116:117], v15 offset:20480
    ds_read_b64_tr_b16 v[118:119], v15 offset:21504
    s_waitcnt vmcnt(14) lgkmcnt(12)
    v_mfma_f32_32x32x16_bf16 v[64:79], v[104:107], a[164:167], v[64:79]
    ds_read_b64_tr_b16 v[104:105], v12 offset:6144
    ds_read_b64_tr_b16 v[106:107], v12 offset:7168
    s_bfe_u32 s49, s70, s74
    s_lshl_b32 s49, s49, 10
    v_mfma_f32_32x32x16_bf16 v[80:95], v[108:111], a[164:167], v[80:95]
    buffer_load_dwordx4 a[192:195], v2, s[36:39], s49 offen offset:0 sc1
    ds_read_b64_tr_b16 v[108:109], v13 offset:6144
    ds_read_b64_tr_b16 v[110:111], v13 offset:7168
    s_waitcnt lgkmcnt(12)
    v_mfma_f32_32x32x16_bf16 v[32:47], v[120:123], a[4:7], v[32:47]
    ds_read_b64_tr_b16 v[120:121], v14 offset:22528
    ds_read_b64_tr_b16 v[122:123], v14 offset:23552
    v_mfma_f32_32x32x16_bf16 v[48:63], v[124:127], a[4:7], v[48:63]
    buffer_load_dwordx4 a[196:199], v2, s[36:39], s49 offen offset:1024 sc1
    ds_read_b64_tr_b16 v[124:125], v15 offset:22528
    ds_read_b64_tr_b16 v[126:127], v15 offset:23552
    s_waitcnt vmcnt(15) lgkmcnt(12)
    v_mfma_f32_32x32x16_bf16 v[64:79], v[96:99], a[168:171], v[64:79]
    ds_read_b64_tr_b16 v[96:97], v12 offset:8192
    ds_read_b64_tr_b16 v[98:99], v12 offset:9216
    v_mfma_f32_32x32x16_bf16 v[80:95], v[100:103], a[168:171], v[80:95]
    buffer_load_dwordx4 a[200:203], v2, s[36:39], s49 offen offset:2048 sc1
    ds_read_b64_tr_b16 v[100:101], v13 offset:8192
    ds_read_b64_tr_b16 v[102:103], v13 offset:9216
    s_waitcnt lgkmcnt(12)
    v_mfma_f32_32x32x16_bf16 v[32:47], v[112:115], a[8:11], v[32:47]
    ds_read_b64_tr_b16 v[112:113], v14 offset:24576
    ds_read_b64_tr_b16 v[114:115], v14 offset:25600
    s_add_u32 m0, s81, 49152
    s_bfe_u32 s86, s68, s74
    s_lshl_b32 s86, s86, 15
    s_add_u32 s86, s86, s80
    v_mfma_f32_32x32x16_bf16 v[48:63], v[116:119], a[8:11], v[48:63]
    buffer_load_dwordx4 v8, s[44:47], s86 offen lds
    ds_read_b64_tr_b16 v[116:117], v15 offset:24576
    ds_read_b64_tr_b16 v[118:119], v15 offset:25600
    s_waitcnt vmcnt(12) lgkmcnt(12)
    v_mfma_f32_32x32x16_bf16 v[64:79], v[104:107], a[172:175], v[64:79]
    ds_read_b64_tr_b16 v[104:105], v12 offset:10240
    ds_read_b64_tr_b16 v[106:107], v12 offset:11264
    s_add_u32 m0, s81, 50176
    s_add_u32 s86, s86, 16384
    v_mfma_f32_32x32x16_bf16 v[80:95], v[108:111], a[172:175], v[80:95]
    buffer_load_dwordx4 v8, s[44:47], s86 offen lds
    ds_read_b64_tr_b16 v[108:109], v13 offset:10240
    ds_read_b64_tr_b16 v[110:111], v13 offset:11264
    s_waitcnt lgkmcnt(12)
    v_mfma_f32_32x32x16_bf16 v[32:47], v[120:123], a[12:15], v[32:47]
    ds_read_b64_tr_b16 v[120:121], v14 offset:26624
    ds_read_b64_tr_b16 v[122:123], v14 offset:27648
    v_mfma_f32_32x32x16_bf16 v[48:63], v[124:127], a[12:15], v[48:63]
    buffer_load_dwordx4 a[204:207], v2, s[36:39], s49 offen offset:3072 sc1
    ds_read_b64_tr_b16 v[124:125], v15 offset:26624
    ds_read_b64_tr_b16 v[126:127], v15 offset:27648
    s_waitcnt vmcnt(17)
    s_waitcnt vmcnt(15)
    s_barrier
    s_waitcnt vmcnt(13) lgkmcnt(12)
    v_mfma_f32_32x32x16_bf16 v[64:79], v[96:99], a[176:179], v[64:79]
    ds_read_b64_tr_b16 v[96:97], v12 offset:12288
    ds_read_b64_tr_b16 v[98:99], v12 offset:13312
    s_bfe_u32 s49, s70, s75
    s_lshl_b32 s49, s49, 10
    v_mfma_f32_32x32x16_bf16 v[80:95], v[100:103], a[176:179], v[80:95]
    buffer_load_dwordx4 a[208:211], v2, s[36:39], s49 offen offset:0 sc1
    ds_read_b64_tr_b16 v[100:101], v13 offset:12288
    ds_read_b64_tr_b16 v[102:103], v13 offset:13312
    s_waitcnt lgkmcnt(12)
    v_mfma_f32_32x32x16_bf16 v[32:47], v[112:115], a[16:19], v[32:47]
    ds_read_b64_tr_b16 v[112:113], v14 offset:28672
    ds_read_b64_tr_b16 v[114:115], v14 offset:29696
    v_mfma_f32_32x32x16_bf16 v[48:63], v[116:119], a[16:19], v[48:63]
    buffer_load_dwordx4 a[212:215], v2, s[36:39], s49 offen offset:1024 sc1
    ds_read_b64_tr_b16 v[116:117], v15 offset:28672
    ds_read_b64_tr_b16 v[118:119], v15 offset:29696
    s_waitcnt vmcnt(14) lgkmcnt(12)
    v_mfma_f32_32x32x16_bf16 v[64:79], v[104:107], a[180:183], v[64:79]
    ds_read_b64_tr_b16 v[104:105], v12 offset:14336
    ds_read_b64_tr_b16 v[106:107], v12 offset:15360
    v_mfma_f32_32x32x16_bf16 v[80:95], v[108:111], a[180:183], v[80:95]
    buffer_load_dwordx4 a[216:219], v2, s[36:39], s49 offen offset:2048 sc1
    ds_read_b64_tr_b16 v[108:109], v13 offset:14336
    ds_read_b64_tr_b16 v[110:111], v13 offset:15360
    s_waitcnt lgkmcnt(12)
    v_mfma_f32_32x32x16_bf16 v[32:47], v[120:123], a[20:23], v[32:47]
    ds_read_b64_tr_b16 v[120:121], v14 offset:30720
    ds_read_b64_tr_b16 v[122:123], v14 offset:31744
    s_add_u32 m0, s81, 57344
    s_bfe_u32 s86, s68, s75
    s_lshl_b32 s86, s86, 15
    s_add_u32 s86, s86, s80
    v_mfma_f32_32x32x16_bf16 v[48:63], v[124:127], a[20:23], v[48:63]
    buffer_load_dwordx4 v8, s[44:47], s86 offen lds
    ds_read_b64_tr_b16 v[124:125], v15 offset:30720
    ds_read_b64_tr_b16 v[126:127], v15 offset:31744
    s_waitcnt vmcnt(15) lgkmcnt(12)
    v_mfma_f32_32x32x16_bf16 v[64:79], v[96:99], a[184:187], v[64:79]
    ds_read_b64_tr_b16 v[96:97], v12 offset:16384
    ds_read_b64_tr_b16 v[98:99], v12 offset:17408
    s_add_u32 m0, s81, 58368
    s_add_u32 s86, s86, 16384
    v_mfma_f32_32x32x16_bf16 v[80:95], v[100:103], a[184:187], v[80:95]
    buffer_load_dwordx4 v8, s[44:47], s86 offen lds
    ds_read_b64_tr_b16 v[100:101], v13 offset:16384
    ds_read_b64_tr_b16 v[102:103], v13 offset:17408
    s_waitcnt lgkmcnt(12)
    v_mfma_f32_32x32x16_bf16 v[32:47], v[112:115], a[24:27], v[32:47]
    ds_read_b64_tr_b16 v[112:113], v14 offset:32768
    ds_read_b64_tr_b16 v[114:115], v14 offset:33792
    v_mfma_f32_32x32x16_bf16 v[48:63], v[116:119], a[24:27], v[48:63]
    buffer_load_dwordx4 a[220:223], v2, s[36:39], s49 offen offset:3072 sc1
    ds_read_b64_tr_b16 v[116:117], v15 offset:32768
    ds_read_b64_tr_b16 v[118:119], v15 offset:33792
    s_waitcnt vmcnt(12) lgkmcnt(12)
    v_mfma_f32_32x32x16_bf16 v[64:79], v[104:107], a[188:191], v[64:79]
    ds_read_b64_tr_b16 v[104:105], v12 offset:18432
    ds_read_b64_tr_b16 v[106:107], v12 offset:19456
    s_add_u32 m0, s81, 65536
    s_bfe_u32 s86, s69, s72
    s_lshl_b32 s86, s86, 15
    s_add_u32 s86, s86, s80
    v_mfma_f32_32x32x16_bf16 v[80:95], v[108:111], a[188:191], v[80:95]
    buffer_load_dwordx4 v8, s[44:47], s86 offen lds
    ds_read_b64_tr_b16 v[108:109], v13 offset:18432
    ds_read_b64_tr_b16 v[110:111], v13 offset:19456
    s_waitcnt lgkmcnt(12)
    v_mfma_f32_32x32x16_bf16 v[32:47], v[120:123], a[28:31], v[32:47]
    ds_read_b64_tr_b16 v[120:121], v14 offset:34816
    ds_read_b64_tr_b16 v[122:123], v14 offset:35840
    s_add_u32 m0, s81, 66560
    s_add_u32 s86, s86, 16384
    v_mfma_f32_32x32x16_bf16 v[48:63], v[124:127], a[28:31], v[48:63]
    buffer_load_dwordx4 v8, s[44:47], s86 offen lds
    ds_read_b64_tr_b16 v[124:125], v15 offset:34816
    ds_read_b64_tr_b16 v[126:127], v15 offset:35840
    s_waitcnt vmcnt(17)
    s_waitcnt vmcnt(15)
    s_barrier
    s_waitcnt vmcnt(13) lgkmcnt(12)
    v_mfma_f32_32x32x16_bf16 v[64:79], v[96:99], a[192:195], v[64:79]
    ds_read_b64_tr_b16 v[96:97], v12 offset:20480
    ds_read_b64_tr_b16 v[98:99], v12 offset:21504
    v_mfma_f32_32x32x16_bf16 v[80:95], v[100:103], a[192:195], v[80:95]
    ds_read_b64_tr_b16 v[100:101], v13 offset:20480
    ds_read_b64_tr_b16 v[102:103], v13 offset:21504
    s_waitcnt lgkmcnt(12)
    v_mfma_f32_32x32x16_bf16 v[32:47], v[112:115], a[32:35], v[32:47]
    ds_read_b64_tr_b16 v[112:113], v14 offset:36864
    ds_read_b64_tr_b16 v[114:115], v14 offset:37888
    s_add_u32 m0, s81, 73728
    s_bfe_u32 s86, s69, s73
    s_lshl_b32 s86, s86, 15
    s_add_u32 s86, s86, s80
    v_mfma_f32_32x32x16_bf16 v[48:63], v[116:119], a[32:35], v[48:63]
    buffer_load_dwordx4 v8, s[44:47], s86 offen lds
    ds_read_b64_tr_b16 v[116:117], v15 offset:36864
    ds_read_b64_tr_b16 v[118:119], v15 offset:37888
    s_waitcnt vmcnt(13) lgkmcnt(12)
    v_mfma_f32_32x32x16_bf16 v[64:79], v[104:107], a[196:199], v[64:79]
    ds_read_b64_tr_b16 v[104:105], v12 offset:22528
    ds_read_b64_tr_b16 v[106:107], v12 offset:23552
    s_add_u32 m0, s81, 74752
    s_add_u32 s86, s86, 16384
    v_mfma_f32_32x32x16_bf16 v[80:95], v[108:111], a[196:199], v[80:95]
    buffer_load_dwordx4 v8, s[44:47], s86 offen lds
    ds_read_b64_tr_b16 v[108:109], v13 offset:22528
    ds_read_b64_tr_b16 v[110:111], v13 offset:23552
    s_waitcnt lgkmcnt(12)
    v_mfma_f32_32x32x16_bf16 v[32:47], v[120:123], a[36:39], v[32:47]
    ds_read_b64_tr_b16 v[120:121], v14 offset:38912
    ds_read_b64_tr_b16 v[122:123], v14 offset:39936
    v_mfma_f32_32x32x16_bf16 v[48:63], v[124:127], a[36:39], v[48:63]
    ds_read_b64_tr_b16 v[124:125], v15 offset:38912
    ds_read_b64_tr_b16 v[126:127], v15 offset:39936
    s_waitcnt vmcnt(13) lgkmcnt(12)
    v_mfma_f32_32x32x16_bf16 v[64:79], v[96:99], a[200:203], v[64:79]
    ds_read_b64_tr_b16 v[96:97], v12 offset:24576
    ds_read_b64_tr_b16 v[98:99], v12 offset:25600
    v_mfma_f32_32x32x16_bf16 v[80:95], v[100:103], a[200:203], v[80:95]
    ds_read_b64_tr_b16 v[100:101], v13 offset:24576
    ds_read_b64_tr_b16 v[102:103], v13 offset:25600
    s_waitcnt lgkmcnt(12)
    v_mfma_f32_32x32x16_bf16 v[32:47], v[112:115], a[40:43], v[32:47]
    ds_read_b64_tr_b16 v[112:113], v14 offset:40960
    ds_read_b64_tr_b16 v[114:115], v14 offset:41984
    v_mfma_f32_32x32x16_bf16 v[48:63], v[116:119], a[40:43], v[48:63]
    ds_read_b64_tr_b16 v[116:117], v15 offset:40960
    ds_read_b64_tr_b16 v[118:119], v15 offset:41984
    s_waitcnt vmcnt(10) lgkmcnt(12)
    v_mfma_f32_32x32x16_bf16 v[64:79], v[104:107], a[204:207], v[64:79]
    ds_read_b64_tr_b16 v[104:105], v12 offset:26624
    ds_read_b64_tr_b16 v[106:107], v12 offset:27648
    v_mfma_f32_32x32x16_bf16 v[80:95], v[108:111], a[204:207], v[80:95]
    ds_read_b64_tr_b16 v[108:109], v13 offset:26624
    ds_read_b64_tr_b16 v[110:111], v13 offset:27648
    s_waitcnt lgkmcnt(12)
    v_mfma_f32_32x32x16_bf16 v[32:47], v[120:123], a[44:47], v[32:47]
    ds_read_b64_tr_b16 v[120:121], v14 offset:43008
    ds_read_b64_tr_b16 v[122:123], v14 offset:44032
    v_mfma_f32_32x32x16_bf16 v[48:63], v[124:127], a[44:47], v[48:63]
    ds_read_b64_tr_b16 v[124:125], v15 offset:43008
    ds_read_b64_tr_b16 v[126:127], v15 offset:44032
    s_waitcnt vmcnt(11)
    s_barrier
    s_waitcnt vmcnt(9) lgkmcnt(12)
    v_mfma_f32_32x32x16_bf16 v[64:79], v[96:99], a[208:211], v[64:79]
    ds_read_b64_tr_b16 v[96:97], v12 offset:28672
    ds_read_b64_tr_b16 v[98:99], v12 offset:29696
    v_mfma_f32_32x32x16_bf16 v[80:95], v[100:103], a[208:211], v[80:95]
    ds_read_b64_tr_b16 v[100:101], v13 offset:28672
    ds_read_b64_tr_b16 v[102:103], v13 offset:29696
    s_waitcnt lgkmcnt(12)
    v_mfma_f32_32x32x16_bf16 v[32:47], v[112:115], a[48:51], v[32:47]
    ds_read_b64_tr_b16 v[112:113], v14 offset:45056
    ds_read_b64_tr_b16 v[114:115], v14 offset:46080
    s_add_u32 m0, s81, 81920
    s_bfe_u32 s86, s69, s74
    s_lshl_b32 s86, s86, 15
    s_add_u32 s86, s86, s80
    v_mfma_f32_32x32x16_bf16 v[48:63], v[116:119], a[48:51], v[48:63]
    buffer_load_dwordx4 v8, s[44:47], s86 offen lds
    ds_read_b64_tr_b16 v[116:117], v15 offset:45056
    ds_read_b64_tr_b16 v[118:119], v15 offset:46080
    s_waitcnt vmcnt(9) lgkmcnt(12)
    v_mfma_f32_32x32x16_bf16 v[64:79], v[104:107], a[212:215], v[64:79]
    ds_read_b64_tr_b16 v[104:105], v12 offset:30720
    ds_read_b64_tr_b16 v[106:107], v12 offset:31744
    s_add_u32 m0, s81, 82944
    s_add_u32 s86, s86, 16384
    v_mfma_f32_32x32x16_bf16 v[80:95], v[108:111], a[212:215], v[80:95]
    buffer_load_dwordx4 v8, s[44:47], s86 offen lds
    ds_read_b64_tr_b16 v[108:109], v13 offset:30720
    ds_read_b64_tr_b16 v[110:111], v13 offset:31744
    s_waitcnt lgkmcnt(12)
    v_mfma_f32_32x32x16_bf16 v[32:47], v[120:123], a[52:55], v[32:47]
    ds_read_b64_tr_b16 v[120:121], v14 offset:47104
    ds_read_b64_tr_b16 v[122:123], v14 offset:48128
    v_mfma_f32_32x32x16_bf16 v[48:63], v[124:127], a[52:55], v[48:63]
    ds_read_b64_tr_b16 v[124:125], v15 offset:47104
    ds_read_b64_tr_b16 v[126:127], v15 offset:48128
    s_waitcnt vmcnt(9) lgkmcnt(12)
    v_mfma_f32_32x32x16_bf16 v[64:79], v[96:99], a[216:219], v[64:79]
    v_mfma_f32_32x32x16_bf16 v[80:95], v[100:103], a[216:219], v[80:95]
    s_waitcnt lgkmcnt(8)
    v_mfma_f32_32x32x16_bf16 v[32:47], v[112:115], a[56:59], v[32:47]
    ds_read_b64_tr_b16 v[112:113], v14 offset:0
    ds_read_b64_tr_b16 v[114:115], v14 offset:1024
    v_mfma_f32_32x32x16_bf16 v[48:63], v[116:119], a[56:59], v[48:63]
    ds_read_b64_tr_b16 v[116:117], v15 offset:0
    ds_read_b64_tr_b16 v[118:119], v15 offset:1024
    s_waitcnt vmcnt(6) lgkmcnt(8)
    v_mfma_f32_32x32x16_bf16 v[64:79], v[104:107], a[220:223], v[64:79]
    v_mfma_f32_32x32x16_bf16 v[80:95], v[108:111], a[220:223], v[80:95]
    s_waitcnt lgkmcnt(4)
    v_mfma_f32_32x32x16_bf16 v[32:47], v[120:123], a[60:63], v[32:47]
    ds_read_b64_tr_b16 v[120:121], v14 offset:2048
    ds_read_b64_tr_b16 v[122:123], v14 offset:3072
    v_mfma_f32_32x32x16_bf16 v[48:63], v[124:127], a[60:63], v[48:63]
    ds_read_b64_tr_b16 v[124:125], v15 offset:2048
    ds_read_b64_tr_b16 v[126:127], v15 offset:3072
    s_waitcnt vmcnt(7)
    s_barrier
    s_waitcnt lgkmcnt(4)
    v_mfma_f32_32x32x16_bf16 v[32:47], v[112:115], a[64:67], v[32:47]
    ds_read_b64_tr_b16 v[112:113], v14 offset:4096
    ds_read_b64_tr_b16 v[114:115], v14 offset:5120
    s_add_u32 m0, s81, 90112
    s_bfe_u32 s86, s69, s75
    s_lshl_b32 s86, s86, 15
    s_add_u32 s86, s86, s80
    buffer_store_dwordx4 v[64:67], v2, s[32:35], s88 offen offset:0 sc1
    v_mfma_f32_32x32x16_bf16 v[48:63], v[116:119], a[64:67], v[48:63]
    buffer_load_dwordx4 v8, s[44:47], s86 offen lds
    ds_read_b64_tr_b16 v[116:117], v15 offset:4096
    ds_read_b64_tr_b16 v[118:119], v15 offset:5120
    buffer_store_dwordx4 v[68:71], v2, s[32:35], s88 offen offset:1024 sc1
    s_waitcnt lgkmcnt(4)
    v_mfma_f32_32x32x16_bf16 v[32:47], v[120:123], a[68:71], v[32:47]
    ds_read_b64_tr_b16 v[120:121], v14 offset:6144
    ds_read_b64_tr_b16 v[122:123], v14 offset:7168
    s_add_u32 m0, s81, 91136
    s_add_u32 s86, s86, 16384
    buffer_store_dwordx4 v[72:75], v2, s[32:35], s88 offen offset:2048 sc1
    v_mfma_f32_32x32x16_bf16 v[48:63], v[124:127], a[68:71], v[48:63]
    buffer_load_dwordx4 v8, s[44:47], s86 offen lds
    ds_read_b64_tr_b16 v[124:125], v15 offset:6144
    ds_read_b64_tr_b16 v[126:127], v15 offset:7168
    buffer_store_dwordx4 v[76:79], v2, s[32:35], s88 offen offset:3072 sc1
    s_waitcnt lgkmcnt(4)
    v_mfma_f32_32x32x16_bf16 v[32:47], v[112:115], a[72:75], v[32:47]
    ds_read_b64_tr_b16 v[112:113], v14 offset:8192
    ds_read_b64_tr_b16 v[114:115], v14 offset:9216
    s_add_u32 s88, s88, 4096
    buffer_store_dwordx4 v[80:83], v2, s[32:35], s88 offen offset:0 sc1
    v_mfma_f32_32x32x16_bf16 v[48:63], v[116:119], a[72:75], v[48:63]
    ds_read_b64_tr_b16 v[116:117], v15 offset:8192
    ds_read_b64_tr_b16 v[118:119], v15 offset:9216
    buffer_store_dwordx4 v[84:87], v2, s[32:35], s88 offen offset:1024 sc1
    s_waitcnt lgkmcnt(4)
    v_mfma_f32_32x32x16_bf16 v[32:47], v[120:123], a[76:79], v[32:47]
    ds_read_b64_tr_b16 v[120:121], v14 offset:10240
    ds_read_b64_tr_b16 v[122:123], v14 offset:11264
    buffer_store_dwordx4 v[88:91], v2, s[32:35], s88 offen offset:2048 sc1
    v_mfma_f32_32x32x16_bf16 v[48:63], v[124:127], a[76:79], v[48:63]
    ds_read_b64_tr_b16 v[124:125], v15 offset:10240
    ds_read_b64_tr_b16 v[126:127], v15 offset:11264
    buffer_store_dwordx4 v[92:95], v2, s[32:35], s88 offen offset:3072 sc1
    s_waitcnt vmcnt(14)
    s_barrier
    s_waitcnt lgkmcnt(4)
    v_mfma_f32_32x32x16_bf16 v[32:47], v[112:115], a[80:83], v[32:47]
    ds_read_b64_tr_b16 v[112:113], v14 offset:12288
    ds_read_b64_tr_b16 v[114:115], v14 offset:13312
    s_add_u32 m0, s81, 49152
    s_bfe_u32 s86, s70, s72
    s_lshl_b32 s86, s86, 15
    s_add_u32 s86, s86, s80
    v_mfma_f32_32x32x16_bf16 v[48:63], v[116:119], a[80:83], v[48:63]
    buffer_load_dwordx4 v8, s[44:47], s86 offen lds
    ds_read_b64_tr_b16 v[116:117], v15 offset:12288
    ds_read_b64_tr_b16 v[118:119], v15 offset:13312
    s_waitcnt lgkmcnt(4)
    v_mfma_f32_32x32x16_bf16 v[32:47], v[120:123], a[84:87], v[32:47]
    ds_read_b64_tr_b16 v[120:121], v14 offset:14336
    ds_read_b64_tr_b16 v[122:123], v14 offset:15360
    s_add_u32 m0, s81, 50176
    s_add_u32 s86, s86, 16384
    v_mfma_f32_32x32x16_bf16 v[48:63], v[124:127], a[84:87], v[48:63]
    buffer_load_dwordx4 v8, s[44:47], s86 offen lds
    ds_read_b64_tr_b16 v[124:125], v15 offset:14336
    ds_read_b64_tr_b16 v[126:127], v15 offset:15360
    s_waitcnt lgkmcnt(4)
    v_mfma_f32_32x32x16_bf16 v[32:47], v[112:115], a[88:91], v[32:47]
    ds_read_b64_tr_b16 v[112:113], v14 offset:16384
    ds_read_b64_tr_b16 v[114:115], v14 offset:17408
    v_mfma_f32_32x32x16_bf16 v[48:63], v[116:119], a[88:91], v[48:63]
    ds_read_b64_tr_b16 v[116:117], v15 offset:16384
    ds_read_b64_tr_b16 v[118:119], v15 offset:17408
    s_waitcnt lgkmcnt(4)
    v_mfma_f32_32x32x16_bf16 v[32:47], v[120:123], a[92:95], v[32:47]
    ds_read_b64_tr_b16 v[120:121], v14 offset:18432
    ds_read_b64_tr_b16 v[122:123], v14 offset:19456
    v_mfma_f32_32x32x16_bf16 v[48:63], v[124:127], a[92:95], v[48:63]
    ds_read_b64_tr_b16 v[124:125], v15 offset:18432
    ds_read_b64_tr_b16 v[126:127], v15 offset:19456
    s_waitcnt vmcnt(14)
    s_barrier
    s_waitcnt lgkmcnt(4)
    v_mfma_f32_32x32x16_bf16 v[32:47], v[112:115], a[96:99], v[32:47]
    ds_read_b64_tr_b16 v[112:113], v14 offset:20480
    ds_read_b64_tr_b16 v[114:115], v14 offset:21504
    s_add_u32 m0, s81, 57344
    s_bfe_u32 s86, s70, s73
    s_lshl_b32 s86, s86, 15
    s_add_u32 s86, s86, s80
    v_mfma_f32_32x32x16_bf16 v[48:63], v[116:119], a[96:99], v[48:63]
    buffer_load_dwordx4 v8, s[44:47], s86 offen lds
    ds_read_b64_tr_b16 v[116:117], v15 offset:20480
    ds_read_b64_tr_b16 v[118:119], v15 offset:21504
    s_waitcnt lgkmcnt(4)
    v_mfma_f32_32x32x16_bf16 v[32:47], v[120:123], a[100:103], v[32:47]
    ds_read_b64_tr_b16 v[120:121], v14 offset:22528
    ds_read_b64_tr_b16 v[122:123], v14 offset:23552
    s_add_u32 m0, s81, 58368
    s_add_u32 s86, s86, 16384
    v_mfma_f32_32x32x16_bf16 v[48:63], v[124:127], a[100:103], v[48:63]
    buffer_load_dwordx4 v8, s[44:47], s86 offen lds
    ds_read_b64_tr_b16 v[124:125], v15 offset:22528
    ds_read_b64_tr_b16 v[126:127], v15 offset:23552
    s_waitcnt lgkmcnt(4)
    v_mfma_f32_32x32x16_bf16 v[32:47], v[112:115], a[104:107], v[32:47]
    ds_read_b64_tr_b16 v[112:113], v14 offset:24576
    ds_read_b64_tr_b16 v[114:115], v14 offset:25600
    v_mfma_f32_32x32x16_bf16 v[48:63], v[116:119], a[104:107], v[48:63]
    ds_read_b64_tr_b16 v[116:117], v15 offset:24576
    ds_read_b64_tr_b16 v[118:119], v15 offset:25600
    s_waitcnt lgkmcnt(4)
    v_mfma_f32_32x32x16_bf16 v[32:47], v[120:123], a[108:111], v[32:47]
    ds_read_b64_tr_b16 v[120:121], v14 offset:26624
    ds_read_b64_tr_b16 v[122:123], v14 offset:27648
    v_mfma_f32_32x32x16_bf16 v[48:63], v[124:127], a[108:111], v[48:63]
    ds_read_b64_tr_b16 v[124:125], v15 offset:26624
    ds_read_b64_tr_b16 v[126:127], v15 offset:27648
    s_waitcnt vmcnt(14)
    s_waitcnt vmcnt(4)
    s_barrier
    s_add_u32 s28, s21, 112
    s_lshl_b32 s28, s28, 4
    s_add_u32 s28, s28, s87
    s_lshl_b32 s28, s28, 7
    s_add_u32 s28, s28, 26214400
    v_mov_b32 v20, s27
    buffer_store_dword v20, v234, s[32:35], s28 offen sc1
    s_add_u32 s28, s21, 112
    s_lshl_b32 s28, s28, 4
    s_add_u32 s28, s28, s22
    s_lshl_b32 s28, s28, 7
    v_and_b32 v11, 31, v1
    v_lshlrev_b32 v11, 2, v11
    v_add_u32 v11, s28, v11
    v_mov_b32 v20, 0x7ffffff0
    v_cmp_gt_u32 vcc, 64, v0
    s_nop 1
    v_cndmask_b32 v11, v20, v11, vcc
    s_waitcnt lgkmcnt(4)
    v_mfma_f32_32x32x16_bf16 v[32:47], v[112:115], a[112:115], v[32:47]
    ds_read_b64_tr_b16 v[112:113], v14 offset:28672
    ds_read_b64_tr_b16 v[114:115], v14 offset:29696
    s_add_u32 m0, s81, 65536
    s_bfe_u32 s86, s70, s74
    s_lshl_b32 s86, s86, 15
    s_add_u32 s86, s86, s80
    v_mfma_f32_32x32x16_bf16 v[48:63], v[116:119], a[112:115], v[48:63]
    buffer_load_dwordx4 v8, s[44:47], s86 offen lds
    ds_read_b64_tr_b16 v[116:117], v15 offset:28672
    ds_read_b64_tr_b16 v[118:119], v15 offset:29696
    s_waitcnt lgkmcnt(4)
    v_mfma_f32_32x32x16_bf16 v[32:47], v[120:123], a[116:119], v[32:47]
    ds_read_b64_tr_b16 v[120:121], v14 offset:30720
    ds_read_b64_tr_b16 v[122:123], v14 offset:31744
    s_add_u32 m0, s81, 66560
    s_add_u32 s86, s86, 16384
    v_mfma_f32_32x32x16_bf16 v[48:63], v[124:127], a[116:119], v[48:63]
    buffer_load_dwordx4 v8, s[44:47], s86 offen lds
    ds_read_b64_tr_b16 v[124:125], v15 offset:30720
    ds_read_b64_tr_b16 v[126:127], v15 offset:31744
    s_waitcnt lgkmcnt(4)
    v_mfma_f32_32x32x16_bf16 v[32:47], v[112:115], a[120:123], v[32:47]
    ds_read_b64_tr_b16 v[112:113], v14 offset:32768
    ds_read_b64_tr_b16 v[114:115], v14 offset:33792
    v_mfma_f32_32x32x16_bf16 v[48:63], v[116:119], a[120:123], v[48:63]
    ds_read_b64_tr_b16 v[116:117], v15 offset:32768
    ds_read_b64_tr_b16 v[118:119], v15 offset:33792
    s_waitcnt lgkmcnt(4)
    v_mfma_f32_32x32x16_bf16 v[32:47], v[120:123], a[124:127], v[32:47]
    ds_read_b64_tr_b16 v[120:121], v14 offset:34816
    ds_read_b64_tr_b16 v[122:123], v14 offset:35840
    v_mfma_f32_32x32x16_bf16 v[48:63], v[124:127], a[124:127], v[48:63]
    ds_read_b64_tr_b16 v[124:125], v15 offset:34816
    ds_read_b64_tr_b16 v[126:127], v15 offset:35840
    s_waitcnt vmcnt(12)
    s_barrier
    s_waitcnt lgkmcnt(4)
    v_mfma_f32_32x32x16_bf16 v[32:47], v[112:115], a[128:131], v[32:47]
    ds_read_b64_tr_b16 v[112:113], v14 offset:36864
    ds_read_b64_tr_b16 v[114:115], v14 offset:37888
    s_add_u32 m0, s81, 73728
    s_bfe_u32 s86, s70, s75
    s_lshl_b32 s86, s86, 15
    s_add_u32 s86, s86, s80
    v_mfma_f32_32x32x16_bf16 v[48:63], v[116:119], a[128:131], v[48:63]
    buffer_load_dwordx4 v8, s[44:47], s86 offen lds
    ds_read_b64_tr_b16 v[116:117], v15 offset:36864
    ds_read_b64_tr_b16 v[118:119], v15 offset:37888
    s_waitcnt lgkmcnt(4)
    v_mfma_f32_32x32x16_bf16 v[32:47], v[120:123], a[132:135], v[32:47]
    ds_read_b64_tr_b16 v[120:121], v14 offset:38912
    ds_read_b64_tr_b16 v[122:123], v14 offset:39936
    s_add_u32 m0, s81, 74752
    s_add_u32 s86, s86, 16384
    v_mfma_f32_32x32x16_bf16 v[48:63], v[124:127], a[132:135], v[48:63]
    buffer_load_dwordx4 v8, s[44:47], s86 offen lds
    ds_read_b64_tr_b16 v[124:125], v15 offset:38912
    ds_read_b64_tr_b16 v[126:127], v15 offset:39936
    s_waitcnt lgkmcnt(4)
    v_mfma_f32_32x32x16_bf16 v[32:47], v[112:115], a[136:139], v[32:47]
    ds_read_b64_tr_b16 v[112:113], v14 offset:40960
    ds_read_b64_tr_b16 v[114:115], v14 offset:41984
    v_mfma_f32_32x32x16_bf16 v[48:63], v[116:119], a[136:139], v[48:63]
    ds_read_b64_tr_b16 v[116:117], v15 offset:40960
    ds_read_b64_tr_b16 v[118:119], v15 offset:41984
    s_waitcnt lgkmcnt(4)
    v_mfma_f32_32x32x16_bf16 v[32:47], v[120:123], a[140:143], v[32:47]
    ds_read_b64_tr_b16 v[120:121], v14 offset:43008
    ds_read_b64_tr_b16 v[122:123], v14 offset:44032
    v_mfma_f32_32x32x16_bf16 v[48:63], v[124:127], a[140:143], v[48:63]
    ds_read_b64_tr_b16 v[124:125], v15 offset:43008
    ds_read_b64_tr_b16 v[126:127], v15 offset:44032
    s_waitcnt vmcnt(7)
    s_barrier
    s_waitcnt lgkmcnt(4)
    v_mfma_f32_32x32x16_bf16 v[32:47], v[112:115], a[144:147], v[32:47]
    ds_read_b64_tr_b16 v[112:113], v14 offset:45056
    ds_read_b64_tr_b16 v[114:115], v14 offset:46080
    v_mfma_f32_32x32x16_bf16 v[48:63], v[116:119], a[144:147], v[48:63]
    ds_read_b64_tr_b16 v[116:117], v15 offset:45056
    ds_read_b64_tr_b16 v[118:119], v15 offset:46080
    s_waitcnt lgkmcnt(4)
    v_mfma_f32_32x32x16_bf16 v[32:47], v[120:123], a[148:151], v[32:47]
    ds_read_b64_tr_b16 v[120:121], v14 offset:47104
    ds_read_b64_tr_b16 v[122:123], v14 offset:48128
    v_mfma_f32_32x32x16_bf16 v[48:63], v[124:127], a[148:151], v[48:63]
    ds_read_b64_tr_b16 v[124:125], v15 offset:47104
    ds_read_b64_tr_b16 v[126:127], v15 offset:48128
    s_waitcnt lgkmcnt(4)
    v_mfma_f32_32x32x16_bf16 v[32:47], v[112:115], a[152:155], v[32:47]
    ds_read_b64_tr_b16 v[112:113], v14 offset:0
    ds_read_b64_tr_b16 v[114:115], v14 offset:1024
    v_mfma_f32_32x32x16_bf16 v[48:63], v[116:119], a[152:155], v[48:63]
    ds_read_b64_tr_b16 v[116:117], v15 offset:0
    ds_read_b64_tr_b16 v[118:119], v15 offset:1024
    s_waitcnt lgkmcnt(4)
    v_mfma_f32_32x32x16_bf16 v[32:47], v[120:123], a[156:159], v[32:47]
    ds_read_b64_tr_b16 v[120:121], v14 offset:2048
    ds_read_b64_tr_b16 v[122:123], v14 offset:3072
    v_mfma_f32_32x32x16_bf16 v[48:63], v[124:127], a[156:159], v[48:63]
    ds_read_b64_tr_b16 v[124:125], v15 offset:2048
    ds_read_b64_tr_b16 v[126:127], v15 offset:3072
    s_waitcnt vmcnt(5)
    s_barrier
    s_waitcnt lgkmcnt(4)
    v_mfma_f32_32x32x16_bf16 v[32:47], v[112:115], a[160:163], v[32:47]
    ds_read_b64_tr_b16 v[112:113], v14 offset:4096
    ds_read_b64_tr_b16 v[114:115], v14 offset:5120
    v_mfma_f32_32x32x16_bf16 v[48:63], v[116:119], a[160:163], v[48:63]
    ds_read_b64_tr_b16 v[116:117], v15 offset:4096
    ds_read_b64_tr_b16 v[118:119], v15 offset:5120
    s_waitcnt lgkmcnt(4)
    v_mfma_f32_32x32x16_bf16 v[32:47], v[120:123], a[164:167], v[32:47]
    ds_read_b64_tr_b16 v[120:121], v14 offset:6144
    ds_read_b64_tr_b16 v[122:123], v14 offset:7168
    v_mfma_f32_32x32x16_bf16 v[48:63], v[124:127], a[164:167], v[48:63]
    ds_read_b64_tr_b16 v[124:125], v15 offset:6144
    ds_read_b64_tr_b16 v[126:127], v15 offset:7168
    s_waitcnt lgkmcnt(4)
    v_mfma_f32_32x32x16_bf16 v[32:47], v[112:115], a[168:171], v[32:47]
    ds_read_b64_tr_b16 v[112:113], v14 offset:8192
    ds_read_b64_tr_b16 v[114:115], v14 offset:9216
    v_mfma_f32_32x32x16_bf16 v[48:63], v[116:119], a[168:171], v[48:63]
    ds_read_b64_tr_b16 v[116:117], v15 offset:8192
    ds_read_b64_tr_b16 v[118:119], v15 offset:9216
    s_waitcnt lgkmcnt(4)
    v_mfma_f32_32x32x16_bf16 v[32:47], v[120:123], a[172:175], v[32:47]
    ds_read_b64_tr_b16 v[120:121], v14 offset:10240
    ds_read_b64_tr_b16 v[122:123], v14 offset:11264
    v_mfma_f32_32x32x16_bf16 v[48:63], v[124:127], a[172:175], v[48:63]
    ds_read_b64_tr_b16 v[124:125], v15 offset:10240
    ds_read_b64_tr_b16 v[126:127], v15 offset:11264
    s_waitcnt vmcnt(2)
    s_barrier
    s_mov_b32 s31, 26214400
    buffer_load_dword v16, v11, s[32:35], s31 offen sc1
    s_waitcnt lgkmcnt(4)
    v_mfma_f32_32x32x16_bf16 v[32:47], v[112:115], a[176:179], v[32:47]
    ds_read_b64_tr_b16 v[112:113], v14 offset:12288
    ds_read_b64_tr_b16 v[114:115], v14 offset:13312
    v_mfma_f32_32x32x16_bf16 v[48:63], v[116:119], a[176:179], v[48:63]
    ds_read_b64_tr_b16 v[116:117], v15 offset:12288
    ds_read_b64_tr_b16 v[118:119], v15 offset:13312
    s_waitcnt lgkmcnt(4)
    v_mfma_f32_32x32x16_bf16 v[32:47], v[120:123], a[180:183], v[32:47]
    ds_read_b64_tr_b16 v[120:121], v14 offset:14336
    ds_read_b64_tr_b16 v[122:123], v14 offset:15360
    v_mfma_f32_32x32x16_bf16 v[48:63], v[124:127], a[180:183], v[48:63]
    ds_read_b64_tr_b16 v[124:125], v15 offset:14336
    ds_read_b64_tr_b16 v[126:127], v15 offset:15360
    s_waitcnt lgkmcnt(4)
    v_mfma_f32_32x32x16_bf16 v[32:47], v[112:115], a[184:187], v[32:47]
    ds_read_b64_tr_b16 v[112:113], v14 offset:16384
    ds_read_b64_tr_b16 v[114:115], v14 offset:17408
    v_mfma_f32_32x32x16_bf16 v[48:63], v[116:119], a[184:187], v[48:63]
    ds_read_b64_tr_b16 v[116:117], v15 offset:16384
    ds_read_b64_tr_b16 v[118:119], v15 offset:17408
    s_waitcnt lgkmcnt(4)
    v_mfma_f32_32x32x16_bf16 v[32:47], v[120:123], a[188:191], v[32:47]
    ds_read_b64_tr_b16 v[120:121], v14 offset:18432
    ds_read_b64_tr_b16 v[122:123], v14 offset:19456
    v_mfma_f32_32x32x16_bf16 v[48:63], v[124:127], a[188:191], v[48:63]
    ds_read_b64_tr_b16 v[124:125], v15 offset:18432
    ds_read_b64_tr_b16 v[126:127], v15 offset:19456
    s_waitcnt vmcnt(1)
    s_waitcnt vmcnt(0)
    s_cmp_lg_u32 s20, 0
    s_cbranch_scc1 L_w_25
    s_mov_b32 s30, 200000
    s_mov_b32 s31, 26214400
    v_cmp_eq_u32 vcc, s27, v16
    s_nop 0
    s_cmp_eq_u64 vcc, -1
    s_cbranch_scc1 L_pdone_27
L_poll_26:
    buffer_load_dword v16, v11, s[32:35], s31 offen sc1
    s_waitcnt vmcnt(0)
    v_cmp_eq_u32 vcc, s27, v16
    s_nop 0
    s_cmp_eq_u64 vcc, -1
    s_cbranch_scc1 L_pdone_27
    s_sleep 1
    s_sub_u32 s30, s30, 1
    s_cmp_lg_u32 s30, 0
    s_cbranch_scc1 L_poll_26
L_pdone_27:
L_w_25:
    s_barrier
    s_lshl_b32 s88, s21, 4
    s_add_u32 s88, s88, s22
    s_lshl_b32 s88, s88, 2
    s_add_u32 s88, s88, s20
    s_lshl_b32 s88, s88, 13
    s_add_u32 s88, s88, 29360128
    s_waitcnt lgkmcnt(4)
    v_mfma_f32_32x32x16_bf16 v[32:47], v[112:115], a[192:195], v[32:47]
    ds_read_b64_tr_b16 v[112:113], v14 offset:20480
    ds_read_b64_tr_b16 v[114:115], v14 offset:21504
    buffer_load_dwordx4 v[128:131], v2, s[32:35], s88 offen offset:0 sc1
    v_mfma_f32_32x32x16_bf16 v[48:63], v[116:119], a[192:195], v[48:63]
    ds_read_b64_tr_b16 v[116:117], v15 offset:20480
    ds_read_b64_tr_b16 v[118:119], v15 offset:21504
    buffer_load_dwordx4 v[132:135], v2, s[32:35], s88 offen offset:1024 sc1
    s_waitcnt lgkmcnt(4)
    v_mfma_f32_32x32x16_bf16 v[32:47], v[120:123], a[196:199], v[32:47]
    ds_read_b64_tr_b16 v[120:121], v14 offset:22528
    ds_read_b64_tr_b16 v[122:123], v14 offset:23552
    buffer_load_dwordx4 v[136:139], v2, s[32:35], s88 offen offset:2048 sc1
    v_mfma_f32_32x32x16_bf16 v[48:63], v[124:127], a[196:199], v[48:63]
    ds_read_b64_tr_b16 v[124:125], v15 offset:22528
    ds_read_b64_tr_b16 v[126:127], v15 offset:23552
    buffer_load_dwordx4 v[140:143], v2, s[32:35], s88 offen offset:3072 sc1
    s_waitcnt lgkmcnt(4)
    v_mfma_f32_32x32x16_bf16 v[32:47], v[112:115], a[200:203], v[32:47]
    ds_read_b64_tr_b16 v[112:113], v14 offset:24576
    ds_read_b64_tr_b16 v[114:115], v14 offset:25600
    s_add_u32 s88, s88, 4096
    buffer_load_dwordx4 v[144:147], v2, s[32:35], s88 offen offset:0 sc1
    v_mfma_f32_32x32x16_bf16 v[48:63], v[116:119], a[200:203], v[48:63]
    ds_read_b64_tr_b16 v[116:117], v15 offset:24576
    ds_read_b64_tr_b16 v[118:119], v15 offset:25600
    buffer_load_dwordx4 v[148:151], v2, s[32:35], s88 offen offset:1024 sc1
    s_waitcnt lgkmcnt(4)
    v_mfma_f32_32x32x16_bf16 v[32:47], v[120:123], a[204:207], v[32:47]
    ds_read_b64_tr_b16 v[120:121], v14 offset:26624
    ds_read_b64_tr_b16 v[122:123], v14 offset:27648
    buffer_load_dwordx4 v[152:155], v2, s[32:35], s88 offen offset:2048 sc1
    v_mfma_f32_32x32x16_bf16 v[48:63], v[124:127], a[204:207], v[48:63]
    ds_read_b64_tr_b16 v[124:125], v15 offset:26624
    ds_read_b64_tr_b16 v[126:127], v15 offset:27648
    buffer_load_dwordx4 v[156:159], v2, s[32:35], s88 offen offset:3072 sc1
    s_barrier
    s_waitcnt lgkmcnt(4)
    v_mfma_f32_32x32x16_bf16 v[32:47], v[112:115], a[208:211], v[32:47]
    ds_read_b64_tr_b16 v[112:113], v14 offset:28672
    ds_read_b64_tr_b16 v[114:115], v14 offset:29696
    v_mfma_f32_32x32x16_bf16 v[48:63], v[116:119], a[208:211], v[48:63]
    ds_read_b64_tr_b16 v[116:117], v15 offset:28672
    ds_read_b64_tr_b16 v[118:119], v15 offset:29696
    s_waitcnt lgkmcnt(4)
    v_mfma_f32_32x32x16_bf16 v[32:47], v[120:123], a[212:215], v[32:47]
    ds_read_b64_tr_b16 v[120:121], v14 offset:30720
    ds_read_b64_tr_b16 v[122:123], v14 offset:31744
    v_mfma_f32_32x32x16_bf16 v[48:63], v[124:127], a[212:215], v[48:63]
    ds_read_b64_tr_b16 v[124:125], v15 offset:30720
    ds_read_b64_tr_b16 v[126:127], v15 offset:31744
    s_waitcnt lgkmcnt(4)
    v_mfma_f32_32x32x16_bf16 v[32:47], v[112:115], a[216:219], v[32:47]
    v_mfma_f32_32x32x16_bf16 v[48:63], v[116:119], a[216:219], v[48:63]
    s_waitcnt lgkmcnt(0)
    v_mfma_f32_32x32x16_bf16 v[32:47], v[120:123], a[220:223], v[32:47]
    v_mfma_f32_32x32x16_bf16 v[48:63], v[124:127], a[220:223], v[48:63]
    s_mov_b32 s44, s14
    s_and_b32 s45, s15, 0xffff
    s_mov_b32 s46, 4194304
    s_mov_b32 s47, 0x20000
    v_lshlrev_b32 v96, 16, v240
    v_and_b32 v97, 0xffff0000, v240
    s_nop 4
    v_pk_add_f32 v[32:33], v[32:33], v[96:97]
    v_lshlrev_b32 v96, 16, v241
    v_and_b32 v97, 0xffff0000, v241
    v_pk_add_f32 v[34:35], v[34:35], v[96:97]
    v_lshlrev_b32 v96, 16, v242
    v_and_b32 v97, 0xffff0000, v242
    v_pk_add_f32 v[36:37], v[36:37], v[96:97]
    v_lshlrev_b32 v96, 16, v243
    v_and_b32 v97, 0xffff0000, v243
    v_pk_add_f32 v[38:39], v[38:39], v[96:97]
    v_lshlrev_b32 v96, 16, v244
    v_and_b32 v97, 0xffff0000, v244
    v_pk_add_f32 v[40:41], v[40:41], v[96:97]
    v_lshlrev_b32 v96, 16, v245
    v_and_b32 v97, 0xffff0000, v245
    v_pk_add_f32 v[42:43], v[42:43], v[96:97]
    v_lshlrev_b32 v96, 16, v246
    v_and_b32 v97, 0xffff0000, v246
    v_pk_add_f32 v[44:45], v[44:45], v[96:97]
    v_lshlrev_b32 v96, 16, v247
    v_and_b32 v97, 0xffff0000, v247
    v_pk_add_f32 v[46:47], v[46:47], v[96:97]
    v_lshlrev_b32 v96, 16, v248
    v_and_b32 v97, 0xffff0000, v248
    v_pk_add_f32 v[48:49], v[48:49], v[96:97]
    v_lshlrev_b32 v96, 16, v249
    v_and_b32 v97, 0xffff0000, v249
    v_pk_add_f32 v[50:51], v[50:51], v[96:97]
    v_lshlrev_b32 v96, 16, v250
    v_and_b32 v97, 0xffff0000, v250
    v_pk_add_f32 v[52:53], v[52:53], v[96:97]
    v_lshlrev_b32 v96, 16, v251
    v_and_b32 v97, 0xffff0000, v251
    v_pk_add_f32 v[54:55], v[54:55], v[96:97]
    v_lshlrev_b32 v96, 16, v252
    v_and_b32 v97, 0xffff0000, v252
    v_pk_add_f32 v[56:57], v[56:57], v[96:97]
    v_lshlrev_b32 v96, 16, v253
    v_and_b32 v97, 0xffff0000, v253
    v_pk_add_f32 v[58:59], v[58:59], v[96:97]
    v_lshlrev_b32 v96, 16, v254
    v_and_b32 v97, 0xffff0000, v254
    v_pk_add_f32 v[60:61], v[60:61], v[96:97]
    v_lshlrev_b32 v96, 16, v255
    v_and_b32 v97, 0xffff0000, v255
    v_pk_add_f32 v[62:63], v[62:63], v[96:97]
    v_and_b32 v20, 31, v1
    v_lshlrev_b32 v21, 7, v20
    v_lshrrev_b32 v20, 1, v20
    v_and_b32 v20, 7, v20
    v_lshlrev_b32 v20, 4, v20
    v_add_u32 v21, v21, v20
    v_lshrrev_b32 v20, 5, v1
    v_lshlrev_b32 v20, 3, v20
    v_add_u32 v21, v21, v20
    s_lshl_b32 s30, s20, 12
    s_add_u32 s30, s30, 102400
    v_add_u32 v21, s30, v21
    v_add_u32 v23, s30, v2
    s_lshl_b32 s57, s25, 16
    s_lshl_b32 s31, s22, 7
    s_add_u32 s57, s57, s31
    v_lshrrev_b32 v26, 3, v1
    v_lshlrev_b32 v26, 11, v26
    v_lshrrev_b32 v27, 4, v1
    v_and_b32 v24, 7, v1
    v_xor_b32 v24, v24, v27
    v_xor_b32 v25, 4, v24
    v_lshlrev_b32 v24, 4, v24
    v_lshlrev_b32 v25, 4, v25
    v_add_u32 v24, v24, v26
    v_add_u32 v25, v25, v26
    s_waitcnt vmcnt(7)
    v_pk_add_f32 v[32:33], v[32:33], v[128:129]
    v_cvt_pk_bf16_f32 v80, v32, v33
    v_pk_add_f32 v[34:35], v[34:35], v[130:131]
    v_cvt_pk_bf16_f32 v81, v34, v35
    v_xor_b32 v22, 0, v21
    ds_write_b64 v22, v[80:81]
    s_waitcnt vmcnt(6)
    v_pk_add_f32 v[36:37], v[36:37], v[132:133]
    v_cvt_pk_bf16_f32 v82, v36, v37
    v_pk_add_f32 v[38:39], v[38:39], v[134:135]
    v_cvt_pk_bf16_f32 v83, v38, v39
    v_xor_b32 v22, 16, v21
    ds_write_b64 v22, v[82:83]
    s_waitcnt vmcnt(5)
    v_pk_add_f32 v[40:41], v[40:41], v[136:137]
    v_cvt_pk_bf16_f32 v84, v40, v41
    v_pk_add_f32 v[42:43], v[42:43], v[138:139]
    v_cvt_pk_bf16_f32 v85, v42, v43
    v_xor_b32 v22, 32, v21
    ds_write_b64 v22, v[84:85]
    s_waitcnt vmcnt(4)
    v_pk_add_f32 v[44:45], v[44:45], v[140:141]
    v_cvt_pk_bf16_f32 v86, v44, v45
    v_pk_add_f32 v[46:47], v[46:47], v[142:143]
    v_cvt_pk_bf16_f32 v87, v46, v47
    v_xor_b32 v22, 48, v21
    ds_write_b64 v22, v[86:87]
    s_waitcnt vmcnt(3)
    v_pk_add_f32 v[48:49], v[48:49], v[144:145]
    v_cvt_pk_bf16_f32 v88, v48, v49
    v_pk_add_f32 v[50:51], v[50:51], v[146:147]
    v_cvt_pk_bf16_f32 v89, v50, v51
    v_xor_b32 v22, 64, v21
    ds_write_b64 v22, v[88:89]
    s_waitcnt vmcnt(2)
    v_pk_add_f32 v[52:53], v[52:53], v[148:149]
    v_cvt_pk_bf16_f32 v90, v52, v53
    v_pk_add_f32 v[54:55], v[54:55], v[150:151]
    v_cvt_pk_bf16_f32 v91, v54, v55
    v_xor_b32 v22, 80, v21
    ds_write_b64 v22, v[90:91]
    s_waitcnt vmcnt(1)
    v_pk_add_f32 v[56:57], v[56:57], v[152:153]
    v_cvt_pk_bf16_f32 v92, v56, v57
    v_pk_add_f32 v[58:59], v[58:59], v[154:155]
    v_cvt_pk_bf16_f32 v93, v58, v59
    v_xor_b32 v22, 96, v21
    ds_write_b64 v22, v[92:93]
    s_waitcnt vmcnt(0)
    v_pk_add_f32 v[60:61], v[60:61], v[156:157]
    v_cvt_pk_bf16_f32 v94, v60, v61
    v_pk_add_f32 v[62:63], v[62:63], v[158:159]
    v_cvt_pk_bf16_f32 v95, v62, v63
    v_xor_b32 v22, 112, v21
    ds_write_b64 v22, v[94:95]
    s_waitcnt lgkmcnt(0)
    ds_read_b128 v[96:99], v23 offset:0
    ds_read_b128 v[100:103], v23 offset:1024
    ds_read_b128 v[104:107], v23 offset:2048
    ds_read_b128 v[108:111], v23 offset:3072
    s_waitcnt lgkmcnt(3)
    buffer_store_dwordx4 v[96:99], v24, s[44:47], s57 offen sc1
    s_waitcnt lgkmcnt(2)
    s_add_u32 s57, s57, 16384
    buffer_store_dwordx4 v[100:103], v25, s[44:47], s57 offen sc1
    s_waitcnt lgkmcnt(1)
    s_add_u32 s57, s57, 16384
    buffer_store_dwordx4 v[104:107], v24, s[44:47], s57 offen sc1
    s_waitcnt lgkmcnt(0)
    s_add_u32 s57, s57, 16384
    buffer_store_dwordx4 v[108:111], v25, s[44:47], s57 offen sc1
L_end:
    s_endpgm

.section .rodata,"a"
.p2align 6
.amdhsa_kernel standalone__mixer_s_mlp__prompt_kernel
  .amdhsa_next_free_vgpr 512
  .amdhsa_next_free_sgpr 102
  .amdhsa_accum_offset 256
  .amdhsa_group_segment_fixed_size 0
  .amdhsa_kernarg_size 64
  .amdhsa_user_sgpr_count 2
  .amdhsa_user_sgpr_kernarg_segment_ptr 1
  .amdhsa_system_sgpr_workgroup_id_x 1
.end_amdhsa_kernel
```
